```python
import torch

def _softmax(x, axis=-1):
    return torch.softmax(x, dim=axis)
def _gelu(x):
    return torch.nn.functional.gelu(x, approximate="tanh")
def _silu(x):
    return torch.nn.functional.silu(x)
def _sigmoid(x):
    return torch.sigmoid(x)
def _layernorm(x, axis=-1, eps=1e-5):
    m = x.mean(dim=axis, keepdim=True)
    v = x.var(dim=axis, keepdim=True, unbiased=False)
    return (x - m) / torch.sqrt(v + eps)
def _scatter_add(tgt, idx, src, axis=0):
    return tgt.clone().index_add_(axis, idx, src)
def _segment_sum(src, seg, n):
    out = torch.zeros((n,) + src.shape[1:], dtype=src.dtype)
    return out.index_add_(0, seg, src)
def _pad(x, pw):
    flat = tuple(v for pair in reversed(pw) for v in pair)
    return torch.nn.functional.pad(x, flat)

kernel_name = 'sequential_preLN__sliding_block_cached__swiglu_ffn__decode'

def setup_inputs():

    _w = (lambda a: (lambda t: t.to(torch.bfloat16) if t.is_floating_point() else t)(torch.as_tensor(a)))
    def _A_setup():
        B, Sq, D = 4, 1, 512
        Hq, Hkv, Sk, Dh = 32, 32, 8192, 128
        assert Hq % Hkv == 0, (Hq, Hkv)
        return {
            "x": _w((lambda *s: torch.randn(*s, dtype=torch.bfloat16) * 0.05)(B, Sq, D)),
            "k_cache": _w((lambda *s: torch.randn(*s, dtype=torch.bfloat16) * 3.2)(B, Hkv, Sk, Dh)),
            "v_cache": _w((lambda *s: torch.randn(*s, dtype=torch.bfloat16) * 0.4)(B, Hkv, Sk, Dh)),
            "wq": _w((lambda *s: torch.randn(*s, dtype=torch.bfloat16) * 3.2)(D, Hq * Dh) * (D ** -0.5)),
            "wo": _w((lambda *s: torch.randn(*s, dtype=torch.bfloat16) * 0.4)(Hq * Dh, D) * ((Hq * Dh) ** -0.5)),
        }
    _A_in = _A_setup()

    def _B_setup():
        B, S, D, F = 4, 1, 512, 1376
        return {
            "x": _w((lambda *s: torch.randn(*s, dtype=torch.bfloat16) * 0.05)(B, S, D)),
            "w_gate": _w((lambda *s: torch.randn(*s, dtype=torch.bfloat16) * 0.05)(D, F)),
            "w_up": _w((lambda *s: torch.randn(*s, dtype=torch.bfloat16) * 0.05)(D, F)),
            "w_down": _w((lambda *s: torch.randn(*s, dtype=torch.bfloat16) * 0.05)(F, D)),
        }
    _B_in = _B_setup()

    return {
        "A_x": _A_in["x"],
        "A_k_cache": _A_in["k_cache"],
        "A_v_cache": _A_in["v_cache"],
        "A_wq": _A_in["wq"],
        "A_wo": _A_in["wo"],
        "B_x": _B_in["x"],
        "B_w_gate": _B_in["w_gate"],
        "B_w_up": _B_in["w_up"],
        "B_w_down": _B_in["w_down"],
    }

def reference(A_x, A_k_cache, A_v_cache, A_wq, A_wo, B_x, B_w_gate, B_w_up, B_w_down):
    def _A_ref(x, k_cache, v_cache, wq, wo):
        B, Sq, D = x.shape
        Hq, Dh = 32, 128
        Hkv, Sk = k_cache.shape[1], k_cache.shape[2]
        W = min(4096, max(256, Sk // 4))
        rep = Hq // Hkv
        q = (lambda x, *d: x.permute(*d))((x @ wq).reshape(B, Sq, Hq, Dh), 0, 2, 1, 3)
        k = (lambda x, n, axis: torch.repeat_interleave(x, n, dim=axis))(k_cache[:, :, Sk - W:, :], rep, axis=1)
        v = (lambda x, n, axis: torch.repeat_interleave(x, n, dim=axis))(v_cache[:, :, Sk - W:, :], rep, axis=1)
        scores = torch.einsum("bhqd,bhkd->bhqk", q, k) * (Dh ** -0.5)
        p = _softmax(scores, axis=-1)
        o = torch.einsum("bhqk,bhkd->bhqd", p, v)
        return (lambda x, *d: x.permute(*d))(o, 0, 2, 1, 3).reshape(B, Sq, Hq * Dh) @ wo

    def _B_ref(x, w_gate, w_up, w_down):
        g = _silu(x @ w_gate)
        u = x @ w_up
        return (g * u) @ w_down

    x = A_x
    h = x + _A_ref(_layernorm(x, axis=-1), A_k_cache, A_v_cache, A_wq, A_wo)
    h2 = h + _B_ref(_layernorm(h, axis=-1), B_w_gate, B_w_up, B_w_down)
    return h2
```

```asm
; @launch grid=(256,1,1) block=(512,1,1) lds=149248
.amdgcn_target "amdgcn-amd-amdhsa--gfx950"
.text
.globl sequential_preLN__sliding_block_cached__swiglu_ffn__decode_kernel
.p2align 8
.type sequential_preLN__sliding_block_cached__swiglu_ffn__decode_kernel,@function
sequential_preLN__sliding_block_cached__swiglu_ffn__decode_kernel:
  s_cmp_ge_u32 s2, 256
  s_cbranch_scc1 L_end
  s_load_dwordx16 s[16:31], s[0:1], 0
  s_load_dwordx8 s[32:39], s[0:1], 64
  v_and_b32 v1, 63, v0
  v_lshrrev_b32 v4, 6, v0
  v_lshrrev_b32 v2, 4, v1
  v_and_b32 v3, 15, v1
  v_readfirstlane_b32 s3, v4
  s_setprio 2
  s_and_b32 s4, s2, 7
  s_lshl_b32 s4, s4, 2
  s_lshr_b32 s9, s2, 3
  s_and_b32 s9, s9, 3
  s_add_u32 s4, s4, s9
  s_lshr_b32 s8, s2, 5
  s_lshr_b32 s5, s8, 1
  s_and_b32 s6, s8, 1
  s_xor_b32 s7, s2, 32
  s_mov_b32 s84, 0
  s_mov_b32 s85, 4096
  s_mov_b32 s86, 8192
  s_mov_b32 s87, 12288
  s_mov_b32 s88, 16384
  s_mov_b32 s89, 20480
  s_mov_b32 s90, 24576
  s_mov_b32 s91, 28672
  v_lshlrev_b32 v6, 4, v1
  s_waitcnt lgkmcnt(0)
  s_mov_b32 s40, s18
  s_mov_b32 s41, s19
  s_mov_b32 s42, 0x10000000
  s_mov_b32 s43, 0x00020000
  s_mov_b32 s44, s20
  s_mov_b32 s45, s21
  s_mov_b32 s46, 0x10000000
  s_mov_b32 s47, 0x00020000
  s_mov_b32 s48, s22
  s_mov_b32 s49, s23
  s_mov_b32 s50, 0x400000
  s_mov_b32 s51, 0x00020000
  s_mov_b32 s52, s24
  s_mov_b32 s53, s25
  s_mov_b32 s54, 0x400000
  s_mov_b32 s55, 0x00020000
  s_mov_b32 s56, s16
  s_mov_b32 s57, s17
  s_mov_b32 s58, 0x1000
  s_mov_b32 s59, 0x00020000
  s_mov_b32 s60, s28
  s_mov_b32 s61, s29
  s_mov_b32 s62, 0x158000
  s_mov_b32 s63, 0x00020000
  s_mov_b32 s64, s30
  s_mov_b32 s65, s31
  s_mov_b32 s66, 0x158000
  s_mov_b32 s67, 0x00020000
  s_mov_b32 s68, s32
  s_mov_b32 s69, s33
  s_mov_b32 s70, 0x158000
  s_mov_b32 s71, 0x00020000
  s_mov_b32 s72, s34
  s_mov_b32 s73, s35
  s_mov_b32 s74, 0x1000
  s_mov_b32 s75, 0x00020000
  s_mov_b32 s76, s36
  s_mov_b32 s77, s37
  s_mov_b32 s78, 0x100
  s_mov_b32 s79, 0x00020000
  s_mov_b32 s80, s38
  s_mov_b32 s81, s39
  s_mov_b32 s82, 0x1b6000
  s_mov_b32 s83, 0x00020000
  s_lshl_b32 s9, s5, 5
  s_add_u32 s9, s9, s4
  s_lshl_b32 s9, s9, 21
  s_add_u32 s9, s9, 0x180000
  s_lshl_b32 s10, s6, 18
  s_add_u32 s10, s10, s9
  s_lshl_b32 s11, s3, 15
  s_add_u32 s10, s10, s11
  v_add_u32 v4, s10, v6
  s_mul_i32 s101, s3, 1024
  s_add_u32 s101, s101, 0
  s_cmp_lg_u32 s3, 7
  s_cbranch_scc1 L_pre_done
  s_setprio 3
  v_mov_b32 v12, -1
  v_mov_b32 v8, 0
  v_mov_b32 v13, -1
  v_mov_b32 v9, 0
  v_mov_b32 v14, -1
  v_mov_b32 v10, 0
  v_mov_b32 v15, -1
  v_mov_b32 v11, 0
  s_cmp_lg_u32 s2, 0
  s_cbranch_scc1 L_pre_nn
  s_memrealtime s[12:13]
  s_waitcnt lgkmcnt(0)
  s_or_b32 s12, s12, 1
  v_mov_b32 v16, s12
  v_mov_b32 v17, s13
  v_mov_b32 v18, 0
  v_mov_b32 v19, 0
  s_mov_b64 s[10:11], exec
  s_mov_b64 exec, 1
  buffer_atomic_cmpswap_x2 v[16:19], v8, s[76:79], 0 offen sc1
  s_mov_b64 exec, s[10:11]
L_pre_nn:
  s_lshl_b32 s9, s2, 10
  v_add_u32 v7, s9, v6
  buffer_store_dwordx4 v[12:15], v7, s[80:83], 0 offen sc1
  s_cmp_lg_u32 s2, 0
  s_cbranch_scc1 L_pre_nz
  v_add_u32 v7, 0x150000, v6
  buffer_store_dwordx4 v[8:11], v7, s[80:83], s84 offen offset:0 sc1
  buffer_store_dwordx4 v[8:11], v7, s[80:83], s84 offen offset:1024 sc1
  buffer_store_dwordx4 v[8:11], v7, s[80:83], s84 offen offset:2048 sc1
  buffer_store_dwordx4 v[8:11], v7, s[80:83], s84 offen offset:3072 sc1
  buffer_store_dwordx4 v[8:11], v7, s[80:83], s85 offen offset:0 sc1
  buffer_store_dwordx4 v[8:11], v7, s[80:83], s85 offen offset:1024 sc1
  buffer_store_dwordx4 v[8:11], v7, s[80:83], s85 offen offset:2048 sc1
  buffer_store_dwordx4 v[8:11], v7, s[80:83], s85 offen offset:3072 sc1
  buffer_store_dwordx4 v[8:11], v7, s[80:83], s86 offen offset:0 sc1
  buffer_store_dwordx4 v[8:11], v7, s[80:83], s86 offen offset:1024 sc1
L_pre_nz:
  s_cmp_ge_u32 s2, 43
  s_cbranch_scc1 L_pre_nf
  s_lshl_b32 s9, s2, 13
  s_add_u32 s9, s9, 0x160000
  v_add_u32 v7, s9, v6
  buffer_store_dwordx4 v[12:15], v7, s[80:83], s84 offen offset:0 sc1
  buffer_store_dwordx4 v[12:15], v7, s[80:83], s84 offen offset:1024 sc1
  buffer_store_dwordx4 v[12:15], v7, s[80:83], s84 offen offset:2048 sc1
  buffer_store_dwordx4 v[12:15], v7, s[80:83], s84 offen offset:3072 sc1
  buffer_store_dwordx4 v[12:15], v7, s[80:83], s85 offen offset:0 sc1
  buffer_store_dwordx4 v[12:15], v7, s[80:83], s85 offen offset:1024 sc1
  buffer_store_dwordx4 v[12:15], v7, s[80:83], s85 offen offset:2048 sc1
  buffer_store_dwordx4 v[12:15], v7, s[80:83], s85 offen offset:3072 sc1
L_pre_nf:
  buffer_load_dwordx2 v[58:59], v8, s[76:79], 0 offen sc1
L_pre_done:
  s_cmp_eq_u32 s3, 7
  s_cbranch_scc1 L_commq
  buffer_load_dwordx4 v[128:131], v4, s[40:43], s84 offen offset:0 nt
  buffer_load_dwordx4 v[132:135], v4, s[40:43], s84 offen offset:1024 nt
  buffer_load_dwordx4 v[136:139], v4, s[40:43], s84 offen offset:2048 nt
  buffer_load_dwordx4 v[140:143], v4, s[40:43], s84 offen offset:3072 nt
  s_waitcnt vmcnt(3)
  buffer_load_dwordx4 v[144:147], v4, s[40:43], s85 offen offset:0 nt
  s_waitcnt vmcnt(3)
  buffer_load_dwordx4 v[148:151], v4, s[40:43], s85 offen offset:1024 nt
  s_waitcnt vmcnt(3)
  buffer_load_dwordx4 v[152:155], v4, s[40:43], s85 offen offset:2048 nt
  s_waitcnt vmcnt(3)
  buffer_load_dwordx4 v[156:159], v4, s[40:43], s85 offen offset:3072 nt
  s_waitcnt vmcnt(3)
  buffer_load_dwordx4 v[160:163], v4, s[40:43], s86 offen offset:0 nt
  s_waitcnt vmcnt(3)
  buffer_load_dwordx4 v[164:167], v4, s[40:43], s86 offen offset:1024 nt
  s_waitcnt vmcnt(3)
  buffer_load_dwordx4 v[168:171], v4, s[40:43], s86 offen offset:2048 nt
  s_waitcnt vmcnt(3)
  buffer_load_dwordx4 v[172:175], v4, s[40:43], s86 offen offset:3072 nt
  s_waitcnt vmcnt(3)
  buffer_load_dwordx4 v[176:179], v4, s[40:43], s87 offen offset:0 nt
  s_waitcnt vmcnt(3)
  buffer_load_dwordx4 v[180:183], v4, s[40:43], s87 offen offset:1024 nt
  s_waitcnt vmcnt(3)
  buffer_load_dwordx4 v[184:187], v4, s[40:43], s87 offen offset:2048 nt
  s_waitcnt vmcnt(3)
  buffer_load_dwordx4 v[188:191], v4, s[40:43], s87 offen offset:3072 nt
  s_waitcnt vmcnt(3)
  buffer_load_dwordx4 v[192:195], v4, s[40:43], s88 offen offset:0 nt
  s_waitcnt vmcnt(3)
  buffer_load_dwordx4 v[196:199], v4, s[40:43], s88 offen offset:1024 nt
  s_waitcnt vmcnt(3)
  buffer_load_dwordx4 v[200:203], v4, s[40:43], s88 offen offset:2048 nt
  s_waitcnt vmcnt(3)
  buffer_load_dwordx4 v[204:207], v4, s[40:43], s88 offen offset:3072 nt
  s_waitcnt vmcnt(3)
  buffer_load_dwordx4 v[208:211], v4, s[40:43], s89 offen offset:0 nt
  s_waitcnt vmcnt(3)
  buffer_load_dwordx4 v[212:215], v4, s[40:43], s89 offen offset:1024 nt
  s_waitcnt vmcnt(3)
  buffer_load_dwordx4 v[216:219], v4, s[40:43], s89 offen offset:2048 nt
  s_waitcnt vmcnt(3)
  buffer_load_dwordx4 v[220:223], v4, s[40:43], s89 offen offset:3072 nt
  s_barrier
  s_branch L_qready
L_commq:
  v_add_u32 v7, 0, v6
  buffer_load_dwordx4 v[64:67], v7, s[56:59], 0 offen
  v_add_u32 v7, 1024, v6
  buffer_load_dwordx4 v[68:71], v7, s[56:59], 0 offen
  v_add_u32 v7, 2048, v6
  buffer_load_dwordx4 v[72:75], v7, s[56:59], 0 offen
  v_add_u32 v7, 3072, v6
  buffer_load_dwordx4 v[76:79], v7, s[56:59], 0 offen
  s_lshl_b32 s9, s8, 6
  v_add_u32 v7, s9, v2
  v_lshlrev_b32 v7, 13, v7
  v_lshlrev_b32 v8, 4, v3
  v_add_u32 v7, v7, v8
  s_lshl_b32 s9, s4, 8
  v_add_u32 v7, s9, v7
  s_mov_b32 m0, 132736
  s_nop 0
  buffer_load_dwordx4 v7, s[48:51], 0 offen nt lds
  v_add_u32 v7, 0x8000, v7
  s_mov_b32 m0, 133760
  s_nop 0
  buffer_load_dwordx4 v7, s[48:51], 0 offen nt lds
  v_add_u32 v7, 0x8000, v7
  s_mov_b32 m0, 134784
  s_nop 0
  buffer_load_dwordx4 v7, s[48:51], 0 offen nt lds
  v_add_u32 v7, 0x8000, v7
  s_mov_b32 m0, 135808
  s_nop 0
  buffer_load_dwordx4 v7, s[48:51], 0 offen nt lds
  v_add_u32 v7, 0x8000, v7
  s_mov_b32 m0, 136832
  s_nop 0
  buffer_load_dwordx4 v7, s[48:51], 0 offen nt lds
  v_add_u32 v7, 0x8000, v7
  s_mov_b32 m0, 137856
  s_nop 0
  buffer_load_dwordx4 v7, s[48:51], 0 offen nt lds
  v_add_u32 v7, 0x8000, v7
  s_mov_b32 m0, 138880
  s_nop 0
  buffer_load_dwordx4 v7, s[48:51], 0 offen nt lds
  v_add_u32 v7, 0x8000, v7
  s_mov_b32 m0, 139904
  s_nop 0
  buffer_load_dwordx4 v7, s[48:51], 0 offen nt lds
  v_add_u32 v7, 0x8000, v7
  s_mov_b32 m0, 140928
  s_nop 0
  buffer_load_dwordx4 v7, s[48:51], 0 offen nt lds
  v_add_u32 v7, 0x8000, v7
  s_mov_b32 m0, 141952
  s_nop 0
  buffer_load_dwordx4 v7, s[48:51], 0 offen nt lds
  v_add_u32 v7, 0x8000, v7
  s_mov_b32 m0, 142976
  s_nop 0
  buffer_load_dwordx4 v7, s[48:51], 0 offen nt lds
  v_add_u32 v7, 0x8000, v7
  s_mov_b32 m0, 144000
  s_nop 0
  buffer_load_dwordx4 v7, s[48:51], 0 offen nt lds
  v_add_u32 v7, 0x8000, v7
  s_mov_b32 m0, 145024
  s_nop 0
  buffer_load_dwordx4 v7, s[48:51], 0 offen nt lds
  v_add_u32 v7, 0x8000, v7
  s_mov_b32 m0, 146048
  s_nop 0
  buffer_load_dwordx4 v7, s[48:51], 0 offen nt lds
  v_add_u32 v7, 0x8000, v7
  s_mov_b32 m0, 147072
  s_nop 0
  buffer_load_dwordx4 v7, s[48:51], 0 offen nt lds
  v_add_u32 v7, 0x8000, v7
  s_mov_b32 m0, 148096
  s_nop 0
  buffer_load_dwordx4 v7, s[48:51], 0 offen nt lds
  v_mov_b32 v7, 149120
  v_mov_b32 v8, 0
  v_mov_b32 v9, 0
  ds_write_b64 v7, v[8:9]
  ds_write_b64 v7, v[8:9] offset:8
  ds_write_b64 v7, v[8:9] offset:16
  v_lshrrev_b32 v7, 3, v1
  v_cmp_eq_u32 s[32:33], s8, v7
  v_and_b32 v5, 7, v1
  v_lshlrev_b32 v5, 4, v5
  v_add_u32 v5, 115840, v5
  s_waitcnt vmcnt(19)
  v_lshlrev_b32 v20, 16, v64
  v_and_b32 v21, 0xffff0000, v64
  v_lshlrev_b32 v22, 16, v65
  v_and_b32 v23, 0xffff0000, v65
  v_lshlrev_b32 v24, 16, v66
  v_and_b32 v25, 0xffff0000, v66
  v_lshlrev_b32 v26, 16, v67
  v_and_b32 v27, 0xffff0000, v67
  v_add_f32 v36, v20, v21
  v_add_f32 v36, v36, v22
  v_add_f32 v36, v36, v23
  v_add_f32 v36, v36, v24
  v_add_f32 v36, v36, v25
  v_add_f32 v36, v36, v26
  v_add_f32 v36, v36, v27
  s_nop 1
  v_add_f32_dpp v36, v36, v36 row_ror:8 row_mask:0xf bank_mask:0xf
  s_nop 1
  v_add_f32_dpp v36, v36, v36 row_ror:4 row_mask:0xf bank_mask:0xf
  s_nop 1
  v_add_f32_dpp v36, v36, v36 row_ror:2 row_mask:0xf bank_mask:0xf
  s_nop 1
  v_add_f32_dpp v36, v36, v36 row_ror:1 row_mask:0xf bank_mask:0xf
  s_nop 0
  v_readlane_b32 s12, v36, 0
  v_readlane_b32 s13, v36, 16
  v_readlane_b32 s14, v36, 32
  v_readlane_b32 s15, v36, 48
  v_mov_b32 v38, s12
  v_add_f32 v38, s13, v38
  v_add_f32 v38, s14, v38
  v_add_f32 v38, s15, v38
  v_mul_f32 v38, 0x3b000000, v38
  v_sub_f32 v28, v20, v38
  v_sub_f32 v29, v21, v38
  v_sub_f32 v30, v22, v38
  v_sub_f32 v31, v23, v38
  v_sub_f32 v32, v24, v38
  v_sub_f32 v33, v25, v38
  v_sub_f32 v34, v26, v38
  v_sub_f32 v35, v27, v38
  v_mul_f32 v36, v28, v28
  v_fmac_f32 v36, v29, v29
  v_fmac_f32 v36, v30, v30
  v_fmac_f32 v36, v31, v31
  v_fmac_f32 v36, v32, v32
  v_fmac_f32 v36, v33, v33
  v_fmac_f32 v36, v34, v34
  v_fmac_f32 v36, v35, v35
  s_nop 1
  v_add_f32_dpp v36, v36, v36 row_ror:8 row_mask:0xf bank_mask:0xf
  s_nop 1
  v_add_f32_dpp v36, v36, v36 row_ror:4 row_mask:0xf bank_mask:0xf
  s_nop 1
  v_add_f32_dpp v36, v36, v36 row_ror:2 row_mask:0xf bank_mask:0xf
  s_nop 1
  v_add_f32_dpp v36, v36, v36 row_ror:1 row_mask:0xf bank_mask:0xf
  s_nop 0
  v_readlane_b32 s12, v36, 0
  v_readlane_b32 s13, v36, 16
  v_readlane_b32 s14, v36, 32
  v_readlane_b32 s15, v36, 48
  v_mov_b32 v37, s12
  v_add_f32 v37, s13, v37
  v_add_f32 v37, s14, v37
  v_add_f32 v37, s15, v37
  v_mul_f32 v37, 0x3b000000, v37
  v_cvt_pk_bf16_f32 v41, v37, v37
  v_lshlrev_b32 v37, 16, v41
  v_add_f32 v37, 0x3727c5ac, v37
  v_cvt_pk_bf16_f32 v41, v37, v37
  v_lshlrev_b32 v37, 16, v41
  v_sqrt_f32 v40, v37
  s_nop 0
  v_cvt_pk_bf16_f32 v41, v40, v40
  v_lshlrev_b32 v40, 16, v41
  v_rcp_f32 v39, v40
  v_cvt_pk_bf16_f32 v41, v38, v38
  v_lshlrev_b32 v38, 16, v41
  v_sub_f32 v28, v20, v38
  v_sub_f32 v29, v21, v38
  v_sub_f32 v30, v22, v38
  v_sub_f32 v31, v23, v38
  v_sub_f32 v32, v24, v38
  v_sub_f32 v33, v25, v38
  v_sub_f32 v34, v26, v38
  v_sub_f32 v35, v27, v38
  v_cvt_pk_bf16_f32 v41, v28, v29
  v_lshlrev_b32 v28, 16, v41
  v_and_b32 v29, 0xffff0000, v41
  v_cvt_pk_bf16_f32 v41, v30, v31
  v_lshlrev_b32 v30, 16, v41
  v_and_b32 v31, 0xffff0000, v41
  v_cvt_pk_bf16_f32 v41, v32, v33
  v_lshlrev_b32 v32, 16, v41
  v_and_b32 v33, 0xffff0000, v41
  v_cvt_pk_bf16_f32 v41, v34, v35
  v_lshlrev_b32 v34, 16, v41
  v_and_b32 v35, 0xffff0000, v41
  v_mul_f32 v36, v28, v39
  v_fma_f32 v37, -v36, v40, v28
  v_fma_f32 v28, v37, v39, v36
  v_mul_f32 v36, v29, v39
  v_fma_f32 v37, -v36, v40, v29
  v_fma_f32 v29, v37, v39, v36
  v_mul_f32 v36, v30, v39
  v_fma_f32 v37, -v36, v40, v30
  v_fma_f32 v30, v37, v39, v36
  v_mul_f32 v36, v31, v39
  v_fma_f32 v37, -v36, v40, v31
  v_fma_f32 v31, v37, v39, v36
  v_mul_f32 v36, v32, v39
  v_fma_f32 v37, -v36, v40, v32
  v_fma_f32 v32, v37, v39, v36
  v_mul_f32 v36, v33, v39
  v_fma_f32 v37, -v36, v40, v33
  v_fma_f32 v33, v37, v39, v36
  v_mul_f32 v36, v34, v39
  v_fma_f32 v37, -v36, v40, v34
  v_fma_f32 v34, v37, v39, v36
  v_mul_f32 v36, v35, v39
  v_fma_f32 v37, -v36, v40, v35
  v_fma_f32 v35, v37, v39, v36
  v_cvt_pk_bf16_f32 v44, v28, v29
  v_lshlrev_b32 v28, 16, v44
  v_and_b32 v29, 0xffff0000, v44
  v_cvt_pk_bf16_f32 v45, v30, v31
  v_lshlrev_b32 v30, 16, v45
  v_and_b32 v31, 0xffff0000, v45
  v_cvt_pk_bf16_f32 v46, v32, v33
  v_lshlrev_b32 v32, 16, v46
  v_and_b32 v33, 0xffff0000, v46
  v_cvt_pk_bf16_f32 v47, v34, v35
  v_lshlrev_b32 v34, 16, v47
  v_and_b32 v35, 0xffff0000, v47
  s_and_saveexec_b64 s[10:11], s[32:33]
  ds_write_b128 v5, v[44:47] offset:0
  s_mov_b64 exec, s[10:11]
  s_waitcnt vmcnt(18)
  v_lshlrev_b32 v20, 16, v68
  v_and_b32 v21, 0xffff0000, v68
  v_lshlrev_b32 v22, 16, v69
  v_and_b32 v23, 0xffff0000, v69
  v_lshlrev_b32 v24, 16, v70
  v_and_b32 v25, 0xffff0000, v70
  v_lshlrev_b32 v26, 16, v71
  v_and_b32 v27, 0xffff0000, v71
  v_add_f32 v36, v20, v21
  v_add_f32 v36, v36, v22
  v_add_f32 v36, v36, v23
  v_add_f32 v36, v36, v24
  v_add_f32 v36, v36, v25
  v_add_f32 v36, v36, v26
  v_add_f32 v36, v36, v27
  s_nop 1
  v_add_f32_dpp v36, v36, v36 row_ror:8 row_mask:0xf bank_mask:0xf
  s_nop 1
  v_add_f32_dpp v36, v36, v36 row_ror:4 row_mask:0xf bank_mask:0xf
  s_nop 1
  v_add_f32_dpp v36, v36, v36 row_ror:2 row_mask:0xf bank_mask:0xf
  s_nop 1
  v_add_f32_dpp v36, v36, v36 row_ror:1 row_mask:0xf bank_mask:0xf
  s_nop 0
  v_readlane_b32 s12, v36, 0
  v_readlane_b32 s13, v36, 16
  v_readlane_b32 s14, v36, 32
  v_readlane_b32 s15, v36, 48
  v_mov_b32 v38, s12
  v_add_f32 v38, s13, v38
  v_add_f32 v38, s14, v38
  v_add_f32 v38, s15, v38
  v_mul_f32 v38, 0x3b000000, v38
  v_sub_f32 v28, v20, v38
  v_sub_f32 v29, v21, v38
  v_sub_f32 v30, v22, v38
  v_sub_f32 v31, v23, v38
  v_sub_f32 v32, v24, v38
  v_sub_f32 v33, v25, v38
  v_sub_f32 v34, v26, v38
  v_sub_f32 v35, v27, v38
  v_mul_f32 v36, v28, v28
  v_fmac_f32 v36, v29, v29
  v_fmac_f32 v36, v30, v30
  v_fmac_f32 v36, v31, v31
  v_fmac_f32 v36, v32, v32
  v_fmac_f32 v36, v33, v33
  v_fmac_f32 v36, v34, v34
  v_fmac_f32 v36, v35, v35
  s_nop 1
  v_add_f32_dpp v36, v36, v36 row_ror:8 row_mask:0xf bank_mask:0xf
  s_nop 1
  v_add_f32_dpp v36, v36, v36 row_ror:4 row_mask:0xf bank_mask:0xf
  s_nop 1
  v_add_f32_dpp v36, v36, v36 row_ror:2 row_mask:0xf bank_mask:0xf
  s_nop 1
  v_add_f32_dpp v36, v36, v36 row_ror:1 row_mask:0xf bank_mask:0xf
  s_nop 0
  v_readlane_b32 s12, v36, 0
  v_readlane_b32 s13, v36, 16
  v_readlane_b32 s14, v36, 32
  v_readlane_b32 s15, v36, 48
  v_mov_b32 v37, s12
  v_add_f32 v37, s13, v37
  v_add_f32 v37, s14, v37
  v_add_f32 v37, s15, v37
  v_mul_f32 v37, 0x3b000000, v37
  v_cvt_pk_bf16_f32 v41, v37, v37
  v_lshlrev_b32 v37, 16, v41
  v_add_f32 v37, 0x3727c5ac, v37
  v_cvt_pk_bf16_f32 v41, v37, v37
  v_lshlrev_b32 v37, 16, v41
  v_sqrt_f32 v40, v37
  s_nop 0
  v_cvt_pk_bf16_f32 v41, v40, v40
  v_lshlrev_b32 v40, 16, v41
  v_rcp_f32 v39, v40
  v_cvt_pk_bf16_f32 v41, v38, v38
  v_lshlrev_b32 v38, 16, v41
  v_sub_f32 v28, v20, v38
  v_sub_f32 v29, v21, v38
  v_sub_f32 v30, v22, v38
  v_sub_f32 v31, v23, v38
  v_sub_f32 v32, v24, v38
  v_sub_f32 v33, v25, v38
  v_sub_f32 v34, v26, v38
  v_sub_f32 v35, v27, v38
  v_cvt_pk_bf16_f32 v41, v28, v29
  v_lshlrev_b32 v28, 16, v41
  v_and_b32 v29, 0xffff0000, v41
  v_cvt_pk_bf16_f32 v41, v30, v31
  v_lshlrev_b32 v30, 16, v41
  v_and_b32 v31, 0xffff0000, v41
  v_cvt_pk_bf16_f32 v41, v32, v33
  v_lshlrev_b32 v32, 16, v41
  v_and_b32 v33, 0xffff0000, v41
  v_cvt_pk_bf16_f32 v41, v34, v35
  v_lshlrev_b32 v34, 16, v41
  v_and_b32 v35, 0xffff0000, v41
  v_mul_f32 v36, v28, v39
  v_fma_f32 v37, -v36, v40, v28
  v_fma_f32 v28, v37, v39, v36
  v_mul_f32 v36, v29, v39
  v_fma_f32 v37, -v36, v40, v29
  v_fma_f32 v29, v37, v39, v36
  v_mul_f32 v36, v30, v39
  v_fma_f32 v37, -v36, v40, v30
  v_fma_f32 v30, v37, v39, v36
  v_mul_f32 v36, v31, v39
  v_fma_f32 v37, -v36, v40, v31
  v_fma_f32 v31, v37, v39, v36
  v_mul_f32 v36, v32, v39
  v_fma_f32 v37, -v36, v40, v32
  v_fma_f32 v32, v37, v39, v36
  v_mul_f32 v36, v33, v39
  v_fma_f32 v37, -v36, v40, v33
  v_fma_f32 v33, v37, v39, v36
  v_mul_f32 v36, v34, v39
  v_fma_f32 v37, -v36, v40, v34
  v_fma_f32 v34, v37, v39, v36
  v_mul_f32 v36, v35, v39
  v_fma_f32 v37, -v36, v40, v35
  v_fma_f32 v35, v37, v39, v36
  v_cvt_pk_bf16_f32 v44, v28, v29
  v_lshlrev_b32 v28, 16, v44
  v_and_b32 v29, 0xffff0000, v44
  v_cvt_pk_bf16_f32 v45, v30, v31
  v_lshlrev_b32 v30, 16, v45
  v_and_b32 v31, 0xffff0000, v45
  v_cvt_pk_bf16_f32 v46, v32, v33
  v_lshlrev_b32 v32, 16, v46
  v_and_b32 v33, 0xffff0000, v46
  v_cvt_pk_bf16_f32 v47, v34, v35
  v_lshlrev_b32 v34, 16, v47
  v_and_b32 v35, 0xffff0000, v47
  s_and_saveexec_b64 s[10:11], s[32:33]
  ds_write_b128 v5, v[44:47] offset:128
  s_mov_b64 exec, s[10:11]
  s_waitcnt vmcnt(17)
  v_lshlrev_b32 v20, 16, v72
  v_and_b32 v21, 0xffff0000, v72
  v_lshlrev_b32 v22, 16, v73
  v_and_b32 v23, 0xffff0000, v73
  v_lshlrev_b32 v24, 16, v74
  v_and_b32 v25, 0xffff0000, v74
  v_lshlrev_b32 v26, 16, v75
  v_and_b32 v27, 0xffff0000, v75
  v_add_f32 v36, v20, v21
  v_add_f32 v36, v36, v22
  v_add_f32 v36, v36, v23
  v_add_f32 v36, v36, v24
  v_add_f32 v36, v36, v25
  v_add_f32 v36, v36, v26
  v_add_f32 v36, v36, v27
  s_nop 1
  v_add_f32_dpp v36, v36, v36 row_ror:8 row_mask:0xf bank_mask:0xf
  s_nop 1
  v_add_f32_dpp v36, v36, v36 row_ror:4 row_mask:0xf bank_mask:0xf
  s_nop 1
  v_add_f32_dpp v36, v36, v36 row_ror:2 row_mask:0xf bank_mask:0xf
  s_nop 1
  v_add_f32_dpp v36, v36, v36 row_ror:1 row_mask:0xf bank_mask:0xf
  s_nop 0
  v_readlane_b32 s12, v36, 0
  v_readlane_b32 s13, v36, 16
  v_readlane_b32 s14, v36, 32
  v_readlane_b32 s15, v36, 48
  v_mov_b32 v38, s12
  v_add_f32 v38, s13, v38
  v_add_f32 v38, s14, v38
  v_add_f32 v38, s15, v38
  v_mul_f32 v38, 0x3b000000, v38
  v_sub_f32 v28, v20, v38
  v_sub_f32 v29, v21, v38
  v_sub_f32 v30, v22, v38
  v_sub_f32 v31, v23, v38
  v_sub_f32 v32, v24, v38
  v_sub_f32 v33, v25, v38
  v_sub_f32 v34, v26, v38
  v_sub_f32 v35, v27, v38
  v_mul_f32 v36, v28, v28
  v_fmac_f32 v36, v29, v29
  v_fmac_f32 v36, v30, v30
  v_fmac_f32 v36, v31, v31
  v_fmac_f32 v36, v32, v32
  v_fmac_f32 v36, v33, v33
  v_fmac_f32 v36, v34, v34
  v_fmac_f32 v36, v35, v35
  s_nop 1
  v_add_f32_dpp v36, v36, v36 row_ror:8 row_mask:0xf bank_mask:0xf
  s_nop 1
  v_add_f32_dpp v36, v36, v36 row_ror:4 row_mask:0xf bank_mask:0xf
  s_nop 1
  v_add_f32_dpp v36, v36, v36 row_ror:2 row_mask:0xf bank_mask:0xf
  s_nop 1
  v_add_f32_dpp v36, v36, v36 row_ror:1 row_mask:0xf bank_mask:0xf
  s_nop 0
  v_readlane_b32 s12, v36, 0
  v_readlane_b32 s13, v36, 16
  v_readlane_b32 s14, v36, 32
  v_readlane_b32 s15, v36, 48
  v_mov_b32 v37, s12
  v_add_f32 v37, s13, v37
  v_add_f32 v37, s14, v37
  v_add_f32 v37, s15, v37
  v_mul_f32 v37, 0x3b000000, v37
  v_cvt_pk_bf16_f32 v41, v37, v37
  v_lshlrev_b32 v37, 16, v41
  v_add_f32 v37, 0x3727c5ac, v37
  v_cvt_pk_bf16_f32 v41, v37, v37
  v_lshlrev_b32 v37, 16, v41
  v_sqrt_f32 v40, v37
  s_nop 0
  v_cvt_pk_bf16_f32 v41, v40, v40
  v_lshlrev_b32 v40, 16, v41
  v_rcp_f32 v39, v40
  v_cvt_pk_bf16_f32 v41, v38, v38
  v_lshlrev_b32 v38, 16, v41
  v_sub_f32 v28, v20, v38
  v_sub_f32 v29, v21, v38
  v_sub_f32 v30, v22, v38
  v_sub_f32 v31, v23, v38
  v_sub_f32 v32, v24, v38
  v_sub_f32 v33, v25, v38
  v_sub_f32 v34, v26, v38
  v_sub_f32 v35, v27, v38
  v_cvt_pk_bf16_f32 v41, v28, v29
  v_lshlrev_b32 v28, 16, v41
  v_and_b32 v29, 0xffff0000, v41
  v_cvt_pk_bf16_f32 v41, v30, v31
  v_lshlrev_b32 v30, 16, v41
  v_and_b32 v31, 0xffff0000, v41
  v_cvt_pk_bf16_f32 v41, v32, v33
  v_lshlrev_b32 v32, 16, v41
  v_and_b32 v33, 0xffff0000, v41
  v_cvt_pk_bf16_f32 v41, v34, v35
  v_lshlrev_b32 v34, 16, v41
  v_and_b32 v35, 0xffff0000, v41
  v_mul_f32 v36, v28, v39
  v_fma_f32 v37, -v36, v40, v28
  v_fma_f32 v28, v37, v39, v36
  v_mul_f32 v36, v29, v39
  v_fma_f32 v37, -v36, v40, v29
  v_fma_f32 v29, v37, v39, v36
  v_mul_f32 v36, v30, v39
  v_fma_f32 v37, -v36, v40, v30
  v_fma_f32 v30, v37, v39, v36
  v_mul_f32 v36, v31, v39
  v_fma_f32 v37, -v36, v40, v31
  v_fma_f32 v31, v37, v39, v36
  v_mul_f32 v36, v32, v39
  v_fma_f32 v37, -v36, v40, v32
  v_fma_f32 v32, v37, v39, v36
  v_mul_f32 v36, v33, v39
  v_fma_f32 v37, -v36, v40, v33
  v_fma_f32 v33, v37, v39, v36
  v_mul_f32 v36, v34, v39
  v_fma_f32 v37, -v36, v40, v34
  v_fma_f32 v34, v37, v39, v36
  v_mul_f32 v36, v35, v39
  v_fma_f32 v37, -v36, v40, v35
  v_fma_f32 v35, v37, v39, v36
  v_cvt_pk_bf16_f32 v44, v28, v29
  v_lshlrev_b32 v28, 16, v44
  v_and_b32 v29, 0xffff0000, v44
  v_cvt_pk_bf16_f32 v45, v30, v31
  v_lshlrev_b32 v30, 16, v45
  v_and_b32 v31, 0xffff0000, v45
  v_cvt_pk_bf16_f32 v46, v32, v33
  v_lshlrev_b32 v32, 16, v46
  v_and_b32 v33, 0xffff0000, v46
  v_cvt_pk_bf16_f32 v47, v34, v35
  v_lshlrev_b32 v34, 16, v47
  v_and_b32 v35, 0xffff0000, v47
  s_and_saveexec_b64 s[10:11], s[32:33]
  ds_write_b128 v5, v[44:47] offset:256
  s_mov_b64 exec, s[10:11]
  s_waitcnt vmcnt(16)
  v_lshlrev_b32 v20, 16, v76
  v_and_b32 v21, 0xffff0000, v76
  v_lshlrev_b32 v22, 16, v77
  v_and_b32 v23, 0xffff0000, v77
  v_lshlrev_b32 v24, 16, v78
  v_and_b32 v25, 0xffff0000, v78
  v_lshlrev_b32 v26, 16, v79
  v_and_b32 v27, 0xffff0000, v79
  v_add_f32 v36, v20, v21
  v_add_f32 v36, v36, v22
  v_add_f32 v36, v36, v23
  v_add_f32 v36, v36, v24
  v_add_f32 v36, v36, v25
  v_add_f32 v36, v36, v26
  v_add_f32 v36, v36, v27
  s_nop 1
  v_add_f32_dpp v36, v36, v36 row_ror:8 row_mask:0xf bank_mask:0xf
  s_nop 1
  v_add_f32_dpp v36, v36, v36 row_ror:4 row_mask:0xf bank_mask:0xf
  s_nop 1
  v_add_f32_dpp v36, v36, v36 row_ror:2 row_mask:0xf bank_mask:0xf
  s_nop 1
  v_add_f32_dpp v36, v36, v36 row_ror:1 row_mask:0xf bank_mask:0xf
  s_nop 0
  v_readlane_b32 s12, v36, 0
  v_readlane_b32 s13, v36, 16
  v_readlane_b32 s14, v36, 32
  v_readlane_b32 s15, v36, 48
  v_mov_b32 v38, s12
  v_add_f32 v38, s13, v38
  v_add_f32 v38, s14, v38
  v_add_f32 v38, s15, v38
  v_mul_f32 v38, 0x3b000000, v38
  v_sub_f32 v28, v20, v38
  v_sub_f32 v29, v21, v38
  v_sub_f32 v30, v22, v38
  v_sub_f32 v31, v23, v38
  v_sub_f32 v32, v24, v38
  v_sub_f32 v33, v25, v38
  v_sub_f32 v34, v26, v38
  v_sub_f32 v35, v27, v38
  v_mul_f32 v36, v28, v28
  v_fmac_f32 v36, v29, v29
  v_fmac_f32 v36, v30, v30
  v_fmac_f32 v36, v31, v31
  v_fmac_f32 v36, v32, v32
  v_fmac_f32 v36, v33, v33
  v_fmac_f32 v36, v34, v34
  v_fmac_f32 v36, v35, v35
  s_nop 1
  v_add_f32_dpp v36, v36, v36 row_ror:8 row_mask:0xf bank_mask:0xf
  s_nop 1
  v_add_f32_dpp v36, v36, v36 row_ror:4 row_mask:0xf bank_mask:0xf
  s_nop 1
  v_add_f32_dpp v36, v36, v36 row_ror:2 row_mask:0xf bank_mask:0xf
  s_nop 1
  v_add_f32_dpp v36, v36, v36 row_ror:1 row_mask:0xf bank_mask:0xf
  s_nop 0
  v_readlane_b32 s12, v36, 0
  v_readlane_b32 s13, v36, 16
  v_readlane_b32 s14, v36, 32
  v_readlane_b32 s15, v36, 48
  v_mov_b32 v37, s12
  v_add_f32 v37, s13, v37
  v_add_f32 v37, s14, v37
  v_add_f32 v37, s15, v37
  v_mul_f32 v37, 0x3b000000, v37
  v_cvt_pk_bf16_f32 v41, v37, v37
  v_lshlrev_b32 v37, 16, v41
  v_add_f32 v37, 0x3727c5ac, v37
  v_cvt_pk_bf16_f32 v41, v37, v37
  v_lshlrev_b32 v37, 16, v41
  v_sqrt_f32 v40, v37
  s_nop 0
  v_cvt_pk_bf16_f32 v41, v40, v40
  v_lshlrev_b32 v40, 16, v41
  v_rcp_f32 v39, v40
  v_cvt_pk_bf16_f32 v41, v38, v38
  v_lshlrev_b32 v38, 16, v41
  v_sub_f32 v28, v20, v38
  v_sub_f32 v29, v21, v38
  v_sub_f32 v30, v22, v38
  v_sub_f32 v31, v23, v38
  v_sub_f32 v32, v24, v38
  v_sub_f32 v33, v25, v38
  v_sub_f32 v34, v26, v38
  v_sub_f32 v35, v27, v38
  v_cvt_pk_bf16_f32 v41, v28, v29
  v_lshlrev_b32 v28, 16, v41
  v_and_b32 v29, 0xffff0000, v41
  v_cvt_pk_bf16_f32 v41, v30, v31
  v_lshlrev_b32 v30, 16, v41
  v_and_b32 v31, 0xffff0000, v41
  v_cvt_pk_bf16_f32 v41, v32, v33
  v_lshlrev_b32 v32, 16, v41
  v_and_b32 v33, 0xffff0000, v41
  v_cvt_pk_bf16_f32 v41, v34, v35
  v_lshlrev_b32 v34, 16, v41
  v_and_b32 v35, 0xffff0000, v41
  v_mul_f32 v36, v28, v39
  v_fma_f32 v37, -v36, v40, v28
  v_fma_f32 v28, v37, v39, v36
  v_mul_f32 v36, v29, v39
  v_fma_f32 v37, -v36, v40, v29
  v_fma_f32 v29, v37, v39, v36
  v_mul_f32 v36, v30, v39
  v_fma_f32 v37, -v36, v40, v30
  v_fma_f32 v30, v37, v39, v36
  v_mul_f32 v36, v31, v39
  v_fma_f32 v37, -v36, v40, v31
  v_fma_f32 v31, v37, v39, v36
  v_mul_f32 v36, v32, v39
  v_fma_f32 v37, -v36, v40, v32
  v_fma_f32 v32, v37, v39, v36
  v_mul_f32 v36, v33, v39
  v_fma_f32 v37, -v36, v40, v33
  v_fma_f32 v33, v37, v39, v36
  v_mul_f32 v36, v34, v39
  v_fma_f32 v37, -v36, v40, v34
  v_fma_f32 v34, v37, v39, v36
  v_mul_f32 v36, v35, v39
  v_fma_f32 v37, -v36, v40, v35
  v_fma_f32 v35, v37, v39, v36
  v_cvt_pk_bf16_f32 v44, v28, v29
  v_lshlrev_b32 v28, 16, v44
  v_and_b32 v29, 0xffff0000, v44
  v_cvt_pk_bf16_f32 v45, v30, v31
  v_lshlrev_b32 v30, 16, v45
  v_and_b32 v31, 0xffff0000, v45
  v_cvt_pk_bf16_f32 v46, v32, v33
  v_lshlrev_b32 v32, 16, v46
  v_and_b32 v33, 0xffff0000, v46
  v_cvt_pk_bf16_f32 v47, v34, v35
  v_lshlrev_b32 v34, 16, v47
  v_and_b32 v35, 0xffff0000, v47
  s_and_saveexec_b64 s[10:11], s[32:33]
  ds_write_b128 v5, v[44:47] offset:384
  s_mov_b64 exec, s[10:11]
  v_lshlrev_b32 v7, 3, v2
  v_lshrrev_b32 v8, 2, v3
  v_add_u32 v7, v7, v8
  v_lshlrev_b32 v9, 8, v7
  v_and_b32 v8, 3, v1
  v_lshlrev_b32 v8, 3, v8
  v_add_u32 v9, v9, v8
  v_add_u32 v9, 132736, v9
  v_and_b32 v10, 3, v1
  v_lshlrev_b32 v10, 7, v10
  v_lshlrev_b32 v11, 4, v2
  v_add_u32 v10, v10, v11
  v_add_u32 v10, 115840, v10
  v_lshlrev_b32 v7, 9, v3
  v_add_u32 v7, v7, v11
  v_add_u32 v7, 98304, v7
  v_cmp_gt_u32 vcc, 4, v3
  s_waitcnt lgkmcnt(0)
  ds_read_b128 v[80:83], v10 offset:0
  ds_read_b128 v[84:87], v10 offset:64
  s_waitcnt vmcnt(0)
  ds_read_b64_tr_b16 v[12:13], v9 offset:0
  ds_read_b64_tr_b16 v[14:15], v9 offset:1024
  ds_read_b64_tr_b16 v[16:17], v9 offset:8192
  ds_read_b64_tr_b16 v[18:19], v9 offset:9216
  ds_read_b64_tr_b16 v[20:21], v9 offset:32
  ds_read_b64_tr_b16 v[22:23], v9 offset:1056
  ds_read_b64_tr_b16 v[24:25], v9 offset:8224
  ds_read_b64_tr_b16 v[26:27], v9 offset:9248
  ds_read_b64_tr_b16 v[28:29], v9 offset:64
  ds_read_b64_tr_b16 v[30:31], v9 offset:1088
  ds_read_b64_tr_b16 v[32:33], v9 offset:8256
  ds_read_b64_tr_b16 v[34:35], v9 offset:9280
  ds_read_b64_tr_b16 v[36:37], v9 offset:96
  ds_read_b64_tr_b16 v[38:39], v9 offset:1120
  ds_read_b64_tr_b16 v[40:41], v9 offset:8288
  ds_read_b64_tr_b16 v[42:43], v9 offset:9312
  s_waitcnt lgkmcnt(0)
  v_mfma_f32_16x16x32_bf16 v[64:67], v[12:15], v[80:83], 0
  v_mfma_f32_16x16x32_bf16 v[64:67], v[16:19], v[84:87], v[64:67]
  v_mfma_f32_16x16x32_bf16 v[68:71], v[20:23], v[80:83], 0
  v_mfma_f32_16x16x32_bf16 v[68:71], v[24:27], v[84:87], v[68:71]
  v_mfma_f32_16x16x32_bf16 v[72:75], v[28:31], v[80:83], 0
  v_mfma_f32_16x16x32_bf16 v[72:75], v[32:35], v[84:87], v[72:75]
  v_mfma_f32_16x16x32_bf16 v[76:79], v[36:39], v[80:83], 0
  v_mfma_f32_16x16x32_bf16 v[76:79], v[40:43], v[84:87], v[76:79]
  s_and_saveexec_b64 s[10:11], vcc
  s_nop 0
  ds_write_b128 v7, v[64:67] offset:0
  s_nop 0
  ds_write_b128 v7, v[68:71] offset:64
  s_nop 0
  ds_write_b128 v7, v[72:75] offset:128
  s_nop 0
  ds_write_b128 v7, v[76:79] offset:192
  s_mov_b64 exec, s[10:11]
  ds_read_b64_tr_b16 v[12:13], v9 offset:128
  ds_read_b64_tr_b16 v[14:15], v9 offset:1152
  ds_read_b64_tr_b16 v[16:17], v9 offset:8320
  ds_read_b64_tr_b16 v[18:19], v9 offset:9344
  ds_read_b64_tr_b16 v[20:21], v9 offset:160
  ds_read_b64_tr_b16 v[22:23], v9 offset:1184
  ds_read_b64_tr_b16 v[24:25], v9 offset:8352
  ds_read_b64_tr_b16 v[26:27], v9 offset:9376
  ds_read_b64_tr_b16 v[28:29], v9 offset:192
  ds_read_b64_tr_b16 v[30:31], v9 offset:1216
  ds_read_b64_tr_b16 v[32:33], v9 offset:8384
  ds_read_b64_tr_b16 v[34:35], v9 offset:9408
  ds_read_b64_tr_b16 v[36:37], v9 offset:224
  ds_read_b64_tr_b16 v[38:39], v9 offset:1248
  ds_read_b64_tr_b16 v[40:41], v9 offset:8416
  ds_read_b64_tr_b16 v[42:43], v9 offset:9440
  s_waitcnt lgkmcnt(0)
  v_mfma_f32_16x16x32_bf16 v[64:67], v[12:15], v[80:83], 0
  v_mfma_f32_16x16x32_bf16 v[64:67], v[16:19], v[84:87], v[64:67]
  v_mfma_f32_16x16x32_bf16 v[68:71], v[20:23], v[80:83], 0
  v_mfma_f32_16x16x32_bf16 v[68:71], v[24:27], v[84:87], v[68:71]
  v_mfma_f32_16x16x32_bf16 v[72:75], v[28:31], v[80:83], 0
  v_mfma_f32_16x16x32_bf16 v[72:75], v[32:35], v[84:87], v[72:75]
  v_mfma_f32_16x16x32_bf16 v[76:79], v[36:39], v[80:83], 0
  v_mfma_f32_16x16x32_bf16 v[76:79], v[40:43], v[84:87], v[76:79]
  s_and_saveexec_b64 s[10:11], vcc
  s_nop 0
  ds_write_b128 v7, v[64:67] offset:256
  s_nop 0
  ds_write_b128 v7, v[68:71] offset:320
  s_nop 0
  ds_write_b128 v7, v[72:75] offset:384
  s_nop 0
  ds_write_b128 v7, v[76:79] offset:448
  s_mov_b64 exec, s[10:11]
  s_waitcnt lgkmcnt(0)
  s_mov_b32 s14, 0
  v_mov_b32 v7, 0
L_nonce:
  s_waitcnt vmcnt(0)
  v_readfirstlane_b32 s98, v58
  v_readfirstlane_b32 s99, v59
  s_cmp_lg_u32 s98, 0
  s_cbranch_scc1 L_nonce_done
  s_sleep 1
  buffer_load_dwordx2 v[58:59], v7, s[76:79], 0 offen sc1
  s_add_u32 s14, s14, 1
  s_cmp_lt_u32 s14, 400000
  s_cbranch_scc1 L_nonce
L_nonce_done:
  v_lshlrev_b32 v7, 3, v1
  v_add_u32 v8, 98304, v7
  ds_read_b64 v[12:13], v8 offset:0
  v_mov_b32 v14, s98
  v_mov_b32 v15, s99
  ds_read_b64 v[16:17], v8 offset:512
  v_mov_b32 v18, s98
  v_mov_b32 v19, s99
  ds_read_b64 v[20:21], v8 offset:1024
  v_mov_b32 v22, s98
  v_mov_b32 v23, s99
  ds_read_b64 v[24:25], v8 offset:1536
  v_mov_b32 v26, s98
  v_mov_b32 v27, s99
  s_lshl_b32 s9, s2, 12
  s_add_u32 s9, s9, 0x40000
  v_add_u32 v7, s9, v6
  s_waitcnt lgkmcnt(0)
  buffer_store_dwordx4 v[12:15], v7, s[80:83], 0 offen offset:0 sc1
  buffer_store_dwordx4 v[16:19], v7, s[80:83], 0 offen offset:1024 sc1
  buffer_store_dwordx4 v[20:23], v7, s[80:83], 0 offen offset:2048 sc1
  buffer_store_dwordx4 v[24:27], v7, s[80:83], 0 offen offset:3072 sc1
  s_lshl_b32 s9, s2, 3
  s_add_u32 s9, s9, 0x154000
  v_mov_b32 v8, s9
  s_mov_b64 s[10:11], exec
  s_mov_b64 exec, 1
  buffer_store_dwordx2 v[14:15], v8, s[80:83], 0 offen sc1
  s_mov_b64 exec, s[10:11]
  v_mov_b32 v8, 114760
  ds_write_b64 v8, v[14:15]
  buffer_load_dwordx4 v[128:131], v4, s[40:43], s84 offen offset:0 nt
  buffer_load_dwordx4 v[132:135], v4, s[40:43], s84 offen offset:1024 nt
  buffer_load_dwordx4 v[136:139], v4, s[40:43], s84 offen offset:2048 nt
  buffer_load_dwordx4 v[140:143], v4, s[40:43], s84 offen offset:3072 nt
  buffer_load_dwordx4 v[144:147], v4, s[40:43], s85 offen offset:0 nt
  buffer_load_dwordx4 v[148:151], v4, s[40:43], s85 offen offset:1024 nt
  buffer_load_dwordx4 v[152:155], v4, s[40:43], s85 offen offset:2048 nt
  buffer_load_dwordx4 v[156:159], v4, s[40:43], s85 offen offset:3072 nt
  buffer_load_dwordx4 v[160:163], v4, s[40:43], s86 offen offset:0 nt
  buffer_load_dwordx4 v[164:167], v4, s[40:43], s86 offen offset:1024 nt
  buffer_load_dwordx4 v[168:171], v4, s[40:43], s86 offen offset:2048 nt
  buffer_load_dwordx4 v[172:175], v4, s[40:43], s86 offen offset:3072 nt
  buffer_load_dwordx4 v[176:179], v4, s[40:43], s87 offen offset:0 nt
  buffer_load_dwordx4 v[180:183], v4, s[40:43], s87 offen offset:1024 nt
  buffer_load_dwordx4 v[184:187], v4, s[40:43], s87 offen offset:2048 nt
  buffer_load_dwordx4 v[188:191], v4, s[40:43], s87 offen offset:3072 nt
  buffer_load_dwordx4 v[192:195], v4, s[40:43], s88 offen offset:0 nt
  buffer_load_dwordx4 v[196:199], v4, s[40:43], s88 offen offset:1024 nt
  buffer_load_dwordx4 v[200:203], v4, s[40:43], s88 offen offset:2048 nt
  buffer_load_dwordx4 v[204:207], v4, s[40:43], s88 offen offset:3072 nt
  buffer_load_dwordx4 v[208:211], v4, s[40:43], s89 offen offset:0 nt
  buffer_load_dwordx4 v[212:215], v4, s[40:43], s89 offen offset:1024 nt
  buffer_load_dwordx4 v[216:219], v4, s[40:43], s89 offen offset:2048 nt
  buffer_load_dwordx4 v[220:223], v4, s[40:43], s89 offen offset:3072 nt
  buffer_load_dwordx4 v[224:227], v4, s[40:43], s90 offen offset:0 nt
  buffer_load_dwordx4 v[228:231], v4, s[40:43], s90 offen offset:1024 nt
  buffer_load_dwordx4 v[232:235], v4, s[40:43], s90 offen offset:2048 nt
  buffer_load_dwordx4 v[236:239], v4, s[40:43], s90 offen offset:3072 nt
  buffer_load_dwordx4 v[240:243], v4, s[40:43], s91 offen offset:0 nt
  buffer_load_dwordx4 v[244:247], v4, s[40:43], s91 offen offset:1024 nt
  buffer_load_dwordx4 v[248:251], v4, s[40:43], s91 offen offset:2048 nt
  buffer_load_dwordx4 v[252:255], v4, s[40:43], s91 offen offset:3072 nt
  s_and_b32 s9, s2, 31
  s_lshl_b32 s9, s9, 12
  s_lshl_b32 s10, s5, 10
  s_add_u32 s9, s9, s10
  s_add_u32 s9, s9, 0x40000
  v_add_u32 v7, s9, v6
  s_mov_b32 s16, 0
  s_mov_b32 s17, 131072
  s_mov_b32 s18, 262144
  s_mov_b32 s19, 393216
  s_mov_b32 s20, 524288
  s_mov_b32 s21, 655360
  s_mov_b32 s22, 786432
  s_mov_b32 s23, 917504
  s_mov_b32 s14, 0
L_pollq:
  buffer_load_dwordx4 v[12:15], v7, s[80:83], s16 offen sc1
  buffer_load_dwordx4 v[16:19], v7, s[80:83], s17 offen sc1
  buffer_load_dwordx4 v[20:23], v7, s[80:83], s18 offen sc1
  buffer_load_dwordx4 v[24:27], v7, s[80:83], s19 offen sc1
  buffer_load_dwordx4 v[28:31], v7, s[80:83], s20 offen sc1
  buffer_load_dwordx4 v[32:35], v7, s[80:83], s21 offen sc1
  buffer_load_dwordx4 v[36:39], v7, s[80:83], s22 offen sc1
  buffer_load_dwordx4 v[40:43], v7, s[80:83], s23 offen sc1
  s_waitcnt vmcnt(0)
  v_cmp_eq_u32 vcc, s98, v14
  v_cmp_eq_u32 s[10:11], s99, v15
  s_and_b64 vcc, vcc, s[10:11]
  v_cmp_eq_u32 s[10:11], s98, v18
  s_and_b64 vcc, vcc, s[10:11]
  v_cmp_eq_u32 s[10:11], s99, v19
  s_and_b64 vcc, vcc, s[10:11]
  v_cmp_eq_u32 s[10:11], s98, v22
  s_and_b64 vcc, vcc, s[10:11]
  v_cmp_eq_u32 s[10:11], s99, v23
  s_and_b64 vcc, vcc, s[10:11]
  v_cmp_eq_u32 s[10:11], s98, v26
  s_and_b64 vcc, vcc, s[10:11]
  v_cmp_eq_u32 s[10:11], s99, v27
  s_and_b64 vcc, vcc, s[10:11]
  v_cmp_eq_u32 s[10:11], s98, v30
  s_and_b64 vcc, vcc, s[10:11]
  v_cmp_eq_u32 s[10:11], s99, v31
  s_and_b64 vcc, vcc, s[10:11]
  v_cmp_eq_u32 s[10:11], s98, v34
  s_and_b64 vcc, vcc, s[10:11]
  v_cmp_eq_u32 s[10:11], s99, v35
  s_and_b64 vcc, vcc, s[10:11]
  v_cmp_eq_u32 s[10:11], s98, v38
  s_and_b64 vcc, vcc, s[10:11]
  v_cmp_eq_u32 s[10:11], s99, v39
  s_and_b64 vcc, vcc, s[10:11]
  v_cmp_eq_u32 s[10:11], s98, v42
  s_and_b64 vcc, vcc, s[10:11]
  v_cmp_eq_u32 s[10:11], s99, v43
  s_and_b64 vcc, vcc, s[10:11]
  s_cmp_eq_u64 vcc, exec
  s_cbranch_scc1 L_pollq_done
  s_sleep 1
  s_add_u32 s14, s14, 1
  s_cmp_lt_u32 s14, 400000
  s_cbranch_scc1 L_pollq
L_pollq_done:
  v_add_f32 v12, v12, v28
  v_add_f32 v13, v13, v29
  v_add_f32 v16, v16, v32
  v_add_f32 v17, v17, v33
  v_add_f32 v20, v20, v36
  v_add_f32 v21, v21, v37
  v_add_f32 v24, v24, v40
  v_add_f32 v25, v25, v41
  v_add_f32 v12, v12, v20
  v_add_f32 v13, v13, v21
  v_add_f32 v16, v16, v24
  v_add_f32 v17, v17, v25
  v_add_f32 v12, v12, v16
  v_add_f32 v13, v13, v17
  v_cvt_pk_bf16_f32 v12, v12, v13
  v_lshlrev_b32 v7, 2, v1
  v_add_u32 v7, 117888, v7
  ds_write_b32 v7, v12
  s_waitcnt lgkmcnt(0)
  s_barrier
  s_branch L_comm_k
L_qready:
  v_mov_b32 v8, 114760
  ds_read_b64 v[8:9], v8
  v_lshlrev_b32 v7, 4, v3
  v_add_u32 v7, 117888, v7
  ds_read_b128 v[56:59], v7
  s_waitcnt lgkmcnt(0)
  v_readfirstlane_b32 s98, v8
  v_readfirstlane_b32 s99, v9
  s_waitcnt vmcnt(23)
  v_dot2_f32_bf16 v20, v128, v56, 0
  v_dot2_f32_bf16 v20, v129, v57, v20
  v_dot2_f32_bf16 v20, v130, v58, v20
  v_dot2_f32_bf16 v20, v131, v59, v20
  s_waitcnt vmcnt(22)
  v_dot2_f32_bf16 v21, v132, v56, 0
  v_dot2_f32_bf16 v21, v133, v57, v21
  v_dot2_f32_bf16 v21, v134, v58, v21
  v_dot2_f32_bf16 v21, v135, v59, v21
  s_waitcnt vmcnt(21)
  v_dot2_f32_bf16 v22, v136, v56, 0
  v_dot2_f32_bf16 v22, v137, v57, v22
  v_dot2_f32_bf16 v22, v138, v58, v22
  v_dot2_f32_bf16 v22, v139, v59, v22
  s_waitcnt vmcnt(20)
  v_dot2_f32_bf16 v23, v140, v56, 0
  v_dot2_f32_bf16 v23, v141, v57, v23
  v_dot2_f32_bf16 v23, v142, v58, v23
  v_dot2_f32_bf16 v23, v143, v59, v23
  v_add_f32_dpp v24, v20, v20 row_ror:8 row_mask:0xf bank_mask:0x3
  v_add_f32_dpp v25, v22, v22 row_ror:8 row_mask:0xf bank_mask:0x3
  v_add_f32_dpp v24, v21, v21 row_ror:8 row_mask:0xf bank_mask:0xc
  v_add_f32_dpp v25, v23, v23 row_ror:8 row_mask:0xf bank_mask:0xc
  s_nop 0
  v_add_f32_dpp v96, v24, v24 row_half_mirror row_mask:0xf bank_mask:0x5
  v_add_f32_dpp v96, v25, v25 row_half_mirror row_mask:0xf bank_mask:0xa
  s_nop 1
  v_add_f32_dpp v96, v96, v96 quad_perm:[1,0,3,2] row_mask:0xf bank_mask:0xf
  s_nop 1
  v_add_f32_dpp v96, v96, v96 quad_perm:[2,3,0,1] row_mask:0xf bank_mask:0xf
  s_waitcnt vmcnt(19)
  v_dot2_f32_bf16 v20, v144, v56, 0
  v_dot2_f32_bf16 v20, v145, v57, v20
  v_dot2_f32_bf16 v20, v146, v58, v20
  v_dot2_f32_bf16 v20, v147, v59, v20
  s_waitcnt vmcnt(18)
  v_dot2_f32_bf16 v21, v148, v56, 0
  v_dot2_f32_bf16 v21, v149, v57, v21
  v_dot2_f32_bf16 v21, v150, v58, v21
  v_dot2_f32_bf16 v21, v151, v59, v21
  s_waitcnt vmcnt(17)
  v_dot2_f32_bf16 v22, v152, v56, 0
  v_dot2_f32_bf16 v22, v153, v57, v22
  v_dot2_f32_bf16 v22, v154, v58, v22
  v_dot2_f32_bf16 v22, v155, v59, v22
  s_waitcnt vmcnt(16)
  v_dot2_f32_bf16 v23, v156, v56, 0
  v_dot2_f32_bf16 v23, v157, v57, v23
  v_dot2_f32_bf16 v23, v158, v58, v23
  v_dot2_f32_bf16 v23, v159, v59, v23
  v_add_f32_dpp v24, v20, v20 row_ror:8 row_mask:0xf bank_mask:0x3
  v_add_f32_dpp v25, v22, v22 row_ror:8 row_mask:0xf bank_mask:0x3
  v_add_f32_dpp v24, v21, v21 row_ror:8 row_mask:0xf bank_mask:0xc
  v_add_f32_dpp v25, v23, v23 row_ror:8 row_mask:0xf bank_mask:0xc
  s_nop 0
  v_add_f32_dpp v97, v24, v24 row_half_mirror row_mask:0xf bank_mask:0x5
  v_add_f32_dpp v97, v25, v25 row_half_mirror row_mask:0xf bank_mask:0xa
  s_nop 1
  v_add_f32_dpp v97, v97, v97 quad_perm:[1,0,3,2] row_mask:0xf bank_mask:0xf
  s_nop 1
  v_add_f32_dpp v97, v97, v97 quad_perm:[2,3,0,1] row_mask:0xf bank_mask:0xf
  v_cvt_pk_bf16_f32 v26, v96, v97
  v_lshlrev_b32 v96, 16, v26
  v_and_b32 v97, 0xffff0000, v26
  v_mul_f32 v96, 0x3db504f3, v96
  v_mul_f32 v97, 0x3db504f3, v97
  v_cvt_pk_bf16_f32 v26, v96, v97
  v_lshlrev_b32 v96, 16, v26
  v_and_b32 v97, 0xffff0000, v26
  s_waitcnt vmcnt(15)
  v_dot2_f32_bf16 v20, v160, v56, 0
  v_dot2_f32_bf16 v20, v161, v57, v20
  v_dot2_f32_bf16 v20, v162, v58, v20
  v_dot2_f32_bf16 v20, v163, v59, v20
  s_waitcnt vmcnt(14)
  v_dot2_f32_bf16 v21, v164, v56, 0
  v_dot2_f32_bf16 v21, v165, v57, v21
  v_dot2_f32_bf16 v21, v166, v58, v21
  v_dot2_f32_bf16 v21, v167, v59, v21
  s_waitcnt vmcnt(13)
  v_dot2_f32_bf16 v22, v168, v56, 0
  v_dot2_f32_bf16 v22, v169, v57, v22
  v_dot2_f32_bf16 v22, v170, v58, v22
  v_dot2_f32_bf16 v22, v171, v59, v22
  s_waitcnt vmcnt(12)
  v_dot2_f32_bf16 v23, v172, v56, 0
  v_dot2_f32_bf16 v23, v173, v57, v23
  v_dot2_f32_bf16 v23, v174, v58, v23
  v_dot2_f32_bf16 v23, v175, v59, v23
  v_add_f32_dpp v24, v20, v20 row_ror:8 row_mask:0xf bank_mask:0x3
  v_add_f32_dpp v25, v22, v22 row_ror:8 row_mask:0xf bank_mask:0x3
  v_add_f32_dpp v24, v21, v21 row_ror:8 row_mask:0xf bank_mask:0xc
  v_add_f32_dpp v25, v23, v23 row_ror:8 row_mask:0xf bank_mask:0xc
  s_nop 0
  v_add_f32_dpp v98, v24, v24 row_half_mirror row_mask:0xf bank_mask:0x5
  v_add_f32_dpp v98, v25, v25 row_half_mirror row_mask:0xf bank_mask:0xa
  s_nop 1
  v_add_f32_dpp v98, v98, v98 quad_perm:[1,0,3,2] row_mask:0xf bank_mask:0xf
  s_nop 1
  v_add_f32_dpp v98, v98, v98 quad_perm:[2,3,0,1] row_mask:0xf bank_mask:0xf
  s_waitcnt vmcnt(11)
  v_dot2_f32_bf16 v20, v176, v56, 0
  v_dot2_f32_bf16 v20, v177, v57, v20
  v_dot2_f32_bf16 v20, v178, v58, v20
  v_dot2_f32_bf16 v20, v179, v59, v20
  s_waitcnt vmcnt(10)
  v_dot2_f32_bf16 v21, v180, v56, 0
  v_dot2_f32_bf16 v21, v181, v57, v21
  v_dot2_f32_bf16 v21, v182, v58, v21
  v_dot2_f32_bf16 v21, v183, v59, v21
  s_waitcnt vmcnt(9)
  v_dot2_f32_bf16 v22, v184, v56, 0
  v_dot2_f32_bf16 v22, v185, v57, v22
  v_dot2_f32_bf16 v22, v186, v58, v22
  v_dot2_f32_bf16 v22, v187, v59, v22
  buffer_load_dwordx4 v[224:227], v4, s[40:43], s90 offen offset:0 nt
  s_waitcnt vmcnt(9)
  v_dot2_f32_bf16 v23, v188, v56, 0
  v_dot2_f32_bf16 v23, v189, v57, v23
  v_dot2_f32_bf16 v23, v190, v58, v23
  v_dot2_f32_bf16 v23, v191, v59, v23
  buffer_load_dwordx4 v[228:231], v4, s[40:43], s90 offen offset:1024 nt
  v_add_f32_dpp v24, v20, v20 row_ror:8 row_mask:0xf bank_mask:0x3
  v_add_f32_dpp v25, v22, v22 row_ror:8 row_mask:0xf bank_mask:0x3
  v_add_f32_dpp v24, v21, v21 row_ror:8 row_mask:0xf bank_mask:0xc
  v_add_f32_dpp v25, v23, v23 row_ror:8 row_mask:0xf bank_mask:0xc
  s_nop 0
  v_add_f32_dpp v99, v24, v24 row_half_mirror row_mask:0xf bank_mask:0x5
  v_add_f32_dpp v99, v25, v25 row_half_mirror row_mask:0xf bank_mask:0xa
  s_nop 1
  v_add_f32_dpp v99, v99, v99 quad_perm:[1,0,3,2] row_mask:0xf bank_mask:0xf
  s_nop 1
  v_add_f32_dpp v99, v99, v99 quad_perm:[2,3,0,1] row_mask:0xf bank_mask:0xf
  v_cvt_pk_bf16_f32 v26, v98, v99
  v_lshlrev_b32 v98, 16, v26
  v_and_b32 v99, 0xffff0000, v26
  v_mul_f32 v98, 0x3db504f3, v98
  v_mul_f32 v99, 0x3db504f3, v99
  v_cvt_pk_bf16_f32 v26, v98, v99
  v_lshlrev_b32 v98, 16, v26
  v_and_b32 v99, 0xffff0000, v26
  s_waitcnt vmcnt(9)
  v_dot2_f32_bf16 v20, v192, v56, 0
  v_dot2_f32_bf16 v20, v193, v57, v20
  v_dot2_f32_bf16 v20, v194, v58, v20
  v_dot2_f32_bf16 v20, v195, v59, v20
  buffer_load_dwordx4 v[232:235], v4, s[40:43], s90 offen offset:2048 nt
  s_waitcnt vmcnt(9)
  v_dot2_f32_bf16 v21, v196, v56, 0
  v_dot2_f32_bf16 v21, v197, v57, v21
  v_dot2_f32_bf16 v21, v198, v58, v21
  v_dot2_f32_bf16 v21, v199, v59, v21
  buffer_load_dwordx4 v[236:239], v4, s[40:43], s90 offen offset:3072 nt
  s_waitcnt vmcnt(9)
  v_dot2_f32_bf16 v22, v200, v56, 0
  v_dot2_f32_bf16 v22, v201, v57, v22
  v_dot2_f32_bf16 v22, v202, v58, v22
  v_dot2_f32_bf16 v22, v203, v59, v22
  buffer_load_dwordx4 v[240:243], v4, s[40:43], s91 offen offset:0 nt
  s_waitcnt vmcnt(9)
  v_dot2_f32_bf16 v23, v204, v56, 0
  v_dot2_f32_bf16 v23, v205, v57, v23
  v_dot2_f32_bf16 v23, v206, v58, v23
  v_dot2_f32_bf16 v23, v207, v59, v23
  buffer_load_dwordx4 v[244:247], v4, s[40:43], s91 offen offset:1024 nt
  v_add_f32_dpp v24, v20, v20 row_ror:8 row_mask:0xf bank_mask:0x3
  v_add_f32_dpp v25, v22, v22 row_ror:8 row_mask:0xf bank_mask:0x3
  v_add_f32_dpp v24, v21, v21 row_ror:8 row_mask:0xf bank_mask:0xc
  v_add_f32_dpp v25, v23, v23 row_ror:8 row_mask:0xf bank_mask:0xc
  s_nop 0
  v_add_f32_dpp v100, v24, v24 row_half_mirror row_mask:0xf bank_mask:0x5
  v_add_f32_dpp v100, v25, v25 row_half_mirror row_mask:0xf bank_mask:0xa
  s_nop 1
  v_add_f32_dpp v100, v100, v100 quad_perm:[1,0,3,2] row_mask:0xf bank_mask:0xf
  s_nop 1
  v_add_f32_dpp v100, v100, v100 quad_perm:[2,3,0,1] row_mask:0xf bank_mask:0xf
  v_lshlrev_b32 v7, 5, v1
  v_add_u32 v7, 0x154000, v7
  buffer_load_dwordx4 v[88:91], v7, s[80:83], 0 offen sc1
  buffer_load_dwordx4 v[92:95], v7, s[80:83], 0 offen offset:16 sc1
  s_lshl_b32 s9, s4, 7
  s_lshl_b32 s10, s3, 4
  s_add_u32 s9, s9, s10
  s_lshl_b32 s9, s9, 10
  s_lshl_b32 s10, s8, 7
  s_add_u32 s9, s9, s10
  v_lshrrev_b32 v7, 3, v1
  v_lshlrev_b32 v7, 10, v7
  v_and_b32 v8, 7, v1
  v_lshlrev_b32 v8, 4, v8
  v_add_u32 v7, v7, v8
  v_add_u32 v7, s9, v7
  s_lshl_b32 s11, s3, 11
  s_add_u32 m0, s11, 132736
  s_nop 0
  buffer_load_dwordx4 v7, s[52:55], 0 offen nt lds
  v_add_u32 v7, 0x2000, v7
  s_add_u32 m0, s11, 133760
  s_nop 0
  buffer_load_dwordx4 v7, s[52:55], 0 offen nt lds
  s_and_b32 s9, s3, 3
  s_lshl_b32 s9, s9, 10
  v_add_u32 v7, s9, v6
  buffer_load_dwordx4 v[60:63], v7, s[56:59], 0 offen
  s_waitcnt vmcnt(14)
  v_dot2_f32_bf16 v20, v208, v56, 0
  v_dot2_f32_bf16 v20, v209, v57, v20
  v_dot2_f32_bf16 v20, v210, v58, v20
  v_dot2_f32_bf16 v20, v211, v59, v20
  buffer_load_dwordx4 v[248:251], v4, s[40:43], s91 offen offset:2048 nt
  s_waitcnt vmcnt(14)
  v_dot2_f32_bf16 v21, v212, v56, 0
  v_dot2_f32_bf16 v21, v213, v57, v21
  v_dot2_f32_bf16 v21, v214, v58, v21
  v_dot2_f32_bf16 v21, v215, v59, v21
  buffer_load_dwordx4 v[252:255], v4, s[40:43], s91 offen offset:3072 nt
  s_waitcnt vmcnt(14)
  v_dot2_f32_bf16 v22, v216, v56, 0
  v_dot2_f32_bf16 v22, v217, v57, v22
  v_dot2_f32_bf16 v22, v218, v58, v22
  v_dot2_f32_bf16 v22, v219, v59, v22
  s_waitcnt vmcnt(13)
  v_dot2_f32_bf16 v23, v220, v56, 0
  v_dot2_f32_bf16 v23, v221, v57, v23
  v_dot2_f32_bf16 v23, v222, v58, v23
  v_dot2_f32_bf16 v23, v223, v59, v23
  v_add_f32_dpp v24, v20, v20 row_ror:8 row_mask:0xf bank_mask:0x3
  v_add_f32_dpp v25, v22, v22 row_ror:8 row_mask:0xf bank_mask:0x3
  v_add_f32_dpp v24, v21, v21 row_ror:8 row_mask:0xf bank_mask:0xc
  v_add_f32_dpp v25, v23, v23 row_ror:8 row_mask:0xf bank_mask:0xc
  s_nop 0
  v_add_f32_dpp v101, v24, v24 row_half_mirror row_mask:0xf bank_mask:0x5
  v_add_f32_dpp v101, v25, v25 row_half_mirror row_mask:0xf bank_mask:0xa
  s_nop 1
  v_add_f32_dpp v101, v101, v101 quad_perm:[1,0,3,2] row_mask:0xf bank_mask:0xf
  s_nop 1
  v_add_f32_dpp v101, v101, v101 quad_perm:[2,3,0,1] row_mask:0xf bank_mask:0xf
  v_cvt_pk_bf16_f32 v26, v100, v101
  v_lshlrev_b32 v100, 16, v26
  v_and_b32 v101, 0xffff0000, v26
  v_mul_f32 v100, 0x3db504f3, v100
  v_mul_f32 v101, 0x3db504f3, v101
  v_cvt_pk_bf16_f32 v26, v100, v101
  v_lshlrev_b32 v100, 16, v26
  v_and_b32 v101, 0xffff0000, v26
  s_waitcnt vmcnt(12)
  v_dot2_f32_bf16 v20, v224, v56, 0
  v_dot2_f32_bf16 v20, v225, v57, v20
  v_dot2_f32_bf16 v20, v226, v58, v20
  v_dot2_f32_bf16 v20, v227, v59, v20
  s_waitcnt vmcnt(11)
  v_dot2_f32_bf16 v21, v228, v56, 0
  v_dot2_f32_bf16 v21, v229, v57, v21
  v_dot2_f32_bf16 v21, v230, v58, v21
  v_dot2_f32_bf16 v21, v231, v59, v21
  s_waitcnt vmcnt(10)
  v_dot2_f32_bf16 v22, v232, v56, 0
  v_dot2_f32_bf16 v22, v233, v57, v22
  v_dot2_f32_bf16 v22, v234, v58, v22
  v_dot2_f32_bf16 v22, v235, v59, v22
  s_waitcnt vmcnt(9)
  v_dot2_f32_bf16 v23, v236, v56, 0
  v_dot2_f32_bf16 v23, v237, v57, v23
  v_dot2_f32_bf16 v23, v238, v58, v23
  v_dot2_f32_bf16 v23, v239, v59, v23
  v_add_f32_dpp v24, v20, v20 row_ror:8 row_mask:0xf bank_mask:0x3
  v_add_f32_dpp v25, v22, v22 row_ror:8 row_mask:0xf bank_mask:0x3
  v_add_f32_dpp v24, v21, v21 row_ror:8 row_mask:0xf bank_mask:0xc
  v_add_f32_dpp v25, v23, v23 row_ror:8 row_mask:0xf bank_mask:0xc
  s_nop 0
  v_add_f32_dpp v102, v24, v24 row_half_mirror row_mask:0xf bank_mask:0x5
  v_add_f32_dpp v102, v25, v25 row_half_mirror row_mask:0xf bank_mask:0xa
  s_nop 1
  v_add_f32_dpp v102, v102, v102 quad_perm:[1,0,3,2] row_mask:0xf bank_mask:0xf
  s_nop 1
  v_add_f32_dpp v102, v102, v102 quad_perm:[2,3,0,1] row_mask:0xf bank_mask:0xf
  s_waitcnt vmcnt(8)
  v_dot2_f32_bf16 v20, v240, v56, 0
  v_dot2_f32_bf16 v20, v241, v57, v20
  v_dot2_f32_bf16 v20, v242, v58, v20
  v_dot2_f32_bf16 v20, v243, v59, v20
  s_waitcnt vmcnt(7)
  v_dot2_f32_bf16 v21, v244, v56, 0
  v_dot2_f32_bf16 v21, v245, v57, v21
  v_dot2_f32_bf16 v21, v246, v58, v21
  v_dot2_f32_bf16 v21, v247, v59, v21
  s_waitcnt vmcnt(1)
  v_dot2_f32_bf16 v22, v248, v56, 0
  v_dot2_f32_bf16 v22, v249, v57, v22
  v_dot2_f32_bf16 v22, v250, v58, v22
  v_dot2_f32_bf16 v22, v251, v59, v22
  s_waitcnt vmcnt(0)
  v_dot2_f32_bf16 v23, v252, v56, 0
  v_dot2_f32_bf16 v23, v253, v57, v23
  v_dot2_f32_bf16 v23, v254, v58, v23
  v_dot2_f32_bf16 v23, v255, v59, v23
  v_add_f32_dpp v24, v20, v20 row_ror:8 row_mask:0xf bank_mask:0x3
  v_add_f32_dpp v25, v22, v22 row_ror:8 row_mask:0xf bank_mask:0x3
  v_add_f32_dpp v24, v21, v21 row_ror:8 row_mask:0xf bank_mask:0xc
  v_add_f32_dpp v25, v23, v23 row_ror:8 row_mask:0xf bank_mask:0xc
  s_nop 0
  v_add_f32_dpp v103, v24, v24 row_half_mirror row_mask:0xf bank_mask:0x5
  v_add_f32_dpp v103, v25, v25 row_half_mirror row_mask:0xf bank_mask:0xa
  s_nop 1
  v_add_f32_dpp v103, v103, v103 quad_perm:[1,0,3,2] row_mask:0xf bank_mask:0xf
  s_nop 1
  v_add_f32_dpp v103, v103, v103 quad_perm:[2,3,0,1] row_mask:0xf bank_mask:0xf
  v_cvt_pk_bf16_f32 v26, v102, v103
  v_lshlrev_b32 v102, 16, v26
  v_and_b32 v103, 0xffff0000, v26
  v_mul_f32 v102, 0x3db504f3, v102
  v_mul_f32 v103, 0x3db504f3, v103
  v_cvt_pk_bf16_f32 v26, v102, v103
  v_lshlrev_b32 v102, 16, v26
  v_and_b32 v103, 0xffff0000, v26
  v_max3_f32 v44, v96, v97, v98
  v_max3_f32 v44, v44, v99, v100
  v_max3_f32 v44, v44, v101, v102
  v_max_f32 v44, v44, v103
  s_nop 1
  v_max_f32_dpp v44, v44, v44 row_ror:4 row_mask:0xf bank_mask:0xf
  s_nop 1
  v_max_f32_dpp v44, v44, v44 row_ror:8 row_mask:0xf bank_mask:0xf
  s_nop 0
  v_readlane_b32 s12, v44, 0
  v_readlane_b32 s13, v44, 16
  v_readlane_b32 s14, v44, 32
  v_readlane_b32 s15, v44, 48
  v_mov_b32 v46, s12
  v_max_f32 v46, s13, v46
  v_max_f32 v46, s14, v46
  v_max_f32 v46, s15, v46
  v_sub_f32 v12, v96, v46
  v_mul_f32 v12, 0x3fb8aa3b, v12
  v_exp_f32 v12, v12
  v_sub_f32 v13, v97, v46
  v_mul_f32 v13, 0x3fb8aa3b, v13
  v_exp_f32 v13, v13
  v_sub_f32 v14, v98, v46
  v_mul_f32 v14, 0x3fb8aa3b, v14
  v_exp_f32 v14, v14
  v_sub_f32 v15, v99, v46
  v_mul_f32 v15, 0x3fb8aa3b, v15
  v_exp_f32 v15, v15
  v_sub_f32 v16, v100, v46
  v_mul_f32 v16, 0x3fb8aa3b, v16
  v_exp_f32 v16, v16
  v_sub_f32 v17, v101, v46
  v_mul_f32 v17, 0x3fb8aa3b, v17
  v_exp_f32 v17, v17
  v_sub_f32 v18, v102, v46
  v_mul_f32 v18, 0x3fb8aa3b, v18
  v_exp_f32 v18, v18
  v_sub_f32 v19, v103, v46
  v_mul_f32 v19, 0x3fb8aa3b, v19
  v_exp_f32 v19, v19
  s_nop 0
  v_add_f32 v12, v12, v16
  v_add_f32 v13, v13, v17
  v_add_f32 v14, v14, v18
  v_add_f32 v15, v15, v19
  v_add_f32 v12, v12, v14
  v_add_f32 v13, v13, v15
  v_add_f32 v12, v12, v13
  s_nop 1
  v_add_f32_dpp v12, v12, v12 row_ror:4 row_mask:0xf bank_mask:0xf
  s_nop 1
  v_add_f32_dpp v12, v12, v12 row_ror:8 row_mask:0xf bank_mask:0xf
  s_nop 0
  v_readlane_b32 s12, v12, 0
  v_readlane_b32 s13, v12, 16
  v_readlane_b32 s14, v12, 32
  v_readlane_b32 s15, v12, 48
  v_mov_b32 v47, s12
  v_add_f32 v47, s13, v47
  v_add_f32 v47, s14, v47
  v_add_f32 v47, s15, v47
  s_lshl_b32 s9, s3, 3
  s_add_u32 s9, s9, 114688
  v_mov_b32 v7, s9
  ds_write_b64 v7, v[46:47]
  v_mov_b32 v7, 149132
  v_mov_b32 v8, 1
  s_mov_b64 s[10:11], exec
  s_mov_b64 exec, 1
  ds_add_rtn_u32 v8, v7, v8
  s_mov_b64 exec, s[10:11]
  s_waitcnt lgkmcnt(0)
  v_readfirstlane_b32 s9, v8
  s_cmp_lg_u32 s9, 7
  s_cbranch_scc1 L_notlast
  v_mov_b32 v8, 114688
  ds_read_b128 v[12:15], v8 offset:0
  ds_read_b128 v[16:19], v8 offset:16
  ds_read_b128 v[20:23], v8 offset:32
  ds_read_b128 v[24:27], v8 offset:48
  s_mov_b32 s14, 0
  v_lshlrev_b32 v51, 5, v1
  v_add_u32 v51, 0x154000, v51
L_chk_1:
  v_cmp_eq_u32 vcc, s98, v88
  v_cmp_eq_u32 s[10:11], s99, v89
  s_and_b64 vcc, vcc, s[10:11]
  v_cmp_eq_u32 s[10:11], s98, v90
  s_and_b64 vcc, vcc, s[10:11]
  v_cmp_eq_u32 s[10:11], s99, v91
  s_and_b64 vcc, vcc, s[10:11]
  v_cmp_eq_u32 s[10:11], s98, v92
  s_and_b64 vcc, vcc, s[10:11]
  v_cmp_eq_u32 s[10:11], s99, v93
  s_and_b64 vcc, vcc, s[10:11]
  v_cmp_eq_u32 s[10:11], s98, v94
  s_and_b64 vcc, vcc, s[10:11]
  v_cmp_eq_u32 s[10:11], s99, v95
  s_and_b64 vcc, vcc, s[10:11]
  s_cmp_eq_u64 vcc, exec
  s_cbranch_scc1 L_chkd_2
  s_sleep 2
  buffer_load_dwordx4 v[88:91], v51, s[80:83], 0 offen sc1
  buffer_load_dwordx4 v[92:95], v51, s[80:83], 0 offen offset:16 sc1
  s_waitcnt vmcnt(0)
  s_add_u32 s14, s14, 1
  s_cmp_lt_u32 s14, 400000
  s_cbranch_scc1 L_chk_1
L_chkd_2:
  s_waitcnt lgkmcnt(0)
  v_max3_f32 v44, v12, v14, v16
  v_max3_f32 v44, v44, v18, v20
  v_max3_f32 v44, v44, v22, v24
  v_max_f32 v46, v44, v26
  v_sub_f32 v28, v12, v46
  v_mul_f32 v28, 0x3fb8aa3b, v28
  v_exp_f32 v28, v28
  v_sub_f32 v29, v14, v46
  v_mul_f32 v29, 0x3fb8aa3b, v29
  v_exp_f32 v29, v29
  v_sub_f32 v30, v16, v46
  v_mul_f32 v30, 0x3fb8aa3b, v30
  v_exp_f32 v30, v30
  v_sub_f32 v31, v18, v46
  v_mul_f32 v31, 0x3fb8aa3b, v31
  v_exp_f32 v31, v31
  v_sub_f32 v32, v20, v46
  v_mul_f32 v32, 0x3fb8aa3b, v32
  v_exp_f32 v32, v32
  v_sub_f32 v33, v22, v46
  v_mul_f32 v33, 0x3fb8aa3b, v33
  v_exp_f32 v33, v33
  v_sub_f32 v34, v24, v46
  v_mul_f32 v34, 0x3fb8aa3b, v34
  v_exp_f32 v34, v34
  v_sub_f32 v35, v26, v46
  v_mul_f32 v35, 0x3fb8aa3b, v35
  v_exp_f32 v35, v35
  s_nop 0
  v_mul_f32 v47, v13, v28
  v_fmac_f32 v47, v15, v29
  v_fmac_f32 v47, v17, v30
  v_fmac_f32 v47, v19, v31
  v_fmac_f32 v47, v21, v32
  v_fmac_f32 v47, v23, v33
  v_fmac_f32 v47, v25, v34
  v_fmac_f32 v47, v27, v35
  s_lshl_b32 s9, s7, 10
  v_mov_b32 v7, s9
  v_mov_b32 v8, 114768
  v_mov_b32 v9, 8
  v_mov_b32 v10, 149132
  s_mov_b64 s[10:11], exec
  s_mov_b64 exec, 1
  buffer_store_dwordx2 v[46:47], v7, s[80:83], 0 offen offset:512 sc1
  ds_write_b64 v8, v[46:47]
  ds_add_u32 v10, v9
  s_mov_b64 exec, s[10:11]
L_notlast:
  s_setprio 0
  s_movk_i32 s15, 0
  s_add_u32 m0, s101, 0
  s_nop 0
  buffer_load_dwordx4 v4, s[44:47], s15 offen nt lds
  buffer_load_dwordx4 v[132:135], v4, s[44:47], s84 offen offset:1024 nt
  buffer_load_dwordx4 v[136:139], v4, s[44:47], s84 offen offset:2048 nt
  buffer_load_dwordx4 v[140:143], v4, s[44:47], s84 offen offset:3072 nt
  buffer_load_dwordx4 v[144:147], v4, s[44:47], s85 offen offset:0 nt
  buffer_load_dwordx4 v[148:151], v4, s[44:47], s85 offen offset:1024 nt
  buffer_load_dwordx4 v[152:155], v4, s[44:47], s85 offen offset:2048 nt
  buffer_load_dwordx4 v[156:159], v4, s[44:47], s85 offen offset:3072 nt
  buffer_load_dwordx4 v[160:163], v4, s[44:47], s86 offen offset:0 nt
  buffer_load_dwordx4 v[164:167], v4, s[44:47], s86 offen offset:1024 nt
  buffer_load_dwordx4 v[168:171], v4, s[44:47], s86 offen offset:2048 nt
  v_mov_b32 v50, 149120
  s_waitcnt vmcnt(9)
  buffer_load_dwordx4 v[172:175], v4, s[44:47], s86 offen offset:3072 nt
  s_waitcnt vmcnt(9)
  buffer_load_dwordx4 v[176:179], v4, s[44:47], s87 offen offset:0 nt
  s_waitcnt vmcnt(9)
  buffer_load_dwordx4 v[180:183], v4, s[44:47], s87 offen offset:1024 nt
  ds_read_b32 v49, v50
  s_waitcnt lgkmcnt(0)
  v_readfirstlane_b32 s9, v49
  s_cmp_ge_u32 s9, 0x100
  s_cbranch_scc1 L_pv3
  s_waitcnt vmcnt(9)
  buffer_load_dwordx4 v[184:187], v4, s[44:47], s87 offen offset:2048 nt
  s_waitcnt vmcnt(9)
  buffer_load_dwordx4 v[188:191], v4, s[44:47], s87 offen offset:3072 nt
  s_waitcnt vmcnt(9)
  buffer_load_dwordx4 v[192:195], v4, s[44:47], s88 offen offset:0 nt
  ds_read_b32 v49, v50
  s_waitcnt lgkmcnt(0)
  v_readfirstlane_b32 s9, v49
  s_cmp_ge_u32 s9, 0x100
  s_cbranch_scc1 L_pv6
  s_waitcnt vmcnt(9)
  buffer_load_dwordx4 v[196:199], v4, s[44:47], s88 offen offset:1024 nt
  s_waitcnt vmcnt(9)
  buffer_load_dwordx4 v[200:203], v4, s[44:47], s88 offen offset:2048 nt
  s_waitcnt vmcnt(9)
  buffer_load_dwordx4 v[204:207], v4, s[44:47], s88 offen offset:3072 nt
  ds_read_b32 v49, v50
  s_waitcnt lgkmcnt(0)
  v_readfirstlane_b32 s9, v49
  s_cmp_ge_u32 s9, 0x100
  s_cbranch_scc1 L_pv9
  s_waitcnt vmcnt(9)
  buffer_load_dwordx4 v[208:211], v4, s[44:47], s89 offen offset:0 nt
  s_waitcnt vmcnt(9)
  buffer_load_dwordx4 v[212:215], v4, s[44:47], s89 offen offset:1024 nt
  s_waitcnt vmcnt(9)
  buffer_load_dwordx4 v[216:219], v4, s[44:47], s89 offen offset:2048 nt
  ds_read_b32 v49, v50
  s_waitcnt lgkmcnt(0)
  v_readfirstlane_b32 s9, v49
  s_cmp_ge_u32 s9, 0x100
  s_cbranch_scc1 L_pv12
  s_waitcnt vmcnt(9)
  buffer_load_dwordx4 v[220:223], v4, s[44:47], s89 offen offset:3072 nt
  s_waitcnt vmcnt(9)
  buffer_load_dwordx4 v[224:227], v4, s[44:47], s90 offen offset:0 nt
  s_waitcnt vmcnt(9)
  buffer_load_dwordx4 v[228:231], v4, s[44:47], s90 offen offset:1024 nt
  ds_read_b32 v49, v50
  s_waitcnt lgkmcnt(0)
  v_readfirstlane_b32 s9, v49
  s_cmp_ge_u32 s9, 0x100
  s_cbranch_scc1 L_pv15
  s_waitcnt vmcnt(9)
  buffer_load_dwordx4 v[232:235], v4, s[44:47], s90 offen offset:2048 nt
  s_waitcnt vmcnt(9)
  buffer_load_dwordx4 v[236:239], v4, s[44:47], s90 offen offset:3072 nt
  s_waitcnt vmcnt(9)
  buffer_load_dwordx4 v[240:243], v4, s[44:47], s91 offen offset:0 nt
  ds_read_b32 v49, v50
  s_waitcnt lgkmcnt(0)
  v_readfirstlane_b32 s9, v49
  s_cmp_ge_u32 s9, 0x100
  s_cbranch_scc1 L_pv18
  s_waitcnt vmcnt(9)
  buffer_load_dwordx4 v[244:247], v4, s[44:47], s91 offen offset:1024 nt
  s_waitcnt vmcnt(9)
  buffer_load_dwordx4 v[248:251], v4, s[44:47], s91 offen offset:2048 nt
  s_waitcnt vmcnt(9)
  buffer_load_dwordx4 v[252:255], v4, s[44:47], s91 offen offset:3072 nt
  ds_read_b32 v49, v50
  s_waitcnt lgkmcnt(0)
  v_readfirstlane_b32 s9, v49
  s_cmp_ge_u32 s9, 0x100
  s_cbranch_scc1 L_pv21
  v_mov_b32 v50, 149120
  s_mov_b32 s14, 0
L_gow_3:
  ds_read_b32 v49, v50
  s_waitcnt lgkmcnt(0)
  v_readfirstlane_b32 s9, v49
  s_cmp_ge_u32 s9, 256
  s_cbranch_scc1 L_gowd_4
  s_sleep 1
  s_add_u32 s14, s14, 1
  s_cmp_lt_u32 s14, 1600000
  s_cbranch_scc1 L_gow_3
L_gowd_4:
L_pvend:
  v_mov_b32 v8, 114752
  ds_read_b64 v[46:47], v8
  s_waitcnt lgkmcnt(0)
  v_sub_f32 v96, v96, v46
  v_mul_f32 v96, 0x3fb8aa3b, v96
  v_exp_f32 v96, v96
  v_sub_f32 v97, v97, v46
  v_mul_f32 v97, 0x3fb8aa3b, v97
  v_exp_f32 v97, v97
  v_sub_f32 v98, v98, v46
  v_mul_f32 v98, 0x3fb8aa3b, v98
  v_exp_f32 v98, v98
  v_sub_f32 v99, v99, v46
  v_mul_f32 v99, 0x3fb8aa3b, v99
  v_exp_f32 v99, v99
  v_sub_f32 v100, v100, v46
  v_mul_f32 v100, 0x3fb8aa3b, v100
  v_exp_f32 v100, v100
  v_sub_f32 v101, v101, v46
  v_mul_f32 v101, 0x3fb8aa3b, v101
  v_exp_f32 v101, v101
  v_sub_f32 v102, v102, v46
  v_mul_f32 v102, 0x3fb8aa3b, v102
  v_exp_f32 v102, v102
  v_sub_f32 v103, v103, v46
  v_mul_f32 v103, 0x3fb8aa3b, v103
  v_exp_f32 v103, v103
  s_nop 0
  v_mul_f32 v96, v96, v47
  v_mul_f32 v97, v97, v47
  v_cvt_pk_bf16_f32 v45, v96, v97
  v_lshlrev_b32 v96, 16, v45
  v_and_b32 v97, 0xffff0000, v45
  v_mul_f32 v98, v98, v47
  v_mul_f32 v99, v99, v47
  v_cvt_pk_bf16_f32 v45, v98, v99
  v_lshlrev_b32 v98, 16, v45
  v_and_b32 v99, 0xffff0000, v45
  v_mul_f32 v100, v100, v47
  v_mul_f32 v101, v101, v47
  v_cvt_pk_bf16_f32 v45, v100, v101
  v_lshlrev_b32 v100, 16, v45
  v_and_b32 v101, 0xffff0000, v45
  v_mul_f32 v102, v102, v47
  v_mul_f32 v103, v103, v47
  v_cvt_pk_bf16_f32 v45, v102, v103
  v_lshlrev_b32 v102, 16, v45
  v_and_b32 v103, 0xffff0000, v45
  v_lshrrev_b32 v104, 16, v96
  v_lshrrev_b32 v105, 16, v97
  v_lshrrev_b32 v106, 16, v98
  v_lshrrev_b32 v107, 16, v99
  v_lshrrev_b32 v108, 16, v100
  v_lshrrev_b32 v109, 16, v101
  v_lshrrev_b32 v110, 16, v102
  v_lshrrev_b32 v111, 16, v103
  v_mov_b32 v12, 0
  v_mov_b32 v13, 0
  v_mov_b32 v14, 0
  v_mov_b32 v15, 0
  v_mov_b32 v16, 0
  v_mov_b32 v17, 0
  v_mov_b32 v18, 0
  v_mov_b32 v19, 0
  v_add_u32 v7, s101, v6
  ds_read_b128 v[128:131], v7 offset:0
  v_mov_b32_dpp v20, v104 row_newbcast:0 row_mask:0xf bank_mask:0xf
  v_mov_b32_dpp v21, v96 row_newbcast:0 row_mask:0xf bank_mask:0xf
  s_waitcnt lgkmcnt(0)
  v_dot2c_f32_bf16 v12, v128, v20
  v_dot2c_f32_bf16 v13, v128, v21
  v_dot2c_f32_bf16 v14, v129, v20
  v_dot2c_f32_bf16 v15, v129, v21
  v_dot2c_f32_bf16 v16, v130, v20
  v_dot2c_f32_bf16 v17, v130, v21
  v_dot2c_f32_bf16 v18, v131, v20
  v_dot2c_f32_bf16 v19, v131, v21
  v_mov_b32_dpp v22, v104 row_newbcast:8 row_mask:0xf bank_mask:0xf
  v_mov_b32_dpp v23, v96 row_newbcast:8 row_mask:0xf bank_mask:0xf
  v_dot2c_f32_bf16 v12, v132, v22
  v_dot2c_f32_bf16 v13, v132, v23
  v_dot2c_f32_bf16 v14, v133, v22
  v_dot2c_f32_bf16 v15, v133, v23
  v_dot2c_f32_bf16 v16, v134, v22
  v_dot2c_f32_bf16 v17, v134, v23
  v_dot2c_f32_bf16 v18, v135, v22
  v_dot2c_f32_bf16 v19, v135, v23
  v_mov_b32_dpp v20, v104 row_newbcast:4 row_mask:0xf bank_mask:0xf
  v_mov_b32_dpp v21, v96 row_newbcast:4 row_mask:0xf bank_mask:0xf
  v_dot2c_f32_bf16 v12, v136, v20
  v_dot2c_f32_bf16 v13, v136, v21
  v_dot2c_f32_bf16 v14, v137, v20
  v_dot2c_f32_bf16 v15, v137, v21
  v_dot2c_f32_bf16 v16, v138, v20
  v_dot2c_f32_bf16 v17, v138, v21
  v_dot2c_f32_bf16 v18, v139, v20
  v_dot2c_f32_bf16 v19, v139, v21
  v_mov_b32_dpp v22, v104 row_newbcast:12 row_mask:0xf bank_mask:0xf
  v_mov_b32_dpp v23, v96 row_newbcast:12 row_mask:0xf bank_mask:0xf
  v_dot2c_f32_bf16 v12, v140, v22
  v_dot2c_f32_bf16 v13, v140, v23
  v_dot2c_f32_bf16 v14, v141, v22
  v_dot2c_f32_bf16 v15, v141, v23
  v_dot2c_f32_bf16 v16, v142, v22
  v_dot2c_f32_bf16 v17, v142, v23
  v_dot2c_f32_bf16 v18, v143, v22
  v_dot2c_f32_bf16 v19, v143, v23
  v_mov_b32_dpp v20, v105 row_newbcast:0 row_mask:0xf bank_mask:0xf
  v_mov_b32_dpp v21, v97 row_newbcast:0 row_mask:0xf bank_mask:0xf
  v_dot2c_f32_bf16 v12, v144, v20
  v_dot2c_f32_bf16 v13, v144, v21
  v_dot2c_f32_bf16 v14, v145, v20
  v_dot2c_f32_bf16 v15, v145, v21
  v_dot2c_f32_bf16 v16, v146, v20
  v_dot2c_f32_bf16 v17, v146, v21
  v_dot2c_f32_bf16 v18, v147, v20
  v_dot2c_f32_bf16 v19, v147, v21
  v_mov_b32_dpp v22, v105 row_newbcast:8 row_mask:0xf bank_mask:0xf
  v_mov_b32_dpp v23, v97 row_newbcast:8 row_mask:0xf bank_mask:0xf
  v_dot2c_f32_bf16 v12, v148, v22
  v_dot2c_f32_bf16 v13, v148, v23
  v_dot2c_f32_bf16 v14, v149, v22
  v_dot2c_f32_bf16 v15, v149, v23
  v_dot2c_f32_bf16 v16, v150, v22
  v_dot2c_f32_bf16 v17, v150, v23
  v_dot2c_f32_bf16 v18, v151, v22
  v_dot2c_f32_bf16 v19, v151, v23
  v_mov_b32_dpp v20, v105 row_newbcast:4 row_mask:0xf bank_mask:0xf
  v_mov_b32_dpp v21, v97 row_newbcast:4 row_mask:0xf bank_mask:0xf
  v_dot2c_f32_bf16 v12, v152, v20
  v_dot2c_f32_bf16 v13, v152, v21
  v_dot2c_f32_bf16 v14, v153, v20
  v_dot2c_f32_bf16 v15, v153, v21
  v_dot2c_f32_bf16 v16, v154, v20
  v_dot2c_f32_bf16 v17, v154, v21
  v_dot2c_f32_bf16 v18, v155, v20
  v_dot2c_f32_bf16 v19, v155, v21
  v_mov_b32_dpp v22, v105 row_newbcast:12 row_mask:0xf bank_mask:0xf
  v_mov_b32_dpp v23, v97 row_newbcast:12 row_mask:0xf bank_mask:0xf
  v_dot2c_f32_bf16 v12, v156, v22
  v_dot2c_f32_bf16 v13, v156, v23
  v_dot2c_f32_bf16 v14, v157, v22
  v_dot2c_f32_bf16 v15, v157, v23
  v_dot2c_f32_bf16 v16, v158, v22
  v_dot2c_f32_bf16 v17, v158, v23
  v_dot2c_f32_bf16 v18, v159, v22
  v_dot2c_f32_bf16 v19, v159, v23
  v_mov_b32_dpp v20, v106 row_newbcast:0 row_mask:0xf bank_mask:0xf
  v_mov_b32_dpp v21, v98 row_newbcast:0 row_mask:0xf bank_mask:0xf
  v_dot2c_f32_bf16 v12, v160, v20
  v_dot2c_f32_bf16 v13, v160, v21
  v_dot2c_f32_bf16 v14, v161, v20
  v_dot2c_f32_bf16 v15, v161, v21
  v_dot2c_f32_bf16 v16, v162, v20
  v_dot2c_f32_bf16 v17, v162, v21
  v_dot2c_f32_bf16 v18, v163, v20
  v_dot2c_f32_bf16 v19, v163, v21
  v_mov_b32_dpp v22, v106 row_newbcast:8 row_mask:0xf bank_mask:0xf
  v_mov_b32_dpp v23, v98 row_newbcast:8 row_mask:0xf bank_mask:0xf
  v_dot2c_f32_bf16 v12, v164, v22
  v_dot2c_f32_bf16 v13, v164, v23
  v_dot2c_f32_bf16 v14, v165, v22
  v_dot2c_f32_bf16 v15, v165, v23
  v_dot2c_f32_bf16 v16, v166, v22
  v_dot2c_f32_bf16 v17, v166, v23
  v_dot2c_f32_bf16 v18, v167, v22
  v_dot2c_f32_bf16 v19, v167, v23
  v_mov_b32_dpp v20, v106 row_newbcast:4 row_mask:0xf bank_mask:0xf
  v_mov_b32_dpp v21, v98 row_newbcast:4 row_mask:0xf bank_mask:0xf
  v_dot2c_f32_bf16 v12, v168, v20
  v_dot2c_f32_bf16 v13, v168, v21
  v_dot2c_f32_bf16 v14, v169, v20
  v_dot2c_f32_bf16 v15, v169, v21
  v_dot2c_f32_bf16 v16, v170, v20
  v_dot2c_f32_bf16 v17, v170, v21
  v_dot2c_f32_bf16 v18, v171, v20
  v_dot2c_f32_bf16 v19, v171, v21
  v_mov_b32_dpp v22, v106 row_newbcast:12 row_mask:0xf bank_mask:0xf
  v_mov_b32_dpp v23, v98 row_newbcast:12 row_mask:0xf bank_mask:0xf
  v_dot2c_f32_bf16 v12, v172, v22
  v_dot2c_f32_bf16 v13, v172, v23
  v_dot2c_f32_bf16 v14, v173, v22
  v_dot2c_f32_bf16 v15, v173, v23
  v_dot2c_f32_bf16 v16, v174, v22
  v_dot2c_f32_bf16 v17, v174, v23
  v_dot2c_f32_bf16 v18, v175, v22
  v_dot2c_f32_bf16 v19, v175, v23
  v_mov_b32_dpp v20, v107 row_newbcast:0 row_mask:0xf bank_mask:0xf
  v_mov_b32_dpp v21, v99 row_newbcast:0 row_mask:0xf bank_mask:0xf
  v_dot2c_f32_bf16 v12, v176, v20
  v_dot2c_f32_bf16 v13, v176, v21
  v_dot2c_f32_bf16 v14, v177, v20
  v_dot2c_f32_bf16 v15, v177, v21
  v_dot2c_f32_bf16 v16, v178, v20
  v_dot2c_f32_bf16 v17, v178, v21
  v_dot2c_f32_bf16 v18, v179, v20
  v_dot2c_f32_bf16 v19, v179, v21
  v_mov_b32_dpp v22, v107 row_newbcast:8 row_mask:0xf bank_mask:0xf
  v_mov_b32_dpp v23, v99 row_newbcast:8 row_mask:0xf bank_mask:0xf
  v_dot2c_f32_bf16 v12, v180, v22
  v_dot2c_f32_bf16 v13, v180, v23
  v_dot2c_f32_bf16 v14, v181, v22
  v_dot2c_f32_bf16 v15, v181, v23
  v_dot2c_f32_bf16 v16, v182, v22
  v_dot2c_f32_bf16 v17, v182, v23
  v_dot2c_f32_bf16 v18, v183, v22
  v_dot2c_f32_bf16 v19, v183, v23
  v_mov_b32_dpp v20, v107 row_newbcast:4 row_mask:0xf bank_mask:0xf
  v_mov_b32_dpp v21, v99 row_newbcast:4 row_mask:0xf bank_mask:0xf
  v_dot2c_f32_bf16 v12, v184, v20
  v_dot2c_f32_bf16 v13, v184, v21
  v_dot2c_f32_bf16 v14, v185, v20
  v_dot2c_f32_bf16 v15, v185, v21
  v_dot2c_f32_bf16 v16, v186, v20
  v_dot2c_f32_bf16 v17, v186, v21
  v_dot2c_f32_bf16 v18, v187, v20
  v_dot2c_f32_bf16 v19, v187, v21
  v_mov_b32_dpp v22, v107 row_newbcast:12 row_mask:0xf bank_mask:0xf
  v_mov_b32_dpp v23, v99 row_newbcast:12 row_mask:0xf bank_mask:0xf
  v_dot2c_f32_bf16 v12, v188, v22
  v_dot2c_f32_bf16 v13, v188, v23
  v_dot2c_f32_bf16 v14, v189, v22
  v_dot2c_f32_bf16 v15, v189, v23
  v_dot2c_f32_bf16 v16, v190, v22
  v_dot2c_f32_bf16 v17, v190, v23
  v_dot2c_f32_bf16 v18, v191, v22
  v_dot2c_f32_bf16 v19, v191, v23
  v_mov_b32_dpp v20, v108 row_newbcast:0 row_mask:0xf bank_mask:0xf
  v_mov_b32_dpp v21, v100 row_newbcast:0 row_mask:0xf bank_mask:0xf
  v_dot2c_f32_bf16 v12, v192, v20
  v_dot2c_f32_bf16 v13, v192, v21
  v_dot2c_f32_bf16 v14, v193, v20
  v_dot2c_f32_bf16 v15, v193, v21
  v_dot2c_f32_bf16 v16, v194, v20
  v_dot2c_f32_bf16 v17, v194, v21
  v_dot2c_f32_bf16 v18, v195, v20
  v_dot2c_f32_bf16 v19, v195, v21
  v_mov_b32_dpp v22, v108 row_newbcast:8 row_mask:0xf bank_mask:0xf
  v_mov_b32_dpp v23, v100 row_newbcast:8 row_mask:0xf bank_mask:0xf
  v_dot2c_f32_bf16 v12, v196, v22
  v_dot2c_f32_bf16 v13, v196, v23
  v_dot2c_f32_bf16 v14, v197, v22
  v_dot2c_f32_bf16 v15, v197, v23
  v_dot2c_f32_bf16 v16, v198, v22
  v_dot2c_f32_bf16 v17, v198, v23
  v_dot2c_f32_bf16 v18, v199, v22
  v_dot2c_f32_bf16 v19, v199, v23
  v_mov_b32_dpp v20, v108 row_newbcast:4 row_mask:0xf bank_mask:0xf
  v_mov_b32_dpp v21, v100 row_newbcast:4 row_mask:0xf bank_mask:0xf
  v_dot2c_f32_bf16 v12, v200, v20
  v_dot2c_f32_bf16 v13, v200, v21
  v_dot2c_f32_bf16 v14, v201, v20
  v_dot2c_f32_bf16 v15, v201, v21
  v_dot2c_f32_bf16 v16, v202, v20
  v_dot2c_f32_bf16 v17, v202, v21
  v_dot2c_f32_bf16 v18, v203, v20
  v_dot2c_f32_bf16 v19, v203, v21
  v_mov_b32_dpp v22, v108 row_newbcast:12 row_mask:0xf bank_mask:0xf
  v_mov_b32_dpp v23, v100 row_newbcast:12 row_mask:0xf bank_mask:0xf
  v_dot2c_f32_bf16 v12, v204, v22
  v_dot2c_f32_bf16 v13, v204, v23
  v_dot2c_f32_bf16 v14, v205, v22
  v_dot2c_f32_bf16 v15, v205, v23
  v_dot2c_f32_bf16 v16, v206, v22
  v_dot2c_f32_bf16 v17, v206, v23
  v_dot2c_f32_bf16 v18, v207, v22
  v_dot2c_f32_bf16 v19, v207, v23
  v_mov_b32_dpp v20, v109 row_newbcast:0 row_mask:0xf bank_mask:0xf
  v_mov_b32_dpp v21, v101 row_newbcast:0 row_mask:0xf bank_mask:0xf
  v_dot2c_f32_bf16 v12, v208, v20
  v_dot2c_f32_bf16 v13, v208, v21
  v_dot2c_f32_bf16 v14, v209, v20
  v_dot2c_f32_bf16 v15, v209, v21
  v_dot2c_f32_bf16 v16, v210, v20
  v_dot2c_f32_bf16 v17, v210, v21
  v_dot2c_f32_bf16 v18, v211, v20
  v_dot2c_f32_bf16 v19, v211, v21
  v_mov_b32_dpp v22, v109 row_newbcast:8 row_mask:0xf bank_mask:0xf
  v_mov_b32_dpp v23, v101 row_newbcast:8 row_mask:0xf bank_mask:0xf
  v_dot2c_f32_bf16 v12, v212, v22
  v_dot2c_f32_bf16 v13, v212, v23
  v_dot2c_f32_bf16 v14, v213, v22
  v_dot2c_f32_bf16 v15, v213, v23
  v_dot2c_f32_bf16 v16, v214, v22
  v_dot2c_f32_bf16 v17, v214, v23
  v_dot2c_f32_bf16 v18, v215, v22
  v_dot2c_f32_bf16 v19, v215, v23
  v_mov_b32_dpp v20, v109 row_newbcast:4 row_mask:0xf bank_mask:0xf
  v_mov_b32_dpp v21, v101 row_newbcast:4 row_mask:0xf bank_mask:0xf
  s_waitcnt vmcnt(9)
  v_dot2c_f32_bf16 v12, v216, v20
  v_dot2c_f32_bf16 v13, v216, v21
  v_dot2c_f32_bf16 v14, v217, v20
  v_dot2c_f32_bf16 v15, v217, v21
  v_dot2c_f32_bf16 v16, v218, v20
  v_dot2c_f32_bf16 v17, v218, v21
  v_dot2c_f32_bf16 v18, v219, v20
  v_dot2c_f32_bf16 v19, v219, v21
  v_mov_b32_dpp v22, v109 row_newbcast:12 row_mask:0xf bank_mask:0xf
  v_mov_b32_dpp v23, v101 row_newbcast:12 row_mask:0xf bank_mask:0xf
  s_waitcnt vmcnt(8)
  v_dot2c_f32_bf16 v12, v220, v22
  v_dot2c_f32_bf16 v13, v220, v23
  v_dot2c_f32_bf16 v14, v221, v22
  v_dot2c_f32_bf16 v15, v221, v23
  v_dot2c_f32_bf16 v16, v222, v22
  v_dot2c_f32_bf16 v17, v222, v23
  v_dot2c_f32_bf16 v18, v223, v22
  v_dot2c_f32_bf16 v19, v223, v23
  v_mov_b32_dpp v20, v110 row_newbcast:0 row_mask:0xf bank_mask:0xf
  v_mov_b32_dpp v21, v102 row_newbcast:0 row_mask:0xf bank_mask:0xf
  s_waitcnt vmcnt(7)
  v_dot2c_f32_bf16 v12, v224, v20
  v_dot2c_f32_bf16 v13, v224, v21
  v_dot2c_f32_bf16 v14, v225, v20
  v_dot2c_f32_bf16 v15, v225, v21
  v_dot2c_f32_bf16 v16, v226, v20
  v_dot2c_f32_bf16 v17, v226, v21
  v_dot2c_f32_bf16 v18, v227, v20
  v_dot2c_f32_bf16 v19, v227, v21
  v_mov_b32_dpp v22, v110 row_newbcast:8 row_mask:0xf bank_mask:0xf
  v_mov_b32_dpp v23, v102 row_newbcast:8 row_mask:0xf bank_mask:0xf
  s_waitcnt vmcnt(6)
  v_dot2c_f32_bf16 v12, v228, v22
  v_dot2c_f32_bf16 v13, v228, v23
  v_dot2c_f32_bf16 v14, v229, v22
  v_dot2c_f32_bf16 v15, v229, v23
  v_dot2c_f32_bf16 v16, v230, v22
  v_dot2c_f32_bf16 v17, v230, v23
  v_dot2c_f32_bf16 v18, v231, v22
  v_dot2c_f32_bf16 v19, v231, v23
  v_mov_b32_dpp v20, v110 row_newbcast:4 row_mask:0xf bank_mask:0xf
  v_mov_b32_dpp v21, v102 row_newbcast:4 row_mask:0xf bank_mask:0xf
  s_waitcnt vmcnt(5)
  v_dot2c_f32_bf16 v12, v232, v20
  v_dot2c_f32_bf16 v13, v232, v21
  v_dot2c_f32_bf16 v14, v233, v20
  v_dot2c_f32_bf16 v15, v233, v21
  v_dot2c_f32_bf16 v16, v234, v20
  v_dot2c_f32_bf16 v17, v234, v21
  v_dot2c_f32_bf16 v18, v235, v20
  v_dot2c_f32_bf16 v19, v235, v21
  v_mov_b32_dpp v22, v110 row_newbcast:12 row_mask:0xf bank_mask:0xf
  v_mov_b32_dpp v23, v102 row_newbcast:12 row_mask:0xf bank_mask:0xf
  s_waitcnt vmcnt(4)
  v_dot2c_f32_bf16 v12, v236, v22
  v_dot2c_f32_bf16 v13, v236, v23
  v_dot2c_f32_bf16 v14, v237, v22
  v_dot2c_f32_bf16 v15, v237, v23
  v_dot2c_f32_bf16 v16, v238, v22
  v_dot2c_f32_bf16 v17, v238, v23
  v_dot2c_f32_bf16 v18, v239, v22
  v_dot2c_f32_bf16 v19, v239, v23
  v_mov_b32_dpp v20, v111 row_newbcast:0 row_mask:0xf bank_mask:0xf
  v_mov_b32_dpp v21, v103 row_newbcast:0 row_mask:0xf bank_mask:0xf
  s_waitcnt vmcnt(3)
  v_dot2c_f32_bf16 v12, v240, v20
  v_dot2c_f32_bf16 v13, v240, v21
  v_dot2c_f32_bf16 v14, v241, v20
  v_dot2c_f32_bf16 v15, v241, v21
  v_dot2c_f32_bf16 v16, v242, v20
  v_dot2c_f32_bf16 v17, v242, v21
  v_dot2c_f32_bf16 v18, v243, v20
  v_dot2c_f32_bf16 v19, v243, v21
  v_mov_b32_dpp v22, v111 row_newbcast:8 row_mask:0xf bank_mask:0xf
  v_mov_b32_dpp v23, v103 row_newbcast:8 row_mask:0xf bank_mask:0xf
  s_waitcnt vmcnt(2)
  v_dot2c_f32_bf16 v12, v244, v22
  v_dot2c_f32_bf16 v13, v244, v23
  v_dot2c_f32_bf16 v14, v245, v22
  v_dot2c_f32_bf16 v15, v245, v23
  v_dot2c_f32_bf16 v16, v246, v22
  v_dot2c_f32_bf16 v17, v246, v23
  v_dot2c_f32_bf16 v18, v247, v22
  v_dot2c_f32_bf16 v19, v247, v23
  v_mov_b32_dpp v20, v111 row_newbcast:4 row_mask:0xf bank_mask:0xf
  v_mov_b32_dpp v21, v103 row_newbcast:4 row_mask:0xf bank_mask:0xf
  s_waitcnt vmcnt(1)
  v_dot2c_f32_bf16 v12, v248, v20
  v_dot2c_f32_bf16 v13, v248, v21
  v_dot2c_f32_bf16 v14, v249, v20
  v_dot2c_f32_bf16 v15, v249, v21
  v_dot2c_f32_bf16 v16, v250, v20
  v_dot2c_f32_bf16 v17, v250, v21
  v_dot2c_f32_bf16 v18, v251, v20
  v_dot2c_f32_bf16 v19, v251, v21
  v_mov_b32_dpp v22, v111 row_newbcast:12 row_mask:0xf bank_mask:0xf
  v_mov_b32_dpp v23, v103 row_newbcast:12 row_mask:0xf bank_mask:0xf
  s_waitcnt vmcnt(0)
  v_dot2c_f32_bf16 v12, v252, v22
  v_dot2c_f32_bf16 v13, v252, v23
  v_dot2c_f32_bf16 v14, v253, v22
  v_dot2c_f32_bf16 v15, v253, v23
  v_dot2c_f32_bf16 v16, v254, v22
  v_dot2c_f32_bf16 v17, v254, v23
  v_dot2c_f32_bf16 v18, v255, v22
  v_dot2c_f32_bf16 v19, v255, v23
  s_branch L_tail
L_comm_k:
  v_mov_b32 v8, 114760
  ds_read_b64 v[8:9], v8
  v_lshlrev_b32 v7, 4, v3
  v_add_u32 v7, 117888, v7
  ds_read_b128 v[56:59], v7
  s_waitcnt lgkmcnt(0)
  v_readfirstlane_b32 s98, v8
  v_readfirstlane_b32 s99, v9
  v_dot2_f32_bf16 v20, v128, v56, 0
  v_dot2_f32_bf16 v20, v129, v57, v20
  v_dot2_f32_bf16 v20, v130, v58, v20
  v_dot2_f32_bf16 v20, v131, v59, v20
  v_dot2_f32_bf16 v21, v132, v56, 0
  v_dot2_f32_bf16 v21, v133, v57, v21
  v_dot2_f32_bf16 v21, v134, v58, v21
  v_dot2_f32_bf16 v21, v135, v59, v21
  v_dot2_f32_bf16 v22, v136, v56, 0
  v_dot2_f32_bf16 v22, v137, v57, v22
  v_dot2_f32_bf16 v22, v138, v58, v22
  v_dot2_f32_bf16 v22, v139, v59, v22
  v_dot2_f32_bf16 v23, v140, v56, 0
  v_dot2_f32_bf16 v23, v141, v57, v23
  v_dot2_f32_bf16 v23, v142, v58, v23
  v_dot2_f32_bf16 v23, v143, v59, v23
  v_add_f32_dpp v24, v20, v20 row_ror:8 row_mask:0xf bank_mask:0x3
  v_add_f32_dpp v25, v22, v22 row_ror:8 row_mask:0xf bank_mask:0x3
  v_add_f32_dpp v24, v21, v21 row_ror:8 row_mask:0xf bank_mask:0xc
  v_add_f32_dpp v25, v23, v23 row_ror:8 row_mask:0xf bank_mask:0xc
  s_nop 0
  v_add_f32_dpp v96, v24, v24 row_half_mirror row_mask:0xf bank_mask:0x5
  v_add_f32_dpp v96, v25, v25 row_half_mirror row_mask:0xf bank_mask:0xa
  s_nop 1
  v_add_f32_dpp v96, v96, v96 quad_perm:[1,0,3,2] row_mask:0xf bank_mask:0xf
  s_nop 1
  v_add_f32_dpp v96, v96, v96 quad_perm:[2,3,0,1] row_mask:0xf bank_mask:0xf
  v_dot2_f32_bf16 v20, v144, v56, 0
  v_dot2_f32_bf16 v20, v145, v57, v20
  v_dot2_f32_bf16 v20, v146, v58, v20
  v_dot2_f32_bf16 v20, v147, v59, v20
  v_dot2_f32_bf16 v21, v148, v56, 0
  v_dot2_f32_bf16 v21, v149, v57, v21
  v_dot2_f32_bf16 v21, v150, v58, v21
  v_dot2_f32_bf16 v21, v151, v59, v21
  v_dot2_f32_bf16 v22, v152, v56, 0
  v_dot2_f32_bf16 v22, v153, v57, v22
  v_dot2_f32_bf16 v22, v154, v58, v22
  v_dot2_f32_bf16 v22, v155, v59, v22
  v_dot2_f32_bf16 v23, v156, v56, 0
  v_dot2_f32_bf16 v23, v157, v57, v23
  v_dot2_f32_bf16 v23, v158, v58, v23
  v_dot2_f32_bf16 v23, v159, v59, v23
  v_add_f32_dpp v24, v20, v20 row_ror:8 row_mask:0xf bank_mask:0x3
  v_add_f32_dpp v25, v22, v22 row_ror:8 row_mask:0xf bank_mask:0x3
  v_add_f32_dpp v24, v21, v21 row_ror:8 row_mask:0xf bank_mask:0xc
  v_add_f32_dpp v25, v23, v23 row_ror:8 row_mask:0xf bank_mask:0xc
  s_nop 0
  v_add_f32_dpp v97, v24, v24 row_half_mirror row_mask:0xf bank_mask:0x5
  v_add_f32_dpp v97, v25, v25 row_half_mirror row_mask:0xf bank_mask:0xa
  s_nop 1
  v_add_f32_dpp v97, v97, v97 quad_perm:[1,0,3,2] row_mask:0xf bank_mask:0xf
  s_nop 1
  v_add_f32_dpp v97, v97, v97 quad_perm:[2,3,0,1] row_mask:0xf bank_mask:0xf
  v_cvt_pk_bf16_f32 v26, v96, v97
  v_lshlrev_b32 v96, 16, v26
  v_and_b32 v97, 0xffff0000, v26
  v_mul_f32 v96, 0x3db504f3, v96
  v_mul_f32 v97, 0x3db504f3, v97
  v_cvt_pk_bf16_f32 v26, v96, v97
  v_lshlrev_b32 v96, 16, v26
  v_and_b32 v97, 0xffff0000, v26
  v_dot2_f32_bf16 v20, v160, v56, 0
  v_dot2_f32_bf16 v20, v161, v57, v20
  v_dot2_f32_bf16 v20, v162, v58, v20
  v_dot2_f32_bf16 v20, v163, v59, v20
  v_dot2_f32_bf16 v21, v164, v56, 0
  v_dot2_f32_bf16 v21, v165, v57, v21
  v_dot2_f32_bf16 v21, v166, v58, v21
  v_dot2_f32_bf16 v21, v167, v59, v21
  v_dot2_f32_bf16 v22, v168, v56, 0
  v_dot2_f32_bf16 v22, v169, v57, v22
  v_dot2_f32_bf16 v22, v170, v58, v22
  v_dot2_f32_bf16 v22, v171, v59, v22
  v_dot2_f32_bf16 v23, v172, v56, 0
  v_dot2_f32_bf16 v23, v173, v57, v23
  v_dot2_f32_bf16 v23, v174, v58, v23
  v_dot2_f32_bf16 v23, v175, v59, v23
  v_add_f32_dpp v24, v20, v20 row_ror:8 row_mask:0xf bank_mask:0x3
  v_add_f32_dpp v25, v22, v22 row_ror:8 row_mask:0xf bank_mask:0x3
  v_add_f32_dpp v24, v21, v21 row_ror:8 row_mask:0xf bank_mask:0xc
  v_add_f32_dpp v25, v23, v23 row_ror:8 row_mask:0xf bank_mask:0xc
  s_nop 0
  v_add_f32_dpp v98, v24, v24 row_half_mirror row_mask:0xf bank_mask:0x5
  v_add_f32_dpp v98, v25, v25 row_half_mirror row_mask:0xf bank_mask:0xa
  s_nop 1
  v_add_f32_dpp v98, v98, v98 quad_perm:[1,0,3,2] row_mask:0xf bank_mask:0xf
  s_nop 1
  v_add_f32_dpp v98, v98, v98 quad_perm:[2,3,0,1] row_mask:0xf bank_mask:0xf
  v_dot2_f32_bf16 v20, v176, v56, 0
  v_dot2_f32_bf16 v20, v177, v57, v20
  v_dot2_f32_bf16 v20, v178, v58, v20
  v_dot2_f32_bf16 v20, v179, v59, v20
  v_dot2_f32_bf16 v21, v180, v56, 0
  v_dot2_f32_bf16 v21, v181, v57, v21
  v_dot2_f32_bf16 v21, v182, v58, v21
  v_dot2_f32_bf16 v21, v183, v59, v21
  v_dot2_f32_bf16 v22, v184, v56, 0
  v_dot2_f32_bf16 v22, v185, v57, v22
  v_dot2_f32_bf16 v22, v186, v58, v22
  v_dot2_f32_bf16 v22, v187, v59, v22
  v_dot2_f32_bf16 v23, v188, v56, 0
  v_dot2_f32_bf16 v23, v189, v57, v23
  v_dot2_f32_bf16 v23, v190, v58, v23
  v_dot2_f32_bf16 v23, v191, v59, v23
  v_add_f32_dpp v24, v20, v20 row_ror:8 row_mask:0xf bank_mask:0x3
  v_add_f32_dpp v25, v22, v22 row_ror:8 row_mask:0xf bank_mask:0x3
  v_add_f32_dpp v24, v21, v21 row_ror:8 row_mask:0xf bank_mask:0xc
  v_add_f32_dpp v25, v23, v23 row_ror:8 row_mask:0xf bank_mask:0xc
  s_nop 0
  v_add_f32_dpp v99, v24, v24 row_half_mirror row_mask:0xf bank_mask:0x5
  v_add_f32_dpp v99, v25, v25 row_half_mirror row_mask:0xf bank_mask:0xa
  s_nop 1
  v_add_f32_dpp v99, v99, v99 quad_perm:[1,0,3,2] row_mask:0xf bank_mask:0xf
  s_nop 1
  v_add_f32_dpp v99, v99, v99 quad_perm:[2,3,0,1] row_mask:0xf bank_mask:0xf
  v_cvt_pk_bf16_f32 v26, v98, v99
  v_lshlrev_b32 v98, 16, v26
  v_and_b32 v99, 0xffff0000, v26
  v_mul_f32 v98, 0x3db504f3, v98
  v_mul_f32 v99, 0x3db504f3, v99
  v_cvt_pk_bf16_f32 v26, v98, v99
  v_lshlrev_b32 v98, 16, v26
  v_and_b32 v99, 0xffff0000, v26
  v_dot2_f32_bf16 v20, v192, v56, 0
  v_dot2_f32_bf16 v20, v193, v57, v20
  v_dot2_f32_bf16 v20, v194, v58, v20
  v_dot2_f32_bf16 v20, v195, v59, v20
  v_dot2_f32_bf16 v21, v196, v56, 0
  v_dot2_f32_bf16 v21, v197, v57, v21
  v_dot2_f32_bf16 v21, v198, v58, v21
  v_dot2_f32_bf16 v21, v199, v59, v21
  v_dot2_f32_bf16 v22, v200, v56, 0
  v_dot2_f32_bf16 v22, v201, v57, v22
  v_dot2_f32_bf16 v22, v202, v58, v22
  v_dot2_f32_bf16 v22, v203, v59, v22
  v_dot2_f32_bf16 v23, v204, v56, 0
  v_dot2_f32_bf16 v23, v205, v57, v23
  v_dot2_f32_bf16 v23, v206, v58, v23
  v_dot2_f32_bf16 v23, v207, v59, v23
  v_add_f32_dpp v24, v20, v20 row_ror:8 row_mask:0xf bank_mask:0x3
  v_add_f32_dpp v25, v22, v22 row_ror:8 row_mask:0xf bank_mask:0x3
  v_add_f32_dpp v24, v21, v21 row_ror:8 row_mask:0xf bank_mask:0xc
  v_add_f32_dpp v25, v23, v23 row_ror:8 row_mask:0xf bank_mask:0xc
  s_nop 0
  v_add_f32_dpp v100, v24, v24 row_half_mirror row_mask:0xf bank_mask:0x5
  v_add_f32_dpp v100, v25, v25 row_half_mirror row_mask:0xf bank_mask:0xa
  s_nop 1
  v_add_f32_dpp v100, v100, v100 quad_perm:[1,0,3,2] row_mask:0xf bank_mask:0xf
  s_nop 1
  v_add_f32_dpp v100, v100, v100 quad_perm:[2,3,0,1] row_mask:0xf bank_mask:0xf
  v_lshlrev_b32 v7, 5, v1
  v_add_u32 v7, 0x154000, v7
  buffer_load_dwordx4 v[88:91], v7, s[80:83], 0 offen sc1
  buffer_load_dwordx4 v[92:95], v7, s[80:83], 0 offen offset:16 sc1
  s_lshl_b32 s9, s4, 7
  s_lshl_b32 s10, s3, 4
  s_add_u32 s9, s9, s10
  s_lshl_b32 s9, s9, 10
  s_lshl_b32 s10, s8, 7
  s_add_u32 s9, s9, s10
  v_lshrrev_b32 v7, 3, v1
  v_lshlrev_b32 v7, 10, v7
  v_and_b32 v8, 7, v1
  v_lshlrev_b32 v8, 4, v8
  v_add_u32 v7, v7, v8
  v_add_u32 v7, s9, v7
  s_lshl_b32 s11, s3, 11
  s_add_u32 m0, s11, 132736
  s_nop 0
  buffer_load_dwordx4 v7, s[52:55], 0 offen nt lds
  v_add_u32 v7, 0x2000, v7
  s_add_u32 m0, s11, 133760
  s_nop 0
  buffer_load_dwordx4 v7, s[52:55], 0 offen nt lds
  s_and_b32 s9, s3, 3
  s_lshl_b32 s9, s9, 10
  v_add_u32 v7, s9, v6
  buffer_load_dwordx4 v[60:63], v7, s[56:59], 0 offen
  v_dot2_f32_bf16 v20, v208, v56, 0
  v_dot2_f32_bf16 v20, v209, v57, v20
  v_dot2_f32_bf16 v20, v210, v58, v20
  v_dot2_f32_bf16 v20, v211, v59, v20
  v_dot2_f32_bf16 v21, v212, v56, 0
  v_dot2_f32_bf16 v21, v213, v57, v21
  v_dot2_f32_bf16 v21, v214, v58, v21
  v_dot2_f32_bf16 v21, v215, v59, v21
  v_dot2_f32_bf16 v22, v216, v56, 0
  v_dot2_f32_bf16 v22, v217, v57, v22
  v_dot2_f32_bf16 v22, v218, v58, v22
  v_dot2_f32_bf16 v22, v219, v59, v22
  v_dot2_f32_bf16 v23, v220, v56, 0
  v_dot2_f32_bf16 v23, v221, v57, v23
  v_dot2_f32_bf16 v23, v222, v58, v23
  v_dot2_f32_bf16 v23, v223, v59, v23
  v_add_f32_dpp v24, v20, v20 row_ror:8 row_mask:0xf bank_mask:0x3
  v_add_f32_dpp v25, v22, v22 row_ror:8 row_mask:0xf bank_mask:0x3
  v_add_f32_dpp v24, v21, v21 row_ror:8 row_mask:0xf bank_mask:0xc
  v_add_f32_dpp v25, v23, v23 row_ror:8 row_mask:0xf bank_mask:0xc
  s_nop 0
  v_add_f32_dpp v101, v24, v24 row_half_mirror row_mask:0xf bank_mask:0x5
  v_add_f32_dpp v101, v25, v25 row_half_mirror row_mask:0xf bank_mask:0xa
  s_nop 1
  v_add_f32_dpp v101, v101, v101 quad_perm:[1,0,3,2] row_mask:0xf bank_mask:0xf
  s_nop 1
  v_add_f32_dpp v101, v101, v101 quad_perm:[2,3,0,1] row_mask:0xf bank_mask:0xf
  v_cvt_pk_bf16_f32 v26, v100, v101
  v_lshlrev_b32 v100, 16, v26
  v_and_b32 v101, 0xffff0000, v26
  v_mul_f32 v100, 0x3db504f3, v100
  v_mul_f32 v101, 0x3db504f3, v101
  v_cvt_pk_bf16_f32 v26, v100, v101
  v_lshlrev_b32 v100, 16, v26
  v_and_b32 v101, 0xffff0000, v26
  v_dot2_f32_bf16 v20, v224, v56, 0
  v_dot2_f32_bf16 v20, v225, v57, v20
  v_dot2_f32_bf16 v20, v226, v58, v20
  v_dot2_f32_bf16 v20, v227, v59, v20
  v_dot2_f32_bf16 v21, v228, v56, 0
  v_dot2_f32_bf16 v21, v229, v57, v21
  v_dot2_f32_bf16 v21, v230, v58, v21
  v_dot2_f32_bf16 v21, v231, v59, v21
  v_dot2_f32_bf16 v22, v232, v56, 0
  v_dot2_f32_bf16 v22, v233, v57, v22
  v_dot2_f32_bf16 v22, v234, v58, v22
  v_dot2_f32_bf16 v22, v235, v59, v22
  v_dot2_f32_bf16 v23, v236, v56, 0
  v_dot2_f32_bf16 v23, v237, v57, v23
  v_dot2_f32_bf16 v23, v238, v58, v23
  v_dot2_f32_bf16 v23, v239, v59, v23
  v_add_f32_dpp v24, v20, v20 row_ror:8 row_mask:0xf bank_mask:0x3
  v_add_f32_dpp v25, v22, v22 row_ror:8 row_mask:0xf bank_mask:0x3
  v_add_f32_dpp v24, v21, v21 row_ror:8 row_mask:0xf bank_mask:0xc
  v_add_f32_dpp v25, v23, v23 row_ror:8 row_mask:0xf bank_mask:0xc
  s_nop 0
  v_add_f32_dpp v102, v24, v24 row_half_mirror row_mask:0xf bank_mask:0x5
  v_add_f32_dpp v102, v25, v25 row_half_mirror row_mask:0xf bank_mask:0xa
  s_nop 1
  v_add_f32_dpp v102, v102, v102 quad_perm:[1,0,3,2] row_mask:0xf bank_mask:0xf
  s_nop 1
  v_add_f32_dpp v102, v102, v102 quad_perm:[2,3,0,1] row_mask:0xf bank_mask:0xf
  v_dot2_f32_bf16 v20, v240, v56, 0
  v_dot2_f32_bf16 v20, v241, v57, v20
  v_dot2_f32_bf16 v20, v242, v58, v20
  v_dot2_f32_bf16 v20, v243, v59, v20
  v_dot2_f32_bf16 v21, v244, v56, 0
  v_dot2_f32_bf16 v21, v245, v57, v21
  v_dot2_f32_bf16 v21, v246, v58, v21
  v_dot2_f32_bf16 v21, v247, v59, v21
  v_dot2_f32_bf16 v22, v248, v56, 0
  v_dot2_f32_bf16 v22, v249, v57, v22
  v_dot2_f32_bf16 v22, v250, v58, v22
  v_dot2_f32_bf16 v22, v251, v59, v22
  v_dot2_f32_bf16 v23, v252, v56, 0
  v_dot2_f32_bf16 v23, v253, v57, v23
  v_dot2_f32_bf16 v23, v254, v58, v23
  v_dot2_f32_bf16 v23, v255, v59, v23
  v_add_f32_dpp v24, v20, v20 row_ror:8 row_mask:0xf bank_mask:0x3
  v_add_f32_dpp v25, v22, v22 row_ror:8 row_mask:0xf bank_mask:0x3
  v_add_f32_dpp v24, v21, v21 row_ror:8 row_mask:0xf bank_mask:0xc
  v_add_f32_dpp v25, v23, v23 row_ror:8 row_mask:0xf bank_mask:0xc
  s_nop 0
  v_add_f32_dpp v103, v24, v24 row_half_mirror row_mask:0xf bank_mask:0x5
  v_add_f32_dpp v103, v25, v25 row_half_mirror row_mask:0xf bank_mask:0xa
  s_nop 1
  v_add_f32_dpp v103, v103, v103 quad_perm:[1,0,3,2] row_mask:0xf bank_mask:0xf
  s_nop 1
  v_add_f32_dpp v103, v103, v103 quad_perm:[2,3,0,1] row_mask:0xf bank_mask:0xf
  v_cvt_pk_bf16_f32 v26, v102, v103
  v_lshlrev_b32 v102, 16, v26
  v_and_b32 v103, 0xffff0000, v26
  v_mul_f32 v102, 0x3db504f3, v102
  v_mul_f32 v103, 0x3db504f3, v103
  v_cvt_pk_bf16_f32 v26, v102, v103
  v_lshlrev_b32 v102, 16, v26
  v_and_b32 v103, 0xffff0000, v26
  v_max3_f32 v44, v96, v97, v98
  v_max3_f32 v44, v44, v99, v100
  v_max3_f32 v44, v44, v101, v102
  v_max_f32 v44, v44, v103
  s_nop 1
  v_max_f32_dpp v44, v44, v44 row_ror:4 row_mask:0xf bank_mask:0xf
  s_nop 1
  v_max_f32_dpp v44, v44, v44 row_ror:8 row_mask:0xf bank_mask:0xf
  s_nop 0
  v_readlane_b32 s12, v44, 0
  v_readlane_b32 s13, v44, 16
  v_readlane_b32 s14, v44, 32
  v_readlane_b32 s15, v44, 48
  v_mov_b32 v46, s12
  v_max_f32 v46, s13, v46
  v_max_f32 v46, s14, v46
  v_max_f32 v46, s15, v46
  v_sub_f32 v12, v96, v46
  v_mul_f32 v12, 0x3fb8aa3b, v12
  v_exp_f32 v12, v12
  v_sub_f32 v13, v97, v46
  v_mul_f32 v13, 0x3fb8aa3b, v13
  v_exp_f32 v13, v13
  v_sub_f32 v14, v98, v46
  v_mul_f32 v14, 0x3fb8aa3b, v14
  v_exp_f32 v14, v14
  v_sub_f32 v15, v99, v46
  v_mul_f32 v15, 0x3fb8aa3b, v15
  v_exp_f32 v15, v15
  v_sub_f32 v16, v100, v46
  v_mul_f32 v16, 0x3fb8aa3b, v16
  v_exp_f32 v16, v16
  v_sub_f32 v17, v101, v46
  v_mul_f32 v17, 0x3fb8aa3b, v17
  v_exp_f32 v17, v17
  v_sub_f32 v18, v102, v46
  v_mul_f32 v18, 0x3fb8aa3b, v18
  v_exp_f32 v18, v18
  v_sub_f32 v19, v103, v46
  v_mul_f32 v19, 0x3fb8aa3b, v19
  v_exp_f32 v19, v19
  s_nop 0
  v_add_f32 v12, v12, v16
  v_add_f32 v13, v13, v17
  v_add_f32 v14, v14, v18
  v_add_f32 v15, v15, v19
  v_add_f32 v12, v12, v14
  v_add_f32 v13, v13, v15
  v_add_f32 v12, v12, v13
  s_nop 1
  v_add_f32_dpp v12, v12, v12 row_ror:4 row_mask:0xf bank_mask:0xf
  s_nop 1
  v_add_f32_dpp v12, v12, v12 row_ror:8 row_mask:0xf bank_mask:0xf
  s_nop 0
  v_readlane_b32 s12, v12, 0
  v_readlane_b32 s13, v12, 16
  v_readlane_b32 s14, v12, 32
  v_readlane_b32 s15, v12, 48
  v_mov_b32 v47, s12
  v_add_f32 v47, s13, v47
  v_add_f32 v47, s14, v47
  v_add_f32 v47, s15, v47
  s_lshl_b32 s9, s3, 3
  s_add_u32 s9, s9, 114688
  v_mov_b32 v7, s9
  ds_write_b64 v7, v[46:47]
  v_mov_b32 v7, 149132
  v_mov_b32 v8, 1
  s_mov_b64 s[10:11], exec
  s_mov_b64 exec, 1
  ds_add_rtn_u32 v8, v7, v8
  s_mov_b64 exec, s[10:11]
  s_waitcnt lgkmcnt(0)
  v_readfirstlane_b32 s9, v8
  s_cmp_lg_u32 s9, 7
  s_cbranch_scc1 L_notlastc
  v_mov_b32 v8, 114688
  ds_read_b128 v[12:15], v8 offset:0
  ds_read_b128 v[16:19], v8 offset:16
  ds_read_b128 v[20:23], v8 offset:32
  ds_read_b128 v[24:27], v8 offset:48
  s_mov_b32 s14, 0
  v_lshlrev_b32 v51, 5, v1
  v_add_u32 v51, 0x154000, v51
L_chk_5:
  v_cmp_eq_u32 vcc, s98, v88
  v_cmp_eq_u32 s[10:11], s99, v89
  s_and_b64 vcc, vcc, s[10:11]
  v_cmp_eq_u32 s[10:11], s98, v90
  s_and_b64 vcc, vcc, s[10:11]
  v_cmp_eq_u32 s[10:11], s99, v91
  s_and_b64 vcc, vcc, s[10:11]
  v_cmp_eq_u32 s[10:11], s98, v92
  s_and_b64 vcc, vcc, s[10:11]
  v_cmp_eq_u32 s[10:11], s99, v93
  s_and_b64 vcc, vcc, s[10:11]
  v_cmp_eq_u32 s[10:11], s98, v94
  s_and_b64 vcc, vcc, s[10:11]
  v_cmp_eq_u32 s[10:11], s99, v95
  s_and_b64 vcc, vcc, s[10:11]
  s_cmp_eq_u64 vcc, exec
  s_cbranch_scc1 L_chkd_6
  s_sleep 2
  buffer_load_dwordx4 v[88:91], v51, s[80:83], 0 offen sc1
  buffer_load_dwordx4 v[92:95], v51, s[80:83], 0 offen offset:16 sc1
  s_waitcnt vmcnt(0)
  s_add_u32 s14, s14, 1
  s_cmp_lt_u32 s14, 400000
  s_cbranch_scc1 L_chk_5
L_chkd_6:
  s_waitcnt lgkmcnt(0)
  v_max3_f32 v44, v12, v14, v16
  v_max3_f32 v44, v44, v18, v20
  v_max3_f32 v44, v44, v22, v24
  v_max_f32 v46, v44, v26
  v_sub_f32 v28, v12, v46
  v_mul_f32 v28, 0x3fb8aa3b, v28
  v_exp_f32 v28, v28
  v_sub_f32 v29, v14, v46
  v_mul_f32 v29, 0x3fb8aa3b, v29
  v_exp_f32 v29, v29
  v_sub_f32 v30, v16, v46
  v_mul_f32 v30, 0x3fb8aa3b, v30
  v_exp_f32 v30, v30
  v_sub_f32 v31, v18, v46
  v_mul_f32 v31, 0x3fb8aa3b, v31
  v_exp_f32 v31, v31
  v_sub_f32 v32, v20, v46
  v_mul_f32 v32, 0x3fb8aa3b, v32
  v_exp_f32 v32, v32
  v_sub_f32 v33, v22, v46
  v_mul_f32 v33, 0x3fb8aa3b, v33
  v_exp_f32 v33, v33
  v_sub_f32 v34, v24, v46
  v_mul_f32 v34, 0x3fb8aa3b, v34
  v_exp_f32 v34, v34
  v_sub_f32 v35, v26, v46
  v_mul_f32 v35, 0x3fb8aa3b, v35
  v_exp_f32 v35, v35
  s_nop 0
  v_mul_f32 v47, v13, v28
  v_fmac_f32 v47, v15, v29
  v_fmac_f32 v47, v17, v30
  v_fmac_f32 v47, v19, v31
  v_fmac_f32 v47, v21, v32
  v_fmac_f32 v47, v23, v33
  v_fmac_f32 v47, v25, v34
  v_fmac_f32 v47, v27, v35
  s_lshl_b32 s9, s7, 10
  v_mov_b32 v7, s9
  v_mov_b32 v8, 114768
  v_mov_b32 v9, 8
  v_mov_b32 v10, 149132
  s_mov_b64 s[10:11], exec
  s_mov_b64 exec, 1
  buffer_store_dwordx2 v[46:47], v7, s[80:83], 0 offen offset:512 sc1
  ds_write_b64 v8, v[46:47]
  ds_add_u32 v10, v9
  s_mov_b64 exec, s[10:11]
L_notlastc:
  s_setprio 0
  s_movk_i32 s15, 0
  s_add_u32 m0, s101, 0
  s_nop 0
  buffer_load_dwordx4 v4, s[44:47], s15 offen nt lds
  s_setprio 1
  buffer_load_dwordx4 v[132:135], v4, s[44:47], s84 offen offset:1024 nt
  buffer_load_dwordx4 v[136:139], v4, s[44:47], s84 offen offset:2048 nt
  buffer_load_dwordx4 v[140:143], v4, s[44:47], s84 offen offset:3072 nt
  buffer_load_dwordx4 v[144:147], v4, s[44:47], s85 offen offset:0 nt
  buffer_load_dwordx4 v[148:151], v4, s[44:47], s85 offen offset:1024 nt
  buffer_load_dwordx4 v[152:155], v4, s[44:47], s85 offen offset:2048 nt
  buffer_load_dwordx4 v[156:159], v4, s[44:47], s85 offen offset:3072 nt
  buffer_load_dwordx4 v[160:163], v4, s[44:47], s86 offen offset:0 nt
  buffer_load_dwordx4 v[164:167], v4, s[44:47], s86 offen offset:1024 nt
  buffer_load_dwordx4 v[168:171], v4, s[44:47], s86 offen offset:2048 nt
  buffer_load_dwordx4 v[172:175], v4, s[44:47], s86 offen offset:3072 nt
  buffer_load_dwordx4 v[176:179], v4, s[44:47], s87 offen offset:0 nt
  buffer_load_dwordx4 v[180:183], v4, s[44:47], s87 offen offset:1024 nt
  buffer_load_dwordx4 v[184:187], v4, s[44:47], s87 offen offset:2048 nt
  buffer_load_dwordx4 v[188:191], v4, s[44:47], s87 offen offset:3072 nt
  buffer_load_dwordx4 v[192:195], v4, s[44:47], s88 offen offset:0 nt
  buffer_load_dwordx4 v[196:199], v4, s[44:47], s88 offen offset:1024 nt
  buffer_load_dwordx4 v[200:203], v4, s[44:47], s88 offen offset:2048 nt
  buffer_load_dwordx4 v[204:207], v4, s[44:47], s88 offen offset:3072 nt
  buffer_load_dwordx4 v[208:211], v4, s[44:47], s89 offen offset:0 nt
  buffer_load_dwordx4 v[212:215], v4, s[44:47], s89 offen offset:1024 nt
  buffer_load_dwordx4 v[216:219], v4, s[44:47], s89 offen offset:2048 nt
  buffer_load_dwordx4 v[220:223], v4, s[44:47], s89 offen offset:3072 nt
  buffer_load_dwordx4 v[224:227], v4, s[44:47], s90 offen offset:0 nt
  buffer_load_dwordx4 v[228:231], v4, s[44:47], s90 offen offset:1024 nt
  buffer_load_dwordx4 v[232:235], v4, s[44:47], s90 offen offset:2048 nt
  buffer_load_dwordx4 v[236:239], v4, s[44:47], s90 offen offset:3072 nt
  buffer_load_dwordx4 v[240:243], v4, s[44:47], s91 offen offset:0 nt
  buffer_load_dwordx4 v[244:247], v4, s[44:47], s91 offen offset:1024 nt
  buffer_load_dwordx4 v[248:251], v4, s[44:47], s91 offen offset:2048 nt
  buffer_load_dwordx4 v[252:255], v4, s[44:47], s91 offen offset:3072 nt
  s_lshl_b32 s9, s2, 10
  v_mov_b32 v48, s9
  v_mov_b32 v50, 149132
L_cslow:
  s_setprio 1
  v_mov_b32 v50, 149132
  s_mov_b32 s14, 0
L_lml_7:
  ds_read_b32 v49, v50
  s_waitcnt lgkmcnt(0)
  v_readfirstlane_b32 s9, v49
  s_cmp_ge_u32 s9, 16
  s_cbranch_scc1 L_lmld_8
  s_sleep 1
  s_add_u32 s14, s14, 1
  s_cmp_lt_u32 s14, 1600000
  s_cbranch_scc1 L_lml_7
L_lmld_8:
  s_mov_b32 s14, 0
L_pollx:
  buffer_load_dwordx2 v[16:17], v48, s[80:83], 0 offen offset:512 sc1
  s_waitcnt vmcnt(0)
  v_cmp_eq_u32 vcc, -1, v16
  v_cmp_eq_u32 s[10:11], -1, v17
  s_or_b64 vcc, vcc, s[10:11]
  s_cmp_eq_u64 vcc, 0
  s_cbranch_scc1 L_pollx_done
  s_add_u32 s14, s14, 1
  s_cmp_lt_u32 s14, 400000
  s_cbranch_scc1 L_pollx
L_pollx_done:
  v_mov_b32 v8, 114768
  ds_read_b64 v[46:47], v8
  s_waitcnt lgkmcnt(0)
  v_max_f32 v40, v46, v16
  v_sub_f32 v41, v46, v40
  v_sub_f32 v42, v16, v40
  v_mul_f32 v41, 0x3fb8aa3b, v41
  v_mul_f32 v42, 0x3fb8aa3b, v42
  v_exp_f32 v41, v41
  v_exp_f32 v42, v42
  s_nop 0
  v_mul_f32 v47, v47, v41
  v_fmac_f32 v47, v17, v42
  v_rcp_f32 v41, v47
  v_mov_b32 v8, 114752
  v_mov_b32 v9, 149120
  v_mov_b32 v10, 0x100
  ds_write_b64 v8, v[40:41]
  s_mov_b64 s[10:11], exec
  s_mov_b64 exec, 1
  ds_add_u32 v9, v10
  s_mov_b64 exec, s[10:11]
  s_branch L_pvend
L_pv3:
  v_mov_b32 v8, 114752
  ds_read_b64 v[46:47], v8
  s_waitcnt lgkmcnt(0)
  v_sub_f32 v96, v96, v46
  v_mul_f32 v96, 0x3fb8aa3b, v96
  v_exp_f32 v96, v96
  v_sub_f32 v97, v97, v46
  v_mul_f32 v97, 0x3fb8aa3b, v97
  v_exp_f32 v97, v97
  v_sub_f32 v98, v98, v46
  v_mul_f32 v98, 0x3fb8aa3b, v98
  v_exp_f32 v98, v98
  v_sub_f32 v99, v99, v46
  v_mul_f32 v99, 0x3fb8aa3b, v99
  v_exp_f32 v99, v99
  v_sub_f32 v100, v100, v46
  v_mul_f32 v100, 0x3fb8aa3b, v100
  v_exp_f32 v100, v100
  v_sub_f32 v101, v101, v46
  v_mul_f32 v101, 0x3fb8aa3b, v101
  v_exp_f32 v101, v101
  v_sub_f32 v102, v102, v46
  v_mul_f32 v102, 0x3fb8aa3b, v102
  v_exp_f32 v102, v102
  v_sub_f32 v103, v103, v46
  v_mul_f32 v103, 0x3fb8aa3b, v103
  v_exp_f32 v103, v103
  s_nop 0
  v_mul_f32 v96, v96, v47
  v_mul_f32 v97, v97, v47
  v_cvt_pk_bf16_f32 v45, v96, v97
  v_lshlrev_b32 v96, 16, v45
  v_and_b32 v97, 0xffff0000, v45
  v_mul_f32 v98, v98, v47
  v_mul_f32 v99, v99, v47
  v_cvt_pk_bf16_f32 v45, v98, v99
  v_lshlrev_b32 v98, 16, v45
  v_and_b32 v99, 0xffff0000, v45
  v_mul_f32 v100, v100, v47
  v_mul_f32 v101, v101, v47
  v_cvt_pk_bf16_f32 v45, v100, v101
  v_lshlrev_b32 v100, 16, v45
  v_and_b32 v101, 0xffff0000, v45
  v_mul_f32 v102, v102, v47
  v_mul_f32 v103, v103, v47
  v_cvt_pk_bf16_f32 v45, v102, v103
  v_lshlrev_b32 v102, 16, v45
  v_and_b32 v103, 0xffff0000, v45
  v_lshrrev_b32 v104, 16, v96
  v_lshrrev_b32 v105, 16, v97
  v_lshrrev_b32 v106, 16, v98
  v_lshrrev_b32 v107, 16, v99
  v_lshrrev_b32 v108, 16, v100
  v_lshrrev_b32 v109, 16, v101
  v_lshrrev_b32 v110, 16, v102
  v_lshrrev_b32 v111, 16, v103
  v_mov_b32 v12, 0
  v_mov_b32 v13, 0
  v_mov_b32 v14, 0
  v_mov_b32 v15, 0
  v_mov_b32 v16, 0
  v_mov_b32 v17, 0
  v_mov_b32 v18, 0
  v_mov_b32 v19, 0
  v_add_u32 v7, s101, v6
  ds_read_b128 v[128:131], v7 offset:0
  v_mov_b32_dpp v20, v104 row_newbcast:0 row_mask:0xf bank_mask:0xf
  v_mov_b32_dpp v21, v96 row_newbcast:0 row_mask:0xf bank_mask:0xf
  s_waitcnt lgkmcnt(0)
  v_dot2c_f32_bf16 v12, v128, v20
  v_dot2c_f32_bf16 v13, v128, v21
  v_dot2c_f32_bf16 v14, v129, v20
  v_dot2c_f32_bf16 v15, v129, v21
  v_dot2c_f32_bf16 v16, v130, v20
  v_dot2c_f32_bf16 v17, v130, v21
  v_dot2c_f32_bf16 v18, v131, v20
  v_dot2c_f32_bf16 v19, v131, v21
  v_mov_b32_dpp v22, v104 row_newbcast:8 row_mask:0xf bank_mask:0xf
  v_mov_b32_dpp v23, v96 row_newbcast:8 row_mask:0xf bank_mask:0xf
  v_dot2c_f32_bf16 v12, v132, v22
  v_dot2c_f32_bf16 v13, v132, v23
  v_dot2c_f32_bf16 v14, v133, v22
  v_dot2c_f32_bf16 v15, v133, v23
  v_dot2c_f32_bf16 v16, v134, v22
  v_dot2c_f32_bf16 v17, v134, v23
  v_dot2c_f32_bf16 v18, v135, v22
  v_dot2c_f32_bf16 v19, v135, v23
  v_mov_b32_dpp v20, v104 row_newbcast:4 row_mask:0xf bank_mask:0xf
  v_mov_b32_dpp v21, v96 row_newbcast:4 row_mask:0xf bank_mask:0xf
  v_dot2c_f32_bf16 v12, v136, v20
  v_dot2c_f32_bf16 v13, v136, v21
  v_dot2c_f32_bf16 v14, v137, v20
  v_dot2c_f32_bf16 v15, v137, v21
  v_dot2c_f32_bf16 v16, v138, v20
  v_dot2c_f32_bf16 v17, v138, v21
  v_dot2c_f32_bf16 v18, v139, v20
  v_dot2c_f32_bf16 v19, v139, v21
  buffer_load_dwordx4 v[184:187], v4, s[44:47], s87 offen offset:2048 nt
  v_mov_b32_dpp v22, v104 row_newbcast:12 row_mask:0xf bank_mask:0xf
  v_mov_b32_dpp v23, v96 row_newbcast:12 row_mask:0xf bank_mask:0xf
  v_dot2c_f32_bf16 v12, v140, v22
  v_dot2c_f32_bf16 v13, v140, v23
  v_dot2c_f32_bf16 v14, v141, v22
  v_dot2c_f32_bf16 v15, v141, v23
  v_dot2c_f32_bf16 v16, v142, v22
  v_dot2c_f32_bf16 v17, v142, v23
  v_dot2c_f32_bf16 v18, v143, v22
  v_dot2c_f32_bf16 v19, v143, v23
  buffer_load_dwordx4 v[188:191], v4, s[44:47], s87 offen offset:3072 nt
  v_mov_b32_dpp v20, v105 row_newbcast:0 row_mask:0xf bank_mask:0xf
  v_mov_b32_dpp v21, v97 row_newbcast:0 row_mask:0xf bank_mask:0xf
  s_waitcnt vmcnt(11)
  v_dot2c_f32_bf16 v12, v144, v20
  v_dot2c_f32_bf16 v13, v144, v21
  v_dot2c_f32_bf16 v14, v145, v20
  v_dot2c_f32_bf16 v15, v145, v21
  v_dot2c_f32_bf16 v16, v146, v20
  v_dot2c_f32_bf16 v17, v146, v21
  v_dot2c_f32_bf16 v18, v147, v20
  v_dot2c_f32_bf16 v19, v147, v21
  buffer_load_dwordx4 v[192:195], v4, s[44:47], s88 offen offset:0 nt
  v_mov_b32_dpp v22, v105 row_newbcast:8 row_mask:0xf bank_mask:0xf
  v_mov_b32_dpp v23, v97 row_newbcast:8 row_mask:0xf bank_mask:0xf
  s_waitcnt vmcnt(11)
  v_dot2c_f32_bf16 v12, v148, v22
  v_dot2c_f32_bf16 v13, v148, v23
  v_dot2c_f32_bf16 v14, v149, v22
  v_dot2c_f32_bf16 v15, v149, v23
  v_dot2c_f32_bf16 v16, v150, v22
  v_dot2c_f32_bf16 v17, v150, v23
  v_dot2c_f32_bf16 v18, v151, v22
  v_dot2c_f32_bf16 v19, v151, v23
  buffer_load_dwordx4 v[196:199], v4, s[44:47], s88 offen offset:1024 nt
  v_mov_b32_dpp v20, v105 row_newbcast:4 row_mask:0xf bank_mask:0xf
  v_mov_b32_dpp v21, v97 row_newbcast:4 row_mask:0xf bank_mask:0xf
  s_waitcnt vmcnt(11)
  v_dot2c_f32_bf16 v12, v152, v20
  v_dot2c_f32_bf16 v13, v152, v21
  v_dot2c_f32_bf16 v14, v153, v20
  v_dot2c_f32_bf16 v15, v153, v21
  v_dot2c_f32_bf16 v16, v154, v20
  v_dot2c_f32_bf16 v17, v154, v21
  v_dot2c_f32_bf16 v18, v155, v20
  v_dot2c_f32_bf16 v19, v155, v21
  buffer_load_dwordx4 v[200:203], v4, s[44:47], s88 offen offset:2048 nt
  v_mov_b32_dpp v22, v105 row_newbcast:12 row_mask:0xf bank_mask:0xf
  v_mov_b32_dpp v23, v97 row_newbcast:12 row_mask:0xf bank_mask:0xf
  s_waitcnt vmcnt(11)
  v_dot2c_f32_bf16 v12, v156, v22
  v_dot2c_f32_bf16 v13, v156, v23
  v_dot2c_f32_bf16 v14, v157, v22
  v_dot2c_f32_bf16 v15, v157, v23
  v_dot2c_f32_bf16 v16, v158, v22
  v_dot2c_f32_bf16 v17, v158, v23
  v_dot2c_f32_bf16 v18, v159, v22
  v_dot2c_f32_bf16 v19, v159, v23
  buffer_load_dwordx4 v[204:207], v4, s[44:47], s88 offen offset:3072 nt
  v_mov_b32_dpp v20, v106 row_newbcast:0 row_mask:0xf bank_mask:0xf
  v_mov_b32_dpp v21, v98 row_newbcast:0 row_mask:0xf bank_mask:0xf
  s_waitcnt vmcnt(11)
  v_dot2c_f32_bf16 v12, v160, v20
  v_dot2c_f32_bf16 v13, v160, v21
  v_dot2c_f32_bf16 v14, v161, v20
  v_dot2c_f32_bf16 v15, v161, v21
  v_dot2c_f32_bf16 v16, v162, v20
  v_dot2c_f32_bf16 v17, v162, v21
  v_dot2c_f32_bf16 v18, v163, v20
  v_dot2c_f32_bf16 v19, v163, v21
  buffer_load_dwordx4 v[208:211], v4, s[44:47], s89 offen offset:0 nt
  v_mov_b32_dpp v22, v106 row_newbcast:8 row_mask:0xf bank_mask:0xf
  v_mov_b32_dpp v23, v98 row_newbcast:8 row_mask:0xf bank_mask:0xf
  s_waitcnt vmcnt(11)
  v_dot2c_f32_bf16 v12, v164, v22
  v_dot2c_f32_bf16 v13, v164, v23
  v_dot2c_f32_bf16 v14, v165, v22
  v_dot2c_f32_bf16 v15, v165, v23
  v_dot2c_f32_bf16 v16, v166, v22
  v_dot2c_f32_bf16 v17, v166, v23
  v_dot2c_f32_bf16 v18, v167, v22
  v_dot2c_f32_bf16 v19, v167, v23
  buffer_load_dwordx4 v[212:215], v4, s[44:47], s89 offen offset:1024 nt
  v_mov_b32_dpp v20, v106 row_newbcast:4 row_mask:0xf bank_mask:0xf
  v_mov_b32_dpp v21, v98 row_newbcast:4 row_mask:0xf bank_mask:0xf
  s_waitcnt vmcnt(11)
  v_dot2c_f32_bf16 v12, v168, v20
  v_dot2c_f32_bf16 v13, v168, v21
  v_dot2c_f32_bf16 v14, v169, v20
  v_dot2c_f32_bf16 v15, v169, v21
  v_dot2c_f32_bf16 v16, v170, v20
  v_dot2c_f32_bf16 v17, v170, v21
  v_dot2c_f32_bf16 v18, v171, v20
  v_dot2c_f32_bf16 v19, v171, v21
  buffer_load_dwordx4 v[216:219], v4, s[44:47], s89 offen offset:2048 nt
  v_mov_b32_dpp v22, v106 row_newbcast:12 row_mask:0xf bank_mask:0xf
  v_mov_b32_dpp v23, v98 row_newbcast:12 row_mask:0xf bank_mask:0xf
  s_waitcnt vmcnt(11)
  v_dot2c_f32_bf16 v12, v172, v22
  v_dot2c_f32_bf16 v13, v172, v23
  v_dot2c_f32_bf16 v14, v173, v22
  v_dot2c_f32_bf16 v15, v173, v23
  v_dot2c_f32_bf16 v16, v174, v22
  v_dot2c_f32_bf16 v17, v174, v23
  v_dot2c_f32_bf16 v18, v175, v22
  v_dot2c_f32_bf16 v19, v175, v23
  buffer_load_dwordx4 v[220:223], v4, s[44:47], s89 offen offset:3072 nt
  v_mov_b32_dpp v20, v107 row_newbcast:0 row_mask:0xf bank_mask:0xf
  v_mov_b32_dpp v21, v99 row_newbcast:0 row_mask:0xf bank_mask:0xf
  s_waitcnt vmcnt(11)
  v_dot2c_f32_bf16 v12, v176, v20
  v_dot2c_f32_bf16 v13, v176, v21
  v_dot2c_f32_bf16 v14, v177, v20
  v_dot2c_f32_bf16 v15, v177, v21
  v_dot2c_f32_bf16 v16, v178, v20
  v_dot2c_f32_bf16 v17, v178, v21
  v_dot2c_f32_bf16 v18, v179, v20
  v_dot2c_f32_bf16 v19, v179, v21
  buffer_load_dwordx4 v[224:227], v4, s[44:47], s90 offen offset:0 nt
  v_mov_b32_dpp v22, v107 row_newbcast:8 row_mask:0xf bank_mask:0xf
  v_mov_b32_dpp v23, v99 row_newbcast:8 row_mask:0xf bank_mask:0xf
  s_waitcnt vmcnt(11)
  v_dot2c_f32_bf16 v12, v180, v22
  v_dot2c_f32_bf16 v13, v180, v23
  v_dot2c_f32_bf16 v14, v181, v22
  v_dot2c_f32_bf16 v15, v181, v23
  v_dot2c_f32_bf16 v16, v182, v22
  v_dot2c_f32_bf16 v17, v182, v23
  v_dot2c_f32_bf16 v18, v183, v22
  v_dot2c_f32_bf16 v19, v183, v23
  buffer_load_dwordx4 v[228:231], v4, s[44:47], s90 offen offset:1024 nt
  v_mov_b32_dpp v20, v107 row_newbcast:4 row_mask:0xf bank_mask:0xf
  v_mov_b32_dpp v21, v99 row_newbcast:4 row_mask:0xf bank_mask:0xf
  s_waitcnt vmcnt(11)
  v_dot2c_f32_bf16 v12, v184, v20
  v_dot2c_f32_bf16 v13, v184, v21
  v_dot2c_f32_bf16 v14, v185, v20
  v_dot2c_f32_bf16 v15, v185, v21
  v_dot2c_f32_bf16 v16, v186, v20
  v_dot2c_f32_bf16 v17, v186, v21
  v_dot2c_f32_bf16 v18, v187, v20
  v_dot2c_f32_bf16 v19, v187, v21
  buffer_load_dwordx4 v[232:235], v4, s[44:47], s90 offen offset:2048 nt
  v_mov_b32_dpp v22, v107 row_newbcast:12 row_mask:0xf bank_mask:0xf
  v_mov_b32_dpp v23, v99 row_newbcast:12 row_mask:0xf bank_mask:0xf
  s_waitcnt vmcnt(11)
  v_dot2c_f32_bf16 v12, v188, v22
  v_dot2c_f32_bf16 v13, v188, v23
  v_dot2c_f32_bf16 v14, v189, v22
  v_dot2c_f32_bf16 v15, v189, v23
  v_dot2c_f32_bf16 v16, v190, v22
  v_dot2c_f32_bf16 v17, v190, v23
  v_dot2c_f32_bf16 v18, v191, v22
  v_dot2c_f32_bf16 v19, v191, v23
  buffer_load_dwordx4 v[236:239], v4, s[44:47], s90 offen offset:3072 nt
  v_mov_b32_dpp v20, v108 row_newbcast:0 row_mask:0xf bank_mask:0xf
  v_mov_b32_dpp v21, v100 row_newbcast:0 row_mask:0xf bank_mask:0xf
  s_waitcnt vmcnt(11)
  v_dot2c_f32_bf16 v12, v192, v20
  v_dot2c_f32_bf16 v13, v192, v21
  v_dot2c_f32_bf16 v14, v193, v20
  v_dot2c_f32_bf16 v15, v193, v21
  v_dot2c_f32_bf16 v16, v194, v20
  v_dot2c_f32_bf16 v17, v194, v21
  v_dot2c_f32_bf16 v18, v195, v20
  v_dot2c_f32_bf16 v19, v195, v21
  buffer_load_dwordx4 v[240:243], v4, s[44:47], s91 offen offset:0 nt
  v_mov_b32_dpp v22, v108 row_newbcast:8 row_mask:0xf bank_mask:0xf
  v_mov_b32_dpp v23, v100 row_newbcast:8 row_mask:0xf bank_mask:0xf
  s_waitcnt vmcnt(11)
  v_dot2c_f32_bf16 v12, v196, v22
  v_dot2c_f32_bf16 v13, v196, v23
  v_dot2c_f32_bf16 v14, v197, v22
  v_dot2c_f32_bf16 v15, v197, v23
  v_dot2c_f32_bf16 v16, v198, v22
  v_dot2c_f32_bf16 v17, v198, v23
  v_dot2c_f32_bf16 v18, v199, v22
  v_dot2c_f32_bf16 v19, v199, v23
  buffer_load_dwordx4 v[244:247], v4, s[44:47], s91 offen offset:1024 nt
  v_mov_b32_dpp v20, v108 row_newbcast:4 row_mask:0xf bank_mask:0xf
  v_mov_b32_dpp v21, v100 row_newbcast:4 row_mask:0xf bank_mask:0xf
  s_waitcnt vmcnt(11)
  v_dot2c_f32_bf16 v12, v200, v20
  v_dot2c_f32_bf16 v13, v200, v21
  v_dot2c_f32_bf16 v14, v201, v20
  v_dot2c_f32_bf16 v15, v201, v21
  v_dot2c_f32_bf16 v16, v202, v20
  v_dot2c_f32_bf16 v17, v202, v21
  v_dot2c_f32_bf16 v18, v203, v20
  v_dot2c_f32_bf16 v19, v203, v21
  buffer_load_dwordx4 v[248:251], v4, s[44:47], s91 offen offset:2048 nt
  v_mov_b32_dpp v22, v108 row_newbcast:12 row_mask:0xf bank_mask:0xf
  v_mov_b32_dpp v23, v100 row_newbcast:12 row_mask:0xf bank_mask:0xf
  s_waitcnt vmcnt(11)
  v_dot2c_f32_bf16 v12, v204, v22
  v_dot2c_f32_bf16 v13, v204, v23
  v_dot2c_f32_bf16 v14, v205, v22
  v_dot2c_f32_bf16 v15, v205, v23
  v_dot2c_f32_bf16 v16, v206, v22
  v_dot2c_f32_bf16 v17, v206, v23
  v_dot2c_f32_bf16 v18, v207, v22
  v_dot2c_f32_bf16 v19, v207, v23
  buffer_load_dwordx4 v[252:255], v4, s[44:47], s91 offen offset:3072 nt
  v_mov_b32_dpp v20, v109 row_newbcast:0 row_mask:0xf bank_mask:0xf
  v_mov_b32_dpp v21, v101 row_newbcast:0 row_mask:0xf bank_mask:0xf
  s_waitcnt vmcnt(11)
  v_dot2c_f32_bf16 v12, v208, v20
  v_dot2c_f32_bf16 v13, v208, v21
  v_dot2c_f32_bf16 v14, v209, v20
  v_dot2c_f32_bf16 v15, v209, v21
  v_dot2c_f32_bf16 v16, v210, v20
  v_dot2c_f32_bf16 v17, v210, v21
  v_dot2c_f32_bf16 v18, v211, v20
  v_dot2c_f32_bf16 v19, v211, v21
  v_mov_b32_dpp v22, v109 row_newbcast:8 row_mask:0xf bank_mask:0xf
  v_mov_b32_dpp v23, v101 row_newbcast:8 row_mask:0xf bank_mask:0xf
  s_waitcnt vmcnt(10)
  v_dot2c_f32_bf16 v12, v212, v22
  v_dot2c_f32_bf16 v13, v212, v23
  v_dot2c_f32_bf16 v14, v213, v22
  v_dot2c_f32_bf16 v15, v213, v23
  v_dot2c_f32_bf16 v16, v214, v22
  v_dot2c_f32_bf16 v17, v214, v23
  v_dot2c_f32_bf16 v18, v215, v22
  v_dot2c_f32_bf16 v19, v215, v23
  v_mov_b32_dpp v20, v109 row_newbcast:4 row_mask:0xf bank_mask:0xf
  v_mov_b32_dpp v21, v101 row_newbcast:4 row_mask:0xf bank_mask:0xf
  s_waitcnt vmcnt(9)
  v_dot2c_f32_bf16 v12, v216, v20
  v_dot2c_f32_bf16 v13, v216, v21
  v_dot2c_f32_bf16 v14, v217, v20
  v_dot2c_f32_bf16 v15, v217, v21
  v_dot2c_f32_bf16 v16, v218, v20
  v_dot2c_f32_bf16 v17, v218, v21
  v_dot2c_f32_bf16 v18, v219, v20
  v_dot2c_f32_bf16 v19, v219, v21
  v_mov_b32_dpp v22, v109 row_newbcast:12 row_mask:0xf bank_mask:0xf
  v_mov_b32_dpp v23, v101 row_newbcast:12 row_mask:0xf bank_mask:0xf
  s_waitcnt vmcnt(8)
  v_dot2c_f32_bf16 v12, v220, v22
  v_dot2c_f32_bf16 v13, v220, v23
  v_dot2c_f32_bf16 v14, v221, v22
  v_dot2c_f32_bf16 v15, v221, v23
  v_dot2c_f32_bf16 v16, v222, v22
  v_dot2c_f32_bf16 v17, v222, v23
  v_dot2c_f32_bf16 v18, v223, v22
  v_dot2c_f32_bf16 v19, v223, v23
  v_mov_b32_dpp v20, v110 row_newbcast:0 row_mask:0xf bank_mask:0xf
  v_mov_b32_dpp v21, v102 row_newbcast:0 row_mask:0xf bank_mask:0xf
  s_waitcnt vmcnt(7)
  v_dot2c_f32_bf16 v12, v224, v20
  v_dot2c_f32_bf16 v13, v224, v21
  v_dot2c_f32_bf16 v14, v225, v20
  v_dot2c_f32_bf16 v15, v225, v21
  v_dot2c_f32_bf16 v16, v226, v20
  v_dot2c_f32_bf16 v17, v226, v21
  v_dot2c_f32_bf16 v18, v227, v20
  v_dot2c_f32_bf16 v19, v227, v21
  v_mov_b32_dpp v22, v110 row_newbcast:8 row_mask:0xf bank_mask:0xf
  v_mov_b32_dpp v23, v102 row_newbcast:8 row_mask:0xf bank_mask:0xf
  s_waitcnt vmcnt(6)
  v_dot2c_f32_bf16 v12, v228, v22
  v_dot2c_f32_bf16 v13, v228, v23
  v_dot2c_f32_bf16 v14, v229, v22
  v_dot2c_f32_bf16 v15, v229, v23
  v_dot2c_f32_bf16 v16, v230, v22
  v_dot2c_f32_bf16 v17, v230, v23
  v_dot2c_f32_bf16 v18, v231, v22
  v_dot2c_f32_bf16 v19, v231, v23
  v_mov_b32_dpp v20, v110 row_newbcast:4 row_mask:0xf bank_mask:0xf
  v_mov_b32_dpp v21, v102 row_newbcast:4 row_mask:0xf bank_mask:0xf
  s_waitcnt vmcnt(5)
  v_dot2c_f32_bf16 v12, v232, v20
  v_dot2c_f32_bf16 v13, v232, v21
  v_dot2c_f32_bf16 v14, v233, v20
  v_dot2c_f32_bf16 v15, v233, v21
  v_dot2c_f32_bf16 v16, v234, v20
  v_dot2c_f32_bf16 v17, v234, v21
  v_dot2c_f32_bf16 v18, v235, v20
  v_dot2c_f32_bf16 v19, v235, v21
  v_mov_b32_dpp v22, v110 row_newbcast:12 row_mask:0xf bank_mask:0xf
  v_mov_b32_dpp v23, v102 row_newbcast:12 row_mask:0xf bank_mask:0xf
  s_waitcnt vmcnt(4)
  v_dot2c_f32_bf16 v12, v236, v22
  v_dot2c_f32_bf16 v13, v236, v23
  v_dot2c_f32_bf16 v14, v237, v22
  v_dot2c_f32_bf16 v15, v237, v23
  v_dot2c_f32_bf16 v16, v238, v22
  v_dot2c_f32_bf16 v17, v238, v23
  v_dot2c_f32_bf16 v18, v239, v22
  v_dot2c_f32_bf16 v19, v239, v23
  v_mov_b32_dpp v20, v111 row_newbcast:0 row_mask:0xf bank_mask:0xf
  v_mov_b32_dpp v21, v103 row_newbcast:0 row_mask:0xf bank_mask:0xf
  s_waitcnt vmcnt(3)
  v_dot2c_f32_bf16 v12, v240, v20
  v_dot2c_f32_bf16 v13, v240, v21
  v_dot2c_f32_bf16 v14, v241, v20
  v_dot2c_f32_bf16 v15, v241, v21
  v_dot2c_f32_bf16 v16, v242, v20
  v_dot2c_f32_bf16 v17, v242, v21
  v_dot2c_f32_bf16 v18, v243, v20
  v_dot2c_f32_bf16 v19, v243, v21
  v_mov_b32_dpp v22, v111 row_newbcast:8 row_mask:0xf bank_mask:0xf
  v_mov_b32_dpp v23, v103 row_newbcast:8 row_mask:0xf bank_mask:0xf
  s_waitcnt vmcnt(2)
  v_dot2c_f32_bf16 v12, v244, v22
  v_dot2c_f32_bf16 v13, v244, v23
  v_dot2c_f32_bf16 v14, v245, v22
  v_dot2c_f32_bf16 v15, v245, v23
  v_dot2c_f32_bf16 v16, v246, v22
  v_dot2c_f32_bf16 v17, v246, v23
  v_dot2c_f32_bf16 v18, v247, v22
  v_dot2c_f32_bf16 v19, v247, v23
  v_mov_b32_dpp v20, v111 row_newbcast:4 row_mask:0xf bank_mask:0xf
  v_mov_b32_dpp v21, v103 row_newbcast:4 row_mask:0xf bank_mask:0xf
  s_waitcnt vmcnt(1)
  v_dot2c_f32_bf16 v12, v248, v20
  v_dot2c_f32_bf16 v13, v248, v21
  v_dot2c_f32_bf16 v14, v249, v20
  v_dot2c_f32_bf16 v15, v249, v21
  v_dot2c_f32_bf16 v16, v250, v20
  v_dot2c_f32_bf16 v17, v250, v21
  v_dot2c_f32_bf16 v18, v251, v20
  v_dot2c_f32_bf16 v19, v251, v21
  v_mov_b32_dpp v22, v111 row_newbcast:12 row_mask:0xf bank_mask:0xf
  v_mov_b32_dpp v23, v103 row_newbcast:12 row_mask:0xf bank_mask:0xf
  s_waitcnt vmcnt(0)
  v_dot2c_f32_bf16 v12, v252, v22
  v_dot2c_f32_bf16 v13, v252, v23
  v_dot2c_f32_bf16 v14, v253, v22
  v_dot2c_f32_bf16 v15, v253, v23
  v_dot2c_f32_bf16 v16, v254, v22
  v_dot2c_f32_bf16 v17, v254, v23
  v_dot2c_f32_bf16 v18, v255, v22
  v_dot2c_f32_bf16 v19, v255, v23
  s_branch L_tail
L_pv6:
  v_mov_b32 v8, 114752
  ds_read_b64 v[46:47], v8
  s_waitcnt lgkmcnt(0)
  v_sub_f32 v96, v96, v46
  v_mul_f32 v96, 0x3fb8aa3b, v96
  v_exp_f32 v96, v96
  v_sub_f32 v97, v97, v46
  v_mul_f32 v97, 0x3fb8aa3b, v97
  v_exp_f32 v97, v97
  v_sub_f32 v98, v98, v46
  v_mul_f32 v98, 0x3fb8aa3b, v98
  v_exp_f32 v98, v98
  v_sub_f32 v99, v99, v46
  v_mul_f32 v99, 0x3fb8aa3b, v99
  v_exp_f32 v99, v99
  v_sub_f32 v100, v100, v46
  v_mul_f32 v100, 0x3fb8aa3b, v100
  v_exp_f32 v100, v100
  v_sub_f32 v101, v101, v46
  v_mul_f32 v101, 0x3fb8aa3b, v101
  v_exp_f32 v101, v101
  v_sub_f32 v102, v102, v46
  v_mul_f32 v102, 0x3fb8aa3b, v102
  v_exp_f32 v102, v102
  v_sub_f32 v103, v103, v46
  v_mul_f32 v103, 0x3fb8aa3b, v103
  v_exp_f32 v103, v103
  s_nop 0
  v_mul_f32 v96, v96, v47
  v_mul_f32 v97, v97, v47
  v_cvt_pk_bf16_f32 v45, v96, v97
  v_lshlrev_b32 v96, 16, v45
  v_and_b32 v97, 0xffff0000, v45
  v_mul_f32 v98, v98, v47
  v_mul_f32 v99, v99, v47
  v_cvt_pk_bf16_f32 v45, v98, v99
  v_lshlrev_b32 v98, 16, v45
  v_and_b32 v99, 0xffff0000, v45
  v_mul_f32 v100, v100, v47
  v_mul_f32 v101, v101, v47
  v_cvt_pk_bf16_f32 v45, v100, v101
  v_lshlrev_b32 v100, 16, v45
  v_and_b32 v101, 0xffff0000, v45
  v_mul_f32 v102, v102, v47
  v_mul_f32 v103, v103, v47
  v_cvt_pk_bf16_f32 v45, v102, v103
  v_lshlrev_b32 v102, 16, v45
  v_and_b32 v103, 0xffff0000, v45
  v_lshrrev_b32 v104, 16, v96
  v_lshrrev_b32 v105, 16, v97
  v_lshrrev_b32 v106, 16, v98
  v_lshrrev_b32 v107, 16, v99
  v_lshrrev_b32 v108, 16, v100
  v_lshrrev_b32 v109, 16, v101
  v_lshrrev_b32 v110, 16, v102
  v_lshrrev_b32 v111, 16, v103
  v_mov_b32 v12, 0
  v_mov_b32 v13, 0
  v_mov_b32 v14, 0
  v_mov_b32 v15, 0
  v_mov_b32 v16, 0
  v_mov_b32 v17, 0
  v_mov_b32 v18, 0
  v_mov_b32 v19, 0
  v_add_u32 v7, s101, v6
  ds_read_b128 v[128:131], v7 offset:0
  v_mov_b32_dpp v20, v104 row_newbcast:0 row_mask:0xf bank_mask:0xf
  v_mov_b32_dpp v21, v96 row_newbcast:0 row_mask:0xf bank_mask:0xf
  s_waitcnt lgkmcnt(0)
  v_dot2c_f32_bf16 v12, v128, v20
  v_dot2c_f32_bf16 v13, v128, v21
  v_dot2c_f32_bf16 v14, v129, v20
  v_dot2c_f32_bf16 v15, v129, v21
  v_dot2c_f32_bf16 v16, v130, v20
  v_dot2c_f32_bf16 v17, v130, v21
  v_dot2c_f32_bf16 v18, v131, v20
  v_dot2c_f32_bf16 v19, v131, v21
  v_mov_b32_dpp v22, v104 row_newbcast:8 row_mask:0xf bank_mask:0xf
  v_mov_b32_dpp v23, v96 row_newbcast:8 row_mask:0xf bank_mask:0xf
  v_dot2c_f32_bf16 v12, v132, v22
  v_dot2c_f32_bf16 v13, v132, v23
  v_dot2c_f32_bf16 v14, v133, v22
  v_dot2c_f32_bf16 v15, v133, v23
  v_dot2c_f32_bf16 v16, v134, v22
  v_dot2c_f32_bf16 v17, v134, v23
  v_dot2c_f32_bf16 v18, v135, v22
  v_dot2c_f32_bf16 v19, v135, v23
  v_mov_b32_dpp v20, v104 row_newbcast:4 row_mask:0xf bank_mask:0xf
  v_mov_b32_dpp v21, v96 row_newbcast:4 row_mask:0xf bank_mask:0xf
  v_dot2c_f32_bf16 v12, v136, v20
  v_dot2c_f32_bf16 v13, v136, v21
  v_dot2c_f32_bf16 v14, v137, v20
  v_dot2c_f32_bf16 v15, v137, v21
  v_dot2c_f32_bf16 v16, v138, v20
  v_dot2c_f32_bf16 v17, v138, v21
  v_dot2c_f32_bf16 v18, v139, v20
  v_dot2c_f32_bf16 v19, v139, v21
  v_mov_b32_dpp v22, v104 row_newbcast:12 row_mask:0xf bank_mask:0xf
  v_mov_b32_dpp v23, v96 row_newbcast:12 row_mask:0xf bank_mask:0xf
  v_dot2c_f32_bf16 v12, v140, v22
  v_dot2c_f32_bf16 v13, v140, v23
  v_dot2c_f32_bf16 v14, v141, v22
  v_dot2c_f32_bf16 v15, v141, v23
  v_dot2c_f32_bf16 v16, v142, v22
  v_dot2c_f32_bf16 v17, v142, v23
  v_dot2c_f32_bf16 v18, v143, v22
  v_dot2c_f32_bf16 v19, v143, v23
  v_mov_b32_dpp v20, v105 row_newbcast:0 row_mask:0xf bank_mask:0xf
  v_mov_b32_dpp v21, v97 row_newbcast:0 row_mask:0xf bank_mask:0xf
  v_dot2c_f32_bf16 v12, v144, v20
  v_dot2c_f32_bf16 v13, v144, v21
  v_dot2c_f32_bf16 v14, v145, v20
  v_dot2c_f32_bf16 v15, v145, v21
  v_dot2c_f32_bf16 v16, v146, v20
  v_dot2c_f32_bf16 v17, v146, v21
  v_dot2c_f32_bf16 v18, v147, v20
  v_dot2c_f32_bf16 v19, v147, v21
  v_mov_b32_dpp v22, v105 row_newbcast:8 row_mask:0xf bank_mask:0xf
  v_mov_b32_dpp v23, v97 row_newbcast:8 row_mask:0xf bank_mask:0xf
  v_dot2c_f32_bf16 v12, v148, v22
  v_dot2c_f32_bf16 v13, v148, v23
  v_dot2c_f32_bf16 v14, v149, v22
  v_dot2c_f32_bf16 v15, v149, v23
  v_dot2c_f32_bf16 v16, v150, v22
  v_dot2c_f32_bf16 v17, v150, v23
  v_dot2c_f32_bf16 v18, v151, v22
  v_dot2c_f32_bf16 v19, v151, v23
  buffer_load_dwordx4 v[196:199], v4, s[44:47], s88 offen offset:1024 nt
  v_mov_b32_dpp v20, v105 row_newbcast:4 row_mask:0xf bank_mask:0xf
  v_mov_b32_dpp v21, v97 row_newbcast:4 row_mask:0xf bank_mask:0xf
  v_dot2c_f32_bf16 v12, v152, v20
  v_dot2c_f32_bf16 v13, v152, v21
  v_dot2c_f32_bf16 v14, v153, v20
  v_dot2c_f32_bf16 v15, v153, v21
  v_dot2c_f32_bf16 v16, v154, v20
  v_dot2c_f32_bf16 v17, v154, v21
  v_dot2c_f32_bf16 v18, v155, v20
  v_dot2c_f32_bf16 v19, v155, v21
  buffer_load_dwordx4 v[200:203], v4, s[44:47], s88 offen offset:2048 nt
  v_mov_b32_dpp v22, v105 row_newbcast:12 row_mask:0xf bank_mask:0xf
  v_mov_b32_dpp v23, v97 row_newbcast:12 row_mask:0xf bank_mask:0xf
  s_waitcnt vmcnt(11)
  v_dot2c_f32_bf16 v12, v156, v22
  v_dot2c_f32_bf16 v13, v156, v23
  v_dot2c_f32_bf16 v14, v157, v22
  v_dot2c_f32_bf16 v15, v157, v23
  v_dot2c_f32_bf16 v16, v158, v22
  v_dot2c_f32_bf16 v17, v158, v23
  v_dot2c_f32_bf16 v18, v159, v22
  v_dot2c_f32_bf16 v19, v159, v23
  buffer_load_dwordx4 v[204:207], v4, s[44:47], s88 offen offset:3072 nt
  v_mov_b32_dpp v20, v106 row_newbcast:0 row_mask:0xf bank_mask:0xf
  v_mov_b32_dpp v21, v98 row_newbcast:0 row_mask:0xf bank_mask:0xf
  s_waitcnt vmcnt(11)
  v_dot2c_f32_bf16 v12, v160, v20
  v_dot2c_f32_bf16 v13, v160, v21
  v_dot2c_f32_bf16 v14, v161, v20
  v_dot2c_f32_bf16 v15, v161, v21
  v_dot2c_f32_bf16 v16, v162, v20
  v_dot2c_f32_bf16 v17, v162, v21
  v_dot2c_f32_bf16 v18, v163, v20
  v_dot2c_f32_bf16 v19, v163, v21
  buffer_load_dwordx4 v[208:211], v4, s[44:47], s89 offen offset:0 nt
  v_mov_b32_dpp v22, v106 row_newbcast:8 row_mask:0xf bank_mask:0xf
  v_mov_b32_dpp v23, v98 row_newbcast:8 row_mask:0xf bank_mask:0xf
  s_waitcnt vmcnt(11)
  v_dot2c_f32_bf16 v12, v164, v22
  v_dot2c_f32_bf16 v13, v164, v23
  v_dot2c_f32_bf16 v14, v165, v22
  v_dot2c_f32_bf16 v15, v165, v23
  v_dot2c_f32_bf16 v16, v166, v22
  v_dot2c_f32_bf16 v17, v166, v23
  v_dot2c_f32_bf16 v18, v167, v22
  v_dot2c_f32_bf16 v19, v167, v23
  buffer_load_dwordx4 v[212:215], v4, s[44:47], s89 offen offset:1024 nt
  v_mov_b32_dpp v20, v106 row_newbcast:4 row_mask:0xf bank_mask:0xf
  v_mov_b32_dpp v21, v98 row_newbcast:4 row_mask:0xf bank_mask:0xf
  s_waitcnt vmcnt(11)
  v_dot2c_f32_bf16 v12, v168, v20
  v_dot2c_f32_bf16 v13, v168, v21
  v_dot2c_f32_bf16 v14, v169, v20
  v_dot2c_f32_bf16 v15, v169, v21
  v_dot2c_f32_bf16 v16, v170, v20
  v_dot2c_f32_bf16 v17, v170, v21
  v_dot2c_f32_bf16 v18, v171, v20
  v_dot2c_f32_bf16 v19, v171, v21
  buffer_load_dwordx4 v[216:219], v4, s[44:47], s89 offen offset:2048 nt
  v_mov_b32_dpp v22, v106 row_newbcast:12 row_mask:0xf bank_mask:0xf
  v_mov_b32_dpp v23, v98 row_newbcast:12 row_mask:0xf bank_mask:0xf
  s_waitcnt vmcnt(11)
  v_dot2c_f32_bf16 v12, v172, v22
  v_dot2c_f32_bf16 v13, v172, v23
  v_dot2c_f32_bf16 v14, v173, v22
  v_dot2c_f32_bf16 v15, v173, v23
  v_dot2c_f32_bf16 v16, v174, v22
  v_dot2c_f32_bf16 v17, v174, v23
  v_dot2c_f32_bf16 v18, v175, v22
  v_dot2c_f32_bf16 v19, v175, v23
  buffer_load_dwordx4 v[220:223], v4, s[44:47], s89 offen offset:3072 nt
  v_mov_b32_dpp v20, v107 row_newbcast:0 row_mask:0xf bank_mask:0xf
  v_mov_b32_dpp v21, v99 row_newbcast:0 row_mask:0xf bank_mask:0xf
  s_waitcnt vmcnt(11)
  v_dot2c_f32_bf16 v12, v176, v20
  v_dot2c_f32_bf16 v13, v176, v21
  v_dot2c_f32_bf16 v14, v177, v20
  v_dot2c_f32_bf16 v15, v177, v21
  v_dot2c_f32_bf16 v16, v178, v20
  v_dot2c_f32_bf16 v17, v178, v21
  v_dot2c_f32_bf16 v18, v179, v20
  v_dot2c_f32_bf16 v19, v179, v21
  buffer_load_dwordx4 v[224:227], v4, s[44:47], s90 offen offset:0 nt
  v_mov_b32_dpp v22, v107 row_newbcast:8 row_mask:0xf bank_mask:0xf
  v_mov_b32_dpp v23, v99 row_newbcast:8 row_mask:0xf bank_mask:0xf
  s_waitcnt vmcnt(11)
  v_dot2c_f32_bf16 v12, v180, v22
  v_dot2c_f32_bf16 v13, v180, v23
  v_dot2c_f32_bf16 v14, v181, v22
  v_dot2c_f32_bf16 v15, v181, v23
  v_dot2c_f32_bf16 v16, v182, v22
  v_dot2c_f32_bf16 v17, v182, v23
  v_dot2c_f32_bf16 v18, v183, v22
  v_dot2c_f32_bf16 v19, v183, v23
  buffer_load_dwordx4 v[228:231], v4, s[44:47], s90 offen offset:1024 nt
  v_mov_b32_dpp v20, v107 row_newbcast:4 row_mask:0xf bank_mask:0xf
  v_mov_b32_dpp v21, v99 row_newbcast:4 row_mask:0xf bank_mask:0xf
  s_waitcnt vmcnt(11)
  v_dot2c_f32_bf16 v12, v184, v20
  v_dot2c_f32_bf16 v13, v184, v21
  v_dot2c_f32_bf16 v14, v185, v20
  v_dot2c_f32_bf16 v15, v185, v21
  v_dot2c_f32_bf16 v16, v186, v20
  v_dot2c_f32_bf16 v17, v186, v21
  v_dot2c_f32_bf16 v18, v187, v20
  v_dot2c_f32_bf16 v19, v187, v21
  buffer_load_dwordx4 v[232:235], v4, s[44:47], s90 offen offset:2048 nt
  v_mov_b32_dpp v22, v107 row_newbcast:12 row_mask:0xf bank_mask:0xf
  v_mov_b32_dpp v23, v99 row_newbcast:12 row_mask:0xf bank_mask:0xf
  s_waitcnt vmcnt(11)
  v_dot2c_f32_bf16 v12, v188, v22
  v_dot2c_f32_bf16 v13, v188, v23
  v_dot2c_f32_bf16 v14, v189, v22
  v_dot2c_f32_bf16 v15, v189, v23
  v_dot2c_f32_bf16 v16, v190, v22
  v_dot2c_f32_bf16 v17, v190, v23
  v_dot2c_f32_bf16 v18, v191, v22
  v_dot2c_f32_bf16 v19, v191, v23
  buffer_load_dwordx4 v[236:239], v4, s[44:47], s90 offen offset:3072 nt
  v_mov_b32_dpp v20, v108 row_newbcast:0 row_mask:0xf bank_mask:0xf
  v_mov_b32_dpp v21, v100 row_newbcast:0 row_mask:0xf bank_mask:0xf
  s_waitcnt vmcnt(11)
  v_dot2c_f32_bf16 v12, v192, v20
  v_dot2c_f32_bf16 v13, v192, v21
  v_dot2c_f32_bf16 v14, v193, v20
  v_dot2c_f32_bf16 v15, v193, v21
  v_dot2c_f32_bf16 v16, v194, v20
  v_dot2c_f32_bf16 v17, v194, v21
  v_dot2c_f32_bf16 v18, v195, v20
  v_dot2c_f32_bf16 v19, v195, v21
  buffer_load_dwordx4 v[240:243], v4, s[44:47], s91 offen offset:0 nt
  v_mov_b32_dpp v22, v108 row_newbcast:8 row_mask:0xf bank_mask:0xf
  v_mov_b32_dpp v23, v100 row_newbcast:8 row_mask:0xf bank_mask:0xf
  s_waitcnt vmcnt(11)
  v_dot2c_f32_bf16 v12, v196, v22
  v_dot2c_f32_bf16 v13, v196, v23
  v_dot2c_f32_bf16 v14, v197, v22
  v_dot2c_f32_bf16 v15, v197, v23
  v_dot2c_f32_bf16 v16, v198, v22
  v_dot2c_f32_bf16 v17, v198, v23
  v_dot2c_f32_bf16 v18, v199, v22
  v_dot2c_f32_bf16 v19, v199, v23
  buffer_load_dwordx4 v[244:247], v4, s[44:47], s91 offen offset:1024 nt
  v_mov_b32_dpp v20, v108 row_newbcast:4 row_mask:0xf bank_mask:0xf
  v_mov_b32_dpp v21, v100 row_newbcast:4 row_mask:0xf bank_mask:0xf
  s_waitcnt vmcnt(11)
  v_dot2c_f32_bf16 v12, v200, v20
  v_dot2c_f32_bf16 v13, v200, v21
  v_dot2c_f32_bf16 v14, v201, v20
  v_dot2c_f32_bf16 v15, v201, v21
  v_dot2c_f32_bf16 v16, v202, v20
  v_dot2c_f32_bf16 v17, v202, v21
  v_dot2c_f32_bf16 v18, v203, v20
  v_dot2c_f32_bf16 v19, v203, v21
  buffer_load_dwordx4 v[248:251], v4, s[44:47], s91 offen offset:2048 nt
  v_mov_b32_dpp v22, v108 row_newbcast:12 row_mask:0xf bank_mask:0xf
  v_mov_b32_dpp v23, v100 row_newbcast:12 row_mask:0xf bank_mask:0xf
  s_waitcnt vmcnt(11)
  v_dot2c_f32_bf16 v12, v204, v22
  v_dot2c_f32_bf16 v13, v204, v23
  v_dot2c_f32_bf16 v14, v205, v22
  v_dot2c_f32_bf16 v15, v205, v23
  v_dot2c_f32_bf16 v16, v206, v22
  v_dot2c_f32_bf16 v17, v206, v23
  v_dot2c_f32_bf16 v18, v207, v22
  v_dot2c_f32_bf16 v19, v207, v23
  buffer_load_dwordx4 v[252:255], v4, s[44:47], s91 offen offset:3072 nt
  v_mov_b32_dpp v20, v109 row_newbcast:0 row_mask:0xf bank_mask:0xf
  v_mov_b32_dpp v21, v101 row_newbcast:0 row_mask:0xf bank_mask:0xf
  s_waitcnt vmcnt(11)
  v_dot2c_f32_bf16 v12, v208, v20
  v_dot2c_f32_bf16 v13, v208, v21
  v_dot2c_f32_bf16 v14, v209, v20
  v_dot2c_f32_bf16 v15, v209, v21
  v_dot2c_f32_bf16 v16, v210, v20
  v_dot2c_f32_bf16 v17, v210, v21
  v_dot2c_f32_bf16 v18, v211, v20
  v_dot2c_f32_bf16 v19, v211, v21
  v_mov_b32_dpp v22, v109 row_newbcast:8 row_mask:0xf bank_mask:0xf
  v_mov_b32_dpp v23, v101 row_newbcast:8 row_mask:0xf bank_mask:0xf
  s_waitcnt vmcnt(10)
  v_dot2c_f32_bf16 v12, v212, v22
  v_dot2c_f32_bf16 v13, v212, v23
  v_dot2c_f32_bf16 v14, v213, v22
  v_dot2c_f32_bf16 v15, v213, v23
  v_dot2c_f32_bf16 v16, v214, v22
  v_dot2c_f32_bf16 v17, v214, v23
  v_dot2c_f32_bf16 v18, v215, v22
  v_dot2c_f32_bf16 v19, v215, v23
  v_mov_b32_dpp v20, v109 row_newbcast:4 row_mask:0xf bank_mask:0xf
  v_mov_b32_dpp v21, v101 row_newbcast:4 row_mask:0xf bank_mask:0xf
  s_waitcnt vmcnt(9)
  v_dot2c_f32_bf16 v12, v216, v20
  v_dot2c_f32_bf16 v13, v216, v21
  v_dot2c_f32_bf16 v14, v217, v20
  v_dot2c_f32_bf16 v15, v217, v21
  v_dot2c_f32_bf16 v16, v218, v20
  v_dot2c_f32_bf16 v17, v218, v21
  v_dot2c_f32_bf16 v18, v219, v20
  v_dot2c_f32_bf16 v19, v219, v21
  v_mov_b32_dpp v22, v109 row_newbcast:12 row_mask:0xf bank_mask:0xf
  v_mov_b32_dpp v23, v101 row_newbcast:12 row_mask:0xf bank_mask:0xf
  s_waitcnt vmcnt(8)
  v_dot2c_f32_bf16 v12, v220, v22
  v_dot2c_f32_bf16 v13, v220, v23
  v_dot2c_f32_bf16 v14, v221, v22
  v_dot2c_f32_bf16 v15, v221, v23
  v_dot2c_f32_bf16 v16, v222, v22
  v_dot2c_f32_bf16 v17, v222, v23
  v_dot2c_f32_bf16 v18, v223, v22
  v_dot2c_f32_bf16 v19, v223, v23
  v_mov_b32_dpp v20, v110 row_newbcast:0 row_mask:0xf bank_mask:0xf
  v_mov_b32_dpp v21, v102 row_newbcast:0 row_mask:0xf bank_mask:0xf
  s_waitcnt vmcnt(7)
  v_dot2c_f32_bf16 v12, v224, v20
  v_dot2c_f32_bf16 v13, v224, v21
  v_dot2c_f32_bf16 v14, v225, v20
  v_dot2c_f32_bf16 v15, v225, v21
  v_dot2c_f32_bf16 v16, v226, v20
  v_dot2c_f32_bf16 v17, v226, v21
  v_dot2c_f32_bf16 v18, v227, v20
  v_dot2c_f32_bf16 v19, v227, v21
  v_mov_b32_dpp v22, v110 row_newbcast:8 row_mask:0xf bank_mask:0xf
  v_mov_b32_dpp v23, v102 row_newbcast:8 row_mask:0xf bank_mask:0xf
  s_waitcnt vmcnt(6)
  v_dot2c_f32_bf16 v12, v228, v22
  v_dot2c_f32_bf16 v13, v228, v23
  v_dot2c_f32_bf16 v14, v229, v22
  v_dot2c_f32_bf16 v15, v229, v23
  v_dot2c_f32_bf16 v16, v230, v22
  v_dot2c_f32_bf16 v17, v230, v23
  v_dot2c_f32_bf16 v18, v231, v22
  v_dot2c_f32_bf16 v19, v231, v23
  v_mov_b32_dpp v20, v110 row_newbcast:4 row_mask:0xf bank_mask:0xf
  v_mov_b32_dpp v21, v102 row_newbcast:4 row_mask:0xf bank_mask:0xf
  s_waitcnt vmcnt(5)
  v_dot2c_f32_bf16 v12, v232, v20
  v_dot2c_f32_bf16 v13, v232, v21
  v_dot2c_f32_bf16 v14, v233, v20
  v_dot2c_f32_bf16 v15, v233, v21
  v_dot2c_f32_bf16 v16, v234, v20
  v_dot2c_f32_bf16 v17, v234, v21
  v_dot2c_f32_bf16 v18, v235, v20
  v_dot2c_f32_bf16 v19, v235, v21
  v_mov_b32_dpp v22, v110 row_newbcast:12 row_mask:0xf bank_mask:0xf
  v_mov_b32_dpp v23, v102 row_newbcast:12 row_mask:0xf bank_mask:0xf
  s_waitcnt vmcnt(4)
  v_dot2c_f32_bf16 v12, v236, v22
  v_dot2c_f32_bf16 v13, v236, v23
  v_dot2c_f32_bf16 v14, v237, v22
  v_dot2c_f32_bf16 v15, v237, v23
  v_dot2c_f32_bf16 v16, v238, v22
  v_dot2c_f32_bf16 v17, v238, v23
  v_dot2c_f32_bf16 v18, v239, v22
  v_dot2c_f32_bf16 v19, v239, v23
  v_mov_b32_dpp v20, v111 row_newbcast:0 row_mask:0xf bank_mask:0xf
  v_mov_b32_dpp v21, v103 row_newbcast:0 row_mask:0xf bank_mask:0xf
  s_waitcnt vmcnt(3)
  v_dot2c_f32_bf16 v12, v240, v20
  v_dot2c_f32_bf16 v13, v240, v21
  v_dot2c_f32_bf16 v14, v241, v20
  v_dot2c_f32_bf16 v15, v241, v21
  v_dot2c_f32_bf16 v16, v242, v20
  v_dot2c_f32_bf16 v17, v242, v21
  v_dot2c_f32_bf16 v18, v243, v20
  v_dot2c_f32_bf16 v19, v243, v21
  v_mov_b32_dpp v22, v111 row_newbcast:8 row_mask:0xf bank_mask:0xf
  v_mov_b32_dpp v23, v103 row_newbcast:8 row_mask:0xf bank_mask:0xf
  s_waitcnt vmcnt(2)
  v_dot2c_f32_bf16 v12, v244, v22
  v_dot2c_f32_bf16 v13, v244, v23
  v_dot2c_f32_bf16 v14, v245, v22
  v_dot2c_f32_bf16 v15, v245, v23
  v_dot2c_f32_bf16 v16, v246, v22
  v_dot2c_f32_bf16 v17, v246, v23
  v_dot2c_f32_bf16 v18, v247, v22
  v_dot2c_f32_bf16 v19, v247, v23
  v_mov_b32_dpp v20, v111 row_newbcast:4 row_mask:0xf bank_mask:0xf
  v_mov_b32_dpp v21, v103 row_newbcast:4 row_mask:0xf bank_mask:0xf
  s_waitcnt vmcnt(1)
  v_dot2c_f32_bf16 v12, v248, v20
  v_dot2c_f32_bf16 v13, v248, v21
  v_dot2c_f32_bf16 v14, v249, v20
  v_dot2c_f32_bf16 v15, v249, v21
  v_dot2c_f32_bf16 v16, v250, v20
  v_dot2c_f32_bf16 v17, v250, v21
  v_dot2c_f32_bf16 v18, v251, v20
  v_dot2c_f32_bf16 v19, v251, v21
  v_mov_b32_dpp v22, v111 row_newbcast:12 row_mask:0xf bank_mask:0xf
  v_mov_b32_dpp v23, v103 row_newbcast:12 row_mask:0xf bank_mask:0xf
  s_waitcnt vmcnt(0)
  v_dot2c_f32_bf16 v12, v252, v22
  v_dot2c_f32_bf16 v13, v252, v23
  v_dot2c_f32_bf16 v14, v253, v22
  v_dot2c_f32_bf16 v15, v253, v23
  v_dot2c_f32_bf16 v16, v254, v22
  v_dot2c_f32_bf16 v17, v254, v23
  v_dot2c_f32_bf16 v18, v255, v22
  v_dot2c_f32_bf16 v19, v255, v23
  s_branch L_tail
L_pv9:
  v_mov_b32 v8, 114752
  ds_read_b64 v[46:47], v8
  s_waitcnt lgkmcnt(0)
  v_sub_f32 v96, v96, v46
  v_mul_f32 v96, 0x3fb8aa3b, v96
  v_exp_f32 v96, v96
  v_sub_f32 v97, v97, v46
  v_mul_f32 v97, 0x3fb8aa3b, v97
  v_exp_f32 v97, v97
  v_sub_f32 v98, v98, v46
  v_mul_f32 v98, 0x3fb8aa3b, v98
  v_exp_f32 v98, v98
  v_sub_f32 v99, v99, v46
  v_mul_f32 v99, 0x3fb8aa3b, v99
  v_exp_f32 v99, v99
  v_sub_f32 v100, v100, v46
  v_mul_f32 v100, 0x3fb8aa3b, v100
  v_exp_f32 v100, v100
  v_sub_f32 v101, v101, v46
  v_mul_f32 v101, 0x3fb8aa3b, v101
  v_exp_f32 v101, v101
  v_sub_f32 v102, v102, v46
  v_mul_f32 v102, 0x3fb8aa3b, v102
  v_exp_f32 v102, v102
  v_sub_f32 v103, v103, v46
  v_mul_f32 v103, 0x3fb8aa3b, v103
  v_exp_f32 v103, v103
  s_nop 0
  v_mul_f32 v96, v96, v47
  v_mul_f32 v97, v97, v47
  v_cvt_pk_bf16_f32 v45, v96, v97
  v_lshlrev_b32 v96, 16, v45
  v_and_b32 v97, 0xffff0000, v45
  v_mul_f32 v98, v98, v47
  v_mul_f32 v99, v99, v47
  v_cvt_pk_bf16_f32 v45, v98, v99
  v_lshlrev_b32 v98, 16, v45
  v_and_b32 v99, 0xffff0000, v45
  v_mul_f32 v100, v100, v47
  v_mul_f32 v101, v101, v47
  v_cvt_pk_bf16_f32 v45, v100, v101
  v_lshlrev_b32 v100, 16, v45
  v_and_b32 v101, 0xffff0000, v45
  v_mul_f32 v102, v102, v47
  v_mul_f32 v103, v103, v47
  v_cvt_pk_bf16_f32 v45, v102, v103
  v_lshlrev_b32 v102, 16, v45
  v_and_b32 v103, 0xffff0000, v45
  v_lshrrev_b32 v104, 16, v96
  v_lshrrev_b32 v105, 16, v97
  v_lshrrev_b32 v106, 16, v98
  v_lshrrev_b32 v107, 16, v99
  v_lshrrev_b32 v108, 16, v100
  v_lshrrev_b32 v109, 16, v101
  v_lshrrev_b32 v110, 16, v102
  v_lshrrev_b32 v111, 16, v103
  v_mov_b32 v12, 0
  v_mov_b32 v13, 0
  v_mov_b32 v14, 0
  v_mov_b32 v15, 0
  v_mov_b32 v16, 0
  v_mov_b32 v17, 0
  v_mov_b32 v18, 0
  v_mov_b32 v19, 0
  v_add_u32 v7, s101, v6
  ds_read_b128 v[128:131], v7 offset:0
  v_mov_b32_dpp v20, v104 row_newbcast:0 row_mask:0xf bank_mask:0xf
  v_mov_b32_dpp v21, v96 row_newbcast:0 row_mask:0xf bank_mask:0xf
  s_waitcnt lgkmcnt(0)
  v_dot2c_f32_bf16 v12, v128, v20
  v_dot2c_f32_bf16 v13, v128, v21
  v_dot2c_f32_bf16 v14, v129, v20
  v_dot2c_f32_bf16 v15, v129, v21
  v_dot2c_f32_bf16 v16, v130, v20
  v_dot2c_f32_bf16 v17, v130, v21
  v_dot2c_f32_bf16 v18, v131, v20
  v_dot2c_f32_bf16 v19, v131, v21
  v_mov_b32_dpp v22, v104 row_newbcast:8 row_mask:0xf bank_mask:0xf
  v_mov_b32_dpp v23, v96 row_newbcast:8 row_mask:0xf bank_mask:0xf
  v_dot2c_f32_bf16 v12, v132, v22
  v_dot2c_f32_bf16 v13, v132, v23
  v_dot2c_f32_bf16 v14, v133, v22
  v_dot2c_f32_bf16 v15, v133, v23
  v_dot2c_f32_bf16 v16, v134, v22
  v_dot2c_f32_bf16 v17, v134, v23
  v_dot2c_f32_bf16 v18, v135, v22
  v_dot2c_f32_bf16 v19, v135, v23
  v_mov_b32_dpp v20, v104 row_newbcast:4 row_mask:0xf bank_mask:0xf
  v_mov_b32_dpp v21, v96 row_newbcast:4 row_mask:0xf bank_mask:0xf
  v_dot2c_f32_bf16 v12, v136, v20
  v_dot2c_f32_bf16 v13, v136, v21
  v_dot2c_f32_bf16 v14, v137, v20
  v_dot2c_f32_bf16 v15, v137, v21
  v_dot2c_f32_bf16 v16, v138, v20
  v_dot2c_f32_bf16 v17, v138, v21
  v_dot2c_f32_bf16 v18, v139, v20
  v_dot2c_f32_bf16 v19, v139, v21
  v_mov_b32_dpp v22, v104 row_newbcast:12 row_mask:0xf bank_mask:0xf
  v_mov_b32_dpp v23, v96 row_newbcast:12 row_mask:0xf bank_mask:0xf
  v_dot2c_f32_bf16 v12, v140, v22
  v_dot2c_f32_bf16 v13, v140, v23
  v_dot2c_f32_bf16 v14, v141, v22
  v_dot2c_f32_bf16 v15, v141, v23
  v_dot2c_f32_bf16 v16, v142, v22
  v_dot2c_f32_bf16 v17, v142, v23
  v_dot2c_f32_bf16 v18, v143, v22
  v_dot2c_f32_bf16 v19, v143, v23
  v_mov_b32_dpp v20, v105 row_newbcast:0 row_mask:0xf bank_mask:0xf
  v_mov_b32_dpp v21, v97 row_newbcast:0 row_mask:0xf bank_mask:0xf
  v_dot2c_f32_bf16 v12, v144, v20
  v_dot2c_f32_bf16 v13, v144, v21
  v_dot2c_f32_bf16 v14, v145, v20
  v_dot2c_f32_bf16 v15, v145, v21
  v_dot2c_f32_bf16 v16, v146, v20
  v_dot2c_f32_bf16 v17, v146, v21
  v_dot2c_f32_bf16 v18, v147, v20
  v_dot2c_f32_bf16 v19, v147, v21
  v_mov_b32_dpp v22, v105 row_newbcast:8 row_mask:0xf bank_mask:0xf
  v_mov_b32_dpp v23, v97 row_newbcast:8 row_mask:0xf bank_mask:0xf
  v_dot2c_f32_bf16 v12, v148, v22
  v_dot2c_f32_bf16 v13, v148, v23
  v_dot2c_f32_bf16 v14, v149, v22
  v_dot2c_f32_bf16 v15, v149, v23
  v_dot2c_f32_bf16 v16, v150, v22
  v_dot2c_f32_bf16 v17, v150, v23
  v_dot2c_f32_bf16 v18, v151, v22
  v_dot2c_f32_bf16 v19, v151, v23
  v_mov_b32_dpp v20, v105 row_newbcast:4 row_mask:0xf bank_mask:0xf
  v_mov_b32_dpp v21, v97 row_newbcast:4 row_mask:0xf bank_mask:0xf
  v_dot2c_f32_bf16 v12, v152, v20
  v_dot2c_f32_bf16 v13, v152, v21
  v_dot2c_f32_bf16 v14, v153, v20
  v_dot2c_f32_bf16 v15, v153, v21
  v_dot2c_f32_bf16 v16, v154, v20
  v_dot2c_f32_bf16 v17, v154, v21
  v_dot2c_f32_bf16 v18, v155, v20
  v_dot2c_f32_bf16 v19, v155, v21
  v_mov_b32_dpp v22, v105 row_newbcast:12 row_mask:0xf bank_mask:0xf
  v_mov_b32_dpp v23, v97 row_newbcast:12 row_mask:0xf bank_mask:0xf
  v_dot2c_f32_bf16 v12, v156, v22
  v_dot2c_f32_bf16 v13, v156, v23
  v_dot2c_f32_bf16 v14, v157, v22
  v_dot2c_f32_bf16 v15, v157, v23
  v_dot2c_f32_bf16 v16, v158, v22
  v_dot2c_f32_bf16 v17, v158, v23
  v_dot2c_f32_bf16 v18, v159, v22
  v_dot2c_f32_bf16 v19, v159, v23
  v_mov_b32_dpp v20, v106 row_newbcast:0 row_mask:0xf bank_mask:0xf
  v_mov_b32_dpp v21, v98 row_newbcast:0 row_mask:0xf bank_mask:0xf
  v_dot2c_f32_bf16 v12, v160, v20
  v_dot2c_f32_bf16 v13, v160, v21
  v_dot2c_f32_bf16 v14, v161, v20
  v_dot2c_f32_bf16 v15, v161, v21
  v_dot2c_f32_bf16 v16, v162, v20
  v_dot2c_f32_bf16 v17, v162, v21
  v_dot2c_f32_bf16 v18, v163, v20
  v_dot2c_f32_bf16 v19, v163, v21
  buffer_load_dwordx4 v[208:211], v4, s[44:47], s89 offen offset:0 nt
  v_mov_b32_dpp v22, v106 row_newbcast:8 row_mask:0xf bank_mask:0xf
  v_mov_b32_dpp v23, v98 row_newbcast:8 row_mask:0xf bank_mask:0xf
  v_dot2c_f32_bf16 v12, v164, v22
  v_dot2c_f32_bf16 v13, v164, v23
  v_dot2c_f32_bf16 v14, v165, v22
  v_dot2c_f32_bf16 v15, v165, v23
  v_dot2c_f32_bf16 v16, v166, v22
  v_dot2c_f32_bf16 v17, v166, v23
  v_dot2c_f32_bf16 v18, v167, v22
  v_dot2c_f32_bf16 v19, v167, v23
  buffer_load_dwordx4 v[212:215], v4, s[44:47], s89 offen offset:1024 nt
  v_mov_b32_dpp v20, v106 row_newbcast:4 row_mask:0xf bank_mask:0xf
  v_mov_b32_dpp v21, v98 row_newbcast:4 row_mask:0xf bank_mask:0xf
  s_waitcnt vmcnt(11)
  v_dot2c_f32_bf16 v12, v168, v20
  v_dot2c_f32_bf16 v13, v168, v21
  v_dot2c_f32_bf16 v14, v169, v20
  v_dot2c_f32_bf16 v15, v169, v21
  v_dot2c_f32_bf16 v16, v170, v20
  v_dot2c_f32_bf16 v17, v170, v21
  v_dot2c_f32_bf16 v18, v171, v20
  v_dot2c_f32_bf16 v19, v171, v21
  buffer_load_dwordx4 v[216:219], v4, s[44:47], s89 offen offset:2048 nt
  v_mov_b32_dpp v22, v106 row_newbcast:12 row_mask:0xf bank_mask:0xf
  v_mov_b32_dpp v23, v98 row_newbcast:12 row_mask:0xf bank_mask:0xf
  s_waitcnt vmcnt(11)
  v_dot2c_f32_bf16 v12, v172, v22
  v_dot2c_f32_bf16 v13, v172, v23
  v_dot2c_f32_bf16 v14, v173, v22
  v_dot2c_f32_bf16 v15, v173, v23
  v_dot2c_f32_bf16 v16, v174, v22
  v_dot2c_f32_bf16 v17, v174, v23
  v_dot2c_f32_bf16 v18, v175, v22
  v_dot2c_f32_bf16 v19, v175, v23
  buffer_load_dwordx4 v[220:223], v4, s[44:47], s89 offen offset:3072 nt
  v_mov_b32_dpp v20, v107 row_newbcast:0 row_mask:0xf bank_mask:0xf
  v_mov_b32_dpp v21, v99 row_newbcast:0 row_mask:0xf bank_mask:0xf
  s_waitcnt vmcnt(11)
  v_dot2c_f32_bf16 v12, v176, v20
  v_dot2c_f32_bf16 v13, v176, v21
  v_dot2c_f32_bf16 v14, v177, v20
  v_dot2c_f32_bf16 v15, v177, v21
  v_dot2c_f32_bf16 v16, v178, v20
  v_dot2c_f32_bf16 v17, v178, v21
  v_dot2c_f32_bf16 v18, v179, v20
  v_dot2c_f32_bf16 v19, v179, v21
  buffer_load_dwordx4 v[224:227], v4, s[44:47], s90 offen offset:0 nt
  v_mov_b32_dpp v22, v107 row_newbcast:8 row_mask:0xf bank_mask:0xf
  v_mov_b32_dpp v23, v99 row_newbcast:8 row_mask:0xf bank_mask:0xf
  s_waitcnt vmcnt(11)
  v_dot2c_f32_bf16 v12, v180, v22
  v_dot2c_f32_bf16 v13, v180, v23
  v_dot2c_f32_bf16 v14, v181, v22
  v_dot2c_f32_bf16 v15, v181, v23
  v_dot2c_f32_bf16 v16, v182, v22
  v_dot2c_f32_bf16 v17, v182, v23
  v_dot2c_f32_bf16 v18, v183, v22
  v_dot2c_f32_bf16 v19, v183, v23
  buffer_load_dwordx4 v[228:231], v4, s[44:47], s90 offen offset:1024 nt
  v_mov_b32_dpp v20, v107 row_newbcast:4 row_mask:0xf bank_mask:0xf
  v_mov_b32_dpp v21, v99 row_newbcast:4 row_mask:0xf bank_mask:0xf
  s_waitcnt vmcnt(11)
  v_dot2c_f32_bf16 v12, v184, v20
  v_dot2c_f32_bf16 v13, v184, v21
  v_dot2c_f32_bf16 v14, v185, v20
  v_dot2c_f32_bf16 v15, v185, v21
  v_dot2c_f32_bf16 v16, v186, v20
  v_dot2c_f32_bf16 v17, v186, v21
  v_dot2c_f32_bf16 v18, v187, v20
  v_dot2c_f32_bf16 v19, v187, v21
  buffer_load_dwordx4 v[232:235], v4, s[44:47], s90 offen offset:2048 nt
  v_mov_b32_dpp v22, v107 row_newbcast:12 row_mask:0xf bank_mask:0xf
  v_mov_b32_dpp v23, v99 row_newbcast:12 row_mask:0xf bank_mask:0xf
  s_waitcnt vmcnt(11)
  v_dot2c_f32_bf16 v12, v188, v22
  v_dot2c_f32_bf16 v13, v188, v23
  v_dot2c_f32_bf16 v14, v189, v22
  v_dot2c_f32_bf16 v15, v189, v23
  v_dot2c_f32_bf16 v16, v190, v22
  v_dot2c_f32_bf16 v17, v190, v23
  v_dot2c_f32_bf16 v18, v191, v22
  v_dot2c_f32_bf16 v19, v191, v23
  buffer_load_dwordx4 v[236:239], v4, s[44:47], s90 offen offset:3072 nt
  v_mov_b32_dpp v20, v108 row_newbcast:0 row_mask:0xf bank_mask:0xf
  v_mov_b32_dpp v21, v100 row_newbcast:0 row_mask:0xf bank_mask:0xf
  s_waitcnt vmcnt(11)
  v_dot2c_f32_bf16 v12, v192, v20
  v_dot2c_f32_bf16 v13, v192, v21
  v_dot2c_f32_bf16 v14, v193, v20
  v_dot2c_f32_bf16 v15, v193, v21
  v_dot2c_f32_bf16 v16, v194, v20
  v_dot2c_f32_bf16 v17, v194, v21
  v_dot2c_f32_bf16 v18, v195, v20
  v_dot2c_f32_bf16 v19, v195, v21
  buffer_load_dwordx4 v[240:243], v4, s[44:47], s91 offen offset:0 nt
  v_mov_b32_dpp v22, v108 row_newbcast:8 row_mask:0xf bank_mask:0xf
  v_mov_b32_dpp v23, v100 row_newbcast:8 row_mask:0xf bank_mask:0xf
  s_waitcnt vmcnt(11)
  v_dot2c_f32_bf16 v12, v196, v22
  v_dot2c_f32_bf16 v13, v196, v23
  v_dot2c_f32_bf16 v14, v197, v22
  v_dot2c_f32_bf16 v15, v197, v23
  v_dot2c_f32_bf16 v16, v198, v22
  v_dot2c_f32_bf16 v17, v198, v23
  v_dot2c_f32_bf16 v18, v199, v22
  v_dot2c_f32_bf16 v19, v199, v23
  buffer_load_dwordx4 v[244:247], v4, s[44:47], s91 offen offset:1024 nt
  v_mov_b32_dpp v20, v108 row_newbcast:4 row_mask:0xf bank_mask:0xf
  v_mov_b32_dpp v21, v100 row_newbcast:4 row_mask:0xf bank_mask:0xf
  s_waitcnt vmcnt(11)
  v_dot2c_f32_bf16 v12, v200, v20
  v_dot2c_f32_bf16 v13, v200, v21
  v_dot2c_f32_bf16 v14, v201, v20
  v_dot2c_f32_bf16 v15, v201, v21
  v_dot2c_f32_bf16 v16, v202, v20
  v_dot2c_f32_bf16 v17, v202, v21
  v_dot2c_f32_bf16 v18, v203, v20
  v_dot2c_f32_bf16 v19, v203, v21
  buffer_load_dwordx4 v[248:251], v4, s[44:47], s91 offen offset:2048 nt
  v_mov_b32_dpp v22, v108 row_newbcast:12 row_mask:0xf bank_mask:0xf
  v_mov_b32_dpp v23, v100 row_newbcast:12 row_mask:0xf bank_mask:0xf
  s_waitcnt vmcnt(11)
  v_dot2c_f32_bf16 v12, v204, v22
  v_dot2c_f32_bf16 v13, v204, v23
  v_dot2c_f32_bf16 v14, v205, v22
  v_dot2c_f32_bf16 v15, v205, v23
  v_dot2c_f32_bf16 v16, v206, v22
  v_dot2c_f32_bf16 v17, v206, v23
  v_dot2c_f32_bf16 v18, v207, v22
  v_dot2c_f32_bf16 v19, v207, v23
  buffer_load_dwordx4 v[252:255], v4, s[44:47], s91 offen offset:3072 nt
  v_mov_b32_dpp v20, v109 row_newbcast:0 row_mask:0xf bank_mask:0xf
  v_mov_b32_dpp v21, v101 row_newbcast:0 row_mask:0xf bank_mask:0xf
  s_waitcnt vmcnt(11)
  v_dot2c_f32_bf16 v12, v208, v20
  v_dot2c_f32_bf16 v13, v208, v21
  v_dot2c_f32_bf16 v14, v209, v20
  v_dot2c_f32_bf16 v15, v209, v21
  v_dot2c_f32_bf16 v16, v210, v20
  v_dot2c_f32_bf16 v17, v210, v21
  v_dot2c_f32_bf16 v18, v211, v20
  v_dot2c_f32_bf16 v19, v211, v21
  v_mov_b32_dpp v22, v109 row_newbcast:8 row_mask:0xf bank_mask:0xf
  v_mov_b32_dpp v23, v101 row_newbcast:8 row_mask:0xf bank_mask:0xf
  s_waitcnt vmcnt(10)
  v_dot2c_f32_bf16 v12, v212, v22
  v_dot2c_f32_bf16 v13, v212, v23
  v_dot2c_f32_bf16 v14, v213, v22
  v_dot2c_f32_bf16 v15, v213, v23
  v_dot2c_f32_bf16 v16, v214, v22
  v_dot2c_f32_bf16 v17, v214, v23
  v_dot2c_f32_bf16 v18, v215, v22
  v_dot2c_f32_bf16 v19, v215, v23
  v_mov_b32_dpp v20, v109 row_newbcast:4 row_mask:0xf bank_mask:0xf
  v_mov_b32_dpp v21, v101 row_newbcast:4 row_mask:0xf bank_mask:0xf
  s_waitcnt vmcnt(9)
  v_dot2c_f32_bf16 v12, v216, v20
  v_dot2c_f32_bf16 v13, v216, v21
  v_dot2c_f32_bf16 v14, v217, v20
  v_dot2c_f32_bf16 v15, v217, v21
  v_dot2c_f32_bf16 v16, v218, v20
  v_dot2c_f32_bf16 v17, v218, v21
  v_dot2c_f32_bf16 v18, v219, v20
  v_dot2c_f32_bf16 v19, v219, v21
  v_mov_b32_dpp v22, v109 row_newbcast:12 row_mask:0xf bank_mask:0xf
  v_mov_b32_dpp v23, v101 row_newbcast:12 row_mask:0xf bank_mask:0xf
  s_waitcnt vmcnt(8)
  v_dot2c_f32_bf16 v12, v220, v22
  v_dot2c_f32_bf16 v13, v220, v23
  v_dot2c_f32_bf16 v14, v221, v22
  v_dot2c_f32_bf16 v15, v221, v23
  v_dot2c_f32_bf16 v16, v222, v22
  v_dot2c_f32_bf16 v17, v222, v23
  v_dot2c_f32_bf16 v18, v223, v22
  v_dot2c_f32_bf16 v19, v223, v23
  v_mov_b32_dpp v20, v110 row_newbcast:0 row_mask:0xf bank_mask:0xf
  v_mov_b32_dpp v21, v102 row_newbcast:0 row_mask:0xf bank_mask:0xf
  s_waitcnt vmcnt(7)
  v_dot2c_f32_bf16 v12, v224, v20
  v_dot2c_f32_bf16 v13, v224, v21
  v_dot2c_f32_bf16 v14, v225, v20
  v_dot2c_f32_bf16 v15, v225, v21
  v_dot2c_f32_bf16 v16, v226, v20
  v_dot2c_f32_bf16 v17, v226, v21
  v_dot2c_f32_bf16 v18, v227, v20
  v_dot2c_f32_bf16 v19, v227, v21
  v_mov_b32_dpp v22, v110 row_newbcast:8 row_mask:0xf bank_mask:0xf
  v_mov_b32_dpp v23, v102 row_newbcast:8 row_mask:0xf bank_mask:0xf
  s_waitcnt vmcnt(6)
  v_dot2c_f32_bf16 v12, v228, v22
  v_dot2c_f32_bf16 v13, v228, v23
  v_dot2c_f32_bf16 v14, v229, v22
  v_dot2c_f32_bf16 v15, v229, v23
  v_dot2c_f32_bf16 v16, v230, v22
  v_dot2c_f32_bf16 v17, v230, v23
  v_dot2c_f32_bf16 v18, v231, v22
  v_dot2c_f32_bf16 v19, v231, v23
  v_mov_b32_dpp v20, v110 row_newbcast:4 row_mask:0xf bank_mask:0xf
  v_mov_b32_dpp v21, v102 row_newbcast:4 row_mask:0xf bank_mask:0xf
  s_waitcnt vmcnt(5)
  v_dot2c_f32_bf16 v12, v232, v20
  v_dot2c_f32_bf16 v13, v232, v21
  v_dot2c_f32_bf16 v14, v233, v20
  v_dot2c_f32_bf16 v15, v233, v21
  v_dot2c_f32_bf16 v16, v234, v20
  v_dot2c_f32_bf16 v17, v234, v21
  v_dot2c_f32_bf16 v18, v235, v20
  v_dot2c_f32_bf16 v19, v235, v21
  v_mov_b32_dpp v22, v110 row_newbcast:12 row_mask:0xf bank_mask:0xf
  v_mov_b32_dpp v23, v102 row_newbcast:12 row_mask:0xf bank_mask:0xf
  s_waitcnt vmcnt(4)
  v_dot2c_f32_bf16 v12, v236, v22
  v_dot2c_f32_bf16 v13, v236, v23
  v_dot2c_f32_bf16 v14, v237, v22
  v_dot2c_f32_bf16 v15, v237, v23
  v_dot2c_f32_bf16 v16, v238, v22
  v_dot2c_f32_bf16 v17, v238, v23
  v_dot2c_f32_bf16 v18, v239, v22
  v_dot2c_f32_bf16 v19, v239, v23
  v_mov_b32_dpp v20, v111 row_newbcast:0 row_mask:0xf bank_mask:0xf
  v_mov_b32_dpp v21, v103 row_newbcast:0 row_mask:0xf bank_mask:0xf
  s_waitcnt vmcnt(3)
  v_dot2c_f32_bf16 v12, v240, v20
  v_dot2c_f32_bf16 v13, v240, v21
  v_dot2c_f32_bf16 v14, v241, v20
  v_dot2c_f32_bf16 v15, v241, v21
  v_dot2c_f32_bf16 v16, v242, v20
  v_dot2c_f32_bf16 v17, v242, v21
  v_dot2c_f32_bf16 v18, v243, v20
  v_dot2c_f32_bf16 v19, v243, v21
  v_mov_b32_dpp v22, v111 row_newbcast:8 row_mask:0xf bank_mask:0xf
  v_mov_b32_dpp v23, v103 row_newbcast:8 row_mask:0xf bank_mask:0xf
  s_waitcnt vmcnt(2)
  v_dot2c_f32_bf16 v12, v244, v22
  v_dot2c_f32_bf16 v13, v244, v23
  v_dot2c_f32_bf16 v14, v245, v22
  v_dot2c_f32_bf16 v15, v245, v23
  v_dot2c_f32_bf16 v16, v246, v22
  v_dot2c_f32_bf16 v17, v246, v23
  v_dot2c_f32_bf16 v18, v247, v22
  v_dot2c_f32_bf16 v19, v247, v23
  v_mov_b32_dpp v20, v111 row_newbcast:4 row_mask:0xf bank_mask:0xf
  v_mov_b32_dpp v21, v103 row_newbcast:4 row_mask:0xf bank_mask:0xf
  s_waitcnt vmcnt(1)
  v_dot2c_f32_bf16 v12, v248, v20
  v_dot2c_f32_bf16 v13, v248, v21
  v_dot2c_f32_bf16 v14, v249, v20
  v_dot2c_f32_bf16 v15, v249, v21
  v_dot2c_f32_bf16 v16, v250, v20
  v_dot2c_f32_bf16 v17, v250, v21
  v_dot2c_f32_bf16 v18, v251, v20
  v_dot2c_f32_bf16 v19, v251, v21
  v_mov_b32_dpp v22, v111 row_newbcast:12 row_mask:0xf bank_mask:0xf
  v_mov_b32_dpp v23, v103 row_newbcast:12 row_mask:0xf bank_mask:0xf
  s_waitcnt vmcnt(0)
  v_dot2c_f32_bf16 v12, v252, v22
  v_dot2c_f32_bf16 v13, v252, v23
  v_dot2c_f32_bf16 v14, v253, v22
  v_dot2c_f32_bf16 v15, v253, v23
  v_dot2c_f32_bf16 v16, v254, v22
  v_dot2c_f32_bf16 v17, v254, v23
  v_dot2c_f32_bf16 v18, v255, v22
  v_dot2c_f32_bf16 v19, v255, v23
  s_branch L_tail
L_pv12:
  v_mov_b32 v8, 114752
  ds_read_b64 v[46:47], v8
  s_waitcnt lgkmcnt(0)
  v_sub_f32 v96, v96, v46
  v_mul_f32 v96, 0x3fb8aa3b, v96
  v_exp_f32 v96, v96
  v_sub_f32 v97, v97, v46
  v_mul_f32 v97, 0x3fb8aa3b, v97
  v_exp_f32 v97, v97
  v_sub_f32 v98, v98, v46
  v_mul_f32 v98, 0x3fb8aa3b, v98
  v_exp_f32 v98, v98
  v_sub_f32 v99, v99, v46
  v_mul_f32 v99, 0x3fb8aa3b, v99
  v_exp_f32 v99, v99
  v_sub_f32 v100, v100, v46
  v_mul_f32 v100, 0x3fb8aa3b, v100
  v_exp_f32 v100, v100
  v_sub_f32 v101, v101, v46
  v_mul_f32 v101, 0x3fb8aa3b, v101
  v_exp_f32 v101, v101
  v_sub_f32 v102, v102, v46
  v_mul_f32 v102, 0x3fb8aa3b, v102
  v_exp_f32 v102, v102
  v_sub_f32 v103, v103, v46
  v_mul_f32 v103, 0x3fb8aa3b, v103
  v_exp_f32 v103, v103
  s_nop 0
  v_mul_f32 v96, v96, v47
  v_mul_f32 v97, v97, v47
  v_cvt_pk_bf16_f32 v45, v96, v97
  v_lshlrev_b32 v96, 16, v45
  v_and_b32 v97, 0xffff0000, v45
  v_mul_f32 v98, v98, v47
  v_mul_f32 v99, v99, v47
  v_cvt_pk_bf16_f32 v45, v98, v99
  v_lshlrev_b32 v98, 16, v45
  v_and_b32 v99, 0xffff0000, v45
  v_mul_f32 v100, v100, v47
  v_mul_f32 v101, v101, v47
  v_cvt_pk_bf16_f32 v45, v100, v101
  v_lshlrev_b32 v100, 16, v45
  v_and_b32 v101, 0xffff0000, v45
  v_mul_f32 v102, v102, v47
  v_mul_f32 v103, v103, v47
  v_cvt_pk_bf16_f32 v45, v102, v103
  v_lshlrev_b32 v102, 16, v45
  v_and_b32 v103, 0xffff0000, v45
  v_lshrrev_b32 v104, 16, v96
  v_lshrrev_b32 v105, 16, v97
  v_lshrrev_b32 v106, 16, v98
  v_lshrrev_b32 v107, 16, v99
  v_lshrrev_b32 v108, 16, v100
  v_lshrrev_b32 v109, 16, v101
  v_lshrrev_b32 v110, 16, v102
  v_lshrrev_b32 v111, 16, v103
  v_mov_b32 v12, 0
  v_mov_b32 v13, 0
  v_mov_b32 v14, 0
  v_mov_b32 v15, 0
  v_mov_b32 v16, 0
  v_mov_b32 v17, 0
  v_mov_b32 v18, 0
  v_mov_b32 v19, 0
  v_add_u32 v7, s101, v6
  ds_read_b128 v[128:131], v7 offset:0
  v_mov_b32_dpp v20, v104 row_newbcast:0 row_mask:0xf bank_mask:0xf
  v_mov_b32_dpp v21, v96 row_newbcast:0 row_mask:0xf bank_mask:0xf
  s_waitcnt lgkmcnt(0)
  v_dot2c_f32_bf16 v12, v128, v20
  v_dot2c_f32_bf16 v13, v128, v21
  v_dot2c_f32_bf16 v14, v129, v20
  v_dot2c_f32_bf16 v15, v129, v21
  v_dot2c_f32_bf16 v16, v130, v20
  v_dot2c_f32_bf16 v17, v130, v21
  v_dot2c_f32_bf16 v18, v131, v20
  v_dot2c_f32_bf16 v19, v131, v21
  v_mov_b32_dpp v22, v104 row_newbcast:8 row_mask:0xf bank_mask:0xf
  v_mov_b32_dpp v23, v96 row_newbcast:8 row_mask:0xf bank_mask:0xf
  v_dot2c_f32_bf16 v12, v132, v22
  v_dot2c_f32_bf16 v13, v132, v23
  v_dot2c_f32_bf16 v14, v133, v22
  v_dot2c_f32_bf16 v15, v133, v23
  v_dot2c_f32_bf16 v16, v134, v22
  v_dot2c_f32_bf16 v17, v134, v23
  v_dot2c_f32_bf16 v18, v135, v22
  v_dot2c_f32_bf16 v19, v135, v23
  v_mov_b32_dpp v20, v104 row_newbcast:4 row_mask:0xf bank_mask:0xf
  v_mov_b32_dpp v21, v96 row_newbcast:4 row_mask:0xf bank_mask:0xf
  v_dot2c_f32_bf16 v12, v136, v20
  v_dot2c_f32_bf16 v13, v136, v21
  v_dot2c_f32_bf16 v14, v137, v20
  v_dot2c_f32_bf16 v15, v137, v21
  v_dot2c_f32_bf16 v16, v138, v20
  v_dot2c_f32_bf16 v17, v138, v21
  v_dot2c_f32_bf16 v18, v139, v20
  v_dot2c_f32_bf16 v19, v139, v21
  v_mov_b32_dpp v22, v104 row_newbcast:12 row_mask:0xf bank_mask:0xf
  v_mov_b32_dpp v23, v96 row_newbcast:12 row_mask:0xf bank_mask:0xf
  v_dot2c_f32_bf16 v12, v140, v22
  v_dot2c_f32_bf16 v13, v140, v23
  v_dot2c_f32_bf16 v14, v141, v22
  v_dot2c_f32_bf16 v15, v141, v23
  v_dot2c_f32_bf16 v16, v142, v22
  v_dot2c_f32_bf16 v17, v142, v23
  v_dot2c_f32_bf16 v18, v143, v22
  v_dot2c_f32_bf16 v19, v143, v23
  v_mov_b32_dpp v20, v105 row_newbcast:0 row_mask:0xf bank_mask:0xf
  v_mov_b32_dpp v21, v97 row_newbcast:0 row_mask:0xf bank_mask:0xf
  v_dot2c_f32_bf16 v12, v144, v20
  v_dot2c_f32_bf16 v13, v144, v21
  v_dot2c_f32_bf16 v14, v145, v20
  v_dot2c_f32_bf16 v15, v145, v21
  v_dot2c_f32_bf16 v16, v146, v20
  v_dot2c_f32_bf16 v17, v146, v21
  v_dot2c_f32_bf16 v18, v147, v20
  v_dot2c_f32_bf16 v19, v147, v21
  v_mov_b32_dpp v22, v105 row_newbcast:8 row_mask:0xf bank_mask:0xf
  v_mov_b32_dpp v23, v97 row_newbcast:8 row_mask:0xf bank_mask:0xf
  v_dot2c_f32_bf16 v12, v148, v22
  v_dot2c_f32_bf16 v13, v148, v23
  v_dot2c_f32_bf16 v14, v149, v22
  v_dot2c_f32_bf16 v15, v149, v23
  v_dot2c_f32_bf16 v16, v150, v22
  v_dot2c_f32_bf16 v17, v150, v23
  v_dot2c_f32_bf16 v18, v151, v22
  v_dot2c_f32_bf16 v19, v151, v23
  v_mov_b32_dpp v20, v105 row_newbcast:4 row_mask:0xf bank_mask:0xf
  v_mov_b32_dpp v21, v97 row_newbcast:4 row_mask:0xf bank_mask:0xf
  v_dot2c_f32_bf16 v12, v152, v20
  v_dot2c_f32_bf16 v13, v152, v21
  v_dot2c_f32_bf16 v14, v153, v20
  v_dot2c_f32_bf16 v15, v153, v21
  v_dot2c_f32_bf16 v16, v154, v20
  v_dot2c_f32_bf16 v17, v154, v21
  v_dot2c_f32_bf16 v18, v155, v20
  v_dot2c_f32_bf16 v19, v155, v21
  v_mov_b32_dpp v22, v105 row_newbcast:12 row_mask:0xf bank_mask:0xf
  v_mov_b32_dpp v23, v97 row_newbcast:12 row_mask:0xf bank_mask:0xf
  v_dot2c_f32_bf16 v12, v156, v22
  v_dot2c_f32_bf16 v13, v156, v23
  v_dot2c_f32_bf16 v14, v157, v22
  v_dot2c_f32_bf16 v15, v157, v23
  v_dot2c_f32_bf16 v16, v158, v22
  v_dot2c_f32_bf16 v17, v158, v23
  v_dot2c_f32_bf16 v18, v159, v22
  v_dot2c_f32_bf16 v19, v159, v23
  v_mov_b32_dpp v20, v106 row_newbcast:0 row_mask:0xf bank_mask:0xf
  v_mov_b32_dpp v21, v98 row_newbcast:0 row_mask:0xf bank_mask:0xf
  v_dot2c_f32_bf16 v12, v160, v20
  v_dot2c_f32_bf16 v13, v160, v21
  v_dot2c_f32_bf16 v14, v161, v20
  v_dot2c_f32_bf16 v15, v161, v21
  v_dot2c_f32_bf16 v16, v162, v20
  v_dot2c_f32_bf16 v17, v162, v21
  v_dot2c_f32_bf16 v18, v163, v20
  v_dot2c_f32_bf16 v19, v163, v21
  v_mov_b32_dpp v22, v106 row_newbcast:8 row_mask:0xf bank_mask:0xf
  v_mov_b32_dpp v23, v98 row_newbcast:8 row_mask:0xf bank_mask:0xf
  v_dot2c_f32_bf16 v12, v164, v22
  v_dot2c_f32_bf16 v13, v164, v23
  v_dot2c_f32_bf16 v14, v165, v22
  v_dot2c_f32_bf16 v15, v165, v23
  v_dot2c_f32_bf16 v16, v166, v22
  v_dot2c_f32_bf16 v17, v166, v23
  v_dot2c_f32_bf16 v18, v167, v22
  v_dot2c_f32_bf16 v19, v167, v23
  v_mov_b32_dpp v20, v106 row_newbcast:4 row_mask:0xf bank_mask:0xf
  v_mov_b32_dpp v21, v98 row_newbcast:4 row_mask:0xf bank_mask:0xf
  v_dot2c_f32_bf16 v12, v168, v20
  v_dot2c_f32_bf16 v13, v168, v21
  v_dot2c_f32_bf16 v14, v169, v20
  v_dot2c_f32_bf16 v15, v169, v21
  v_dot2c_f32_bf16 v16, v170, v20
  v_dot2c_f32_bf16 v17, v170, v21
  v_dot2c_f32_bf16 v18, v171, v20
  v_dot2c_f32_bf16 v19, v171, v21
  v_mov_b32_dpp v22, v106 row_newbcast:12 row_mask:0xf bank_mask:0xf
  v_mov_b32_dpp v23, v98 row_newbcast:12 row_mask:0xf bank_mask:0xf
  v_dot2c_f32_bf16 v12, v172, v22
  v_dot2c_f32_bf16 v13, v172, v23
  v_dot2c_f32_bf16 v14, v173, v22
  v_dot2c_f32_bf16 v15, v173, v23
  v_dot2c_f32_bf16 v16, v174, v22
  v_dot2c_f32_bf16 v17, v174, v23
  v_dot2c_f32_bf16 v18, v175, v22
  v_dot2c_f32_bf16 v19, v175, v23
  buffer_load_dwordx4 v[220:223], v4, s[44:47], s89 offen offset:3072 nt
  v_mov_b32_dpp v20, v107 row_newbcast:0 row_mask:0xf bank_mask:0xf
  v_mov_b32_dpp v21, v99 row_newbcast:0 row_mask:0xf bank_mask:0xf
  v_dot2c_f32_bf16 v12, v176, v20
  v_dot2c_f32_bf16 v13, v176, v21
  v_dot2c_f32_bf16 v14, v177, v20
  v_dot2c_f32_bf16 v15, v177, v21
  v_dot2c_f32_bf16 v16, v178, v20
  v_dot2c_f32_bf16 v17, v178, v21
  v_dot2c_f32_bf16 v18, v179, v20
  v_dot2c_f32_bf16 v19, v179, v21
  buffer_load_dwordx4 v[224:227], v4, s[44:47], s90 offen offset:0 nt
  v_mov_b32_dpp v22, v107 row_newbcast:8 row_mask:0xf bank_mask:0xf
  v_mov_b32_dpp v23, v99 row_newbcast:8 row_mask:0xf bank_mask:0xf
  s_waitcnt vmcnt(11)
  v_dot2c_f32_bf16 v12, v180, v22
  v_dot2c_f32_bf16 v13, v180, v23
  v_dot2c_f32_bf16 v14, v181, v22
  v_dot2c_f32_bf16 v15, v181, v23
  v_dot2c_f32_bf16 v16, v182, v22
  v_dot2c_f32_bf16 v17, v182, v23
  v_dot2c_f32_bf16 v18, v183, v22
  v_dot2c_f32_bf16 v19, v183, v23
  buffer_load_dwordx4 v[228:231], v4, s[44:47], s90 offen offset:1024 nt
  v_mov_b32_dpp v20, v107 row_newbcast:4 row_mask:0xf bank_mask:0xf
  v_mov_b32_dpp v21, v99 row_newbcast:4 row_mask:0xf bank_mask:0xf
  s_waitcnt vmcnt(11)
  v_dot2c_f32_bf16 v12, v184, v20
  v_dot2c_f32_bf16 v13, v184, v21
  v_dot2c_f32_bf16 v14, v185, v20
  v_dot2c_f32_bf16 v15, v185, v21
  v_dot2c_f32_bf16 v16, v186, v20
  v_dot2c_f32_bf16 v17, v186, v21
  v_dot2c_f32_bf16 v18, v187, v20
  v_dot2c_f32_bf16 v19, v187, v21
  buffer_load_dwordx4 v[232:235], v4, s[44:47], s90 offen offset:2048 nt
  v_mov_b32_dpp v22, v107 row_newbcast:12 row_mask:0xf bank_mask:0xf
  v_mov_b32_dpp v23, v99 row_newbcast:12 row_mask:0xf bank_mask:0xf
  s_waitcnt vmcnt(11)
  v_dot2c_f32_bf16 v12, v188, v22
  v_dot2c_f32_bf16 v13, v188, v23
  v_dot2c_f32_bf16 v14, v189, v22
  v_dot2c_f32_bf16 v15, v189, v23
  v_dot2c_f32_bf16 v16, v190, v22
  v_dot2c_f32_bf16 v17, v190, v23
  v_dot2c_f32_bf16 v18, v191, v22
  v_dot2c_f32_bf16 v19, v191, v23
  buffer_load_dwordx4 v[236:239], v4, s[44:47], s90 offen offset:3072 nt
  v_mov_b32_dpp v20, v108 row_newbcast:0 row_mask:0xf bank_mask:0xf
  v_mov_b32_dpp v21, v100 row_newbcast:0 row_mask:0xf bank_mask:0xf
  s_waitcnt vmcnt(11)
  v_dot2c_f32_bf16 v12, v192, v20
  v_dot2c_f32_bf16 v13, v192, v21
  v_dot2c_f32_bf16 v14, v193, v20
  v_dot2c_f32_bf16 v15, v193, v21
  v_dot2c_f32_bf16 v16, v194, v20
  v_dot2c_f32_bf16 v17, v194, v21
  v_dot2c_f32_bf16 v18, v195, v20
  v_dot2c_f32_bf16 v19, v195, v21
  buffer_load_dwordx4 v[240:243], v4, s[44:47], s91 offen offset:0 nt
  v_mov_b32_dpp v22, v108 row_newbcast:8 row_mask:0xf bank_mask:0xf
  v_mov_b32_dpp v23, v100 row_newbcast:8 row_mask:0xf bank_mask:0xf
  s_waitcnt vmcnt(11)
  v_dot2c_f32_bf16 v12, v196, v22
  v_dot2c_f32_bf16 v13, v196, v23
  v_dot2c_f32_bf16 v14, v197, v22
  v_dot2c_f32_bf16 v15, v197, v23
  v_dot2c_f32_bf16 v16, v198, v22
  v_dot2c_f32_bf16 v17, v198, v23
  v_dot2c_f32_bf16 v18, v199, v22
  v_dot2c_f32_bf16 v19, v199, v23
  buffer_load_dwordx4 v[244:247], v4, s[44:47], s91 offen offset:1024 nt
  v_mov_b32_dpp v20, v108 row_newbcast:4 row_mask:0xf bank_mask:0xf
  v_mov_b32_dpp v21, v100 row_newbcast:4 row_mask:0xf bank_mask:0xf
  s_waitcnt vmcnt(11)
  v_dot2c_f32_bf16 v12, v200, v20
  v_dot2c_f32_bf16 v13, v200, v21
  v_dot2c_f32_bf16 v14, v201, v20
  v_dot2c_f32_bf16 v15, v201, v21
  v_dot2c_f32_bf16 v16, v202, v20
  v_dot2c_f32_bf16 v17, v202, v21
  v_dot2c_f32_bf16 v18, v203, v20
  v_dot2c_f32_bf16 v19, v203, v21
  buffer_load_dwordx4 v[248:251], v4, s[44:47], s91 offen offset:2048 nt
  v_mov_b32_dpp v22, v108 row_newbcast:12 row_mask:0xf bank_mask:0xf
  v_mov_b32_dpp v23, v100 row_newbcast:12 row_mask:0xf bank_mask:0xf
  s_waitcnt vmcnt(11)
  v_dot2c_f32_bf16 v12, v204, v22
  v_dot2c_f32_bf16 v13, v204, v23
  v_dot2c_f32_bf16 v14, v205, v22
  v_dot2c_f32_bf16 v15, v205, v23
  v_dot2c_f32_bf16 v16, v206, v22
  v_dot2c_f32_bf16 v17, v206, v23
  v_dot2c_f32_bf16 v18, v207, v22
  v_dot2c_f32_bf16 v19, v207, v23
  buffer_load_dwordx4 v[252:255], v4, s[44:47], s91 offen offset:3072 nt
  v_mov_b32_dpp v20, v109 row_newbcast:0 row_mask:0xf bank_mask:0xf
  v_mov_b32_dpp v21, v101 row_newbcast:0 row_mask:0xf bank_mask:0xf
  s_waitcnt vmcnt(11)
  v_dot2c_f32_bf16 v12, v208, v20
  v_dot2c_f32_bf16 v13, v208, v21
  v_dot2c_f32_bf16 v14, v209, v20
  v_dot2c_f32_bf16 v15, v209, v21
  v_dot2c_f32_bf16 v16, v210, v20
  v_dot2c_f32_bf16 v17, v210, v21
  v_dot2c_f32_bf16 v18, v211, v20
  v_dot2c_f32_bf16 v19, v211, v21
  v_mov_b32_dpp v22, v109 row_newbcast:8 row_mask:0xf bank_mask:0xf
  v_mov_b32_dpp v23, v101 row_newbcast:8 row_mask:0xf bank_mask:0xf
  s_waitcnt vmcnt(10)
  v_dot2c_f32_bf16 v12, v212, v22
  v_dot2c_f32_bf16 v13, v212, v23
  v_dot2c_f32_bf16 v14, v213, v22
  v_dot2c_f32_bf16 v15, v213, v23
  v_dot2c_f32_bf16 v16, v214, v22
  v_dot2c_f32_bf16 v17, v214, v23
  v_dot2c_f32_bf16 v18, v215, v22
  v_dot2c_f32_bf16 v19, v215, v23
  v_mov_b32_dpp v20, v109 row_newbcast:4 row_mask:0xf bank_mask:0xf
  v_mov_b32_dpp v21, v101 row_newbcast:4 row_mask:0xf bank_mask:0xf
  s_waitcnt vmcnt(9)
  v_dot2c_f32_bf16 v12, v216, v20
  v_dot2c_f32_bf16 v13, v216, v21
  v_dot2c_f32_bf16 v14, v217, v20
  v_dot2c_f32_bf16 v15, v217, v21
  v_dot2c_f32_bf16 v16, v218, v20
  v_dot2c_f32_bf16 v17, v218, v21
  v_dot2c_f32_bf16 v18, v219, v20
  v_dot2c_f32_bf16 v19, v219, v21
  v_mov_b32_dpp v22, v109 row_newbcast:12 row_mask:0xf bank_mask:0xf
  v_mov_b32_dpp v23, v101 row_newbcast:12 row_mask:0xf bank_mask:0xf
  s_waitcnt vmcnt(8)
  v_dot2c_f32_bf16 v12, v220, v22
  v_dot2c_f32_bf16 v13, v220, v23
  v_dot2c_f32_bf16 v14, v221, v22
  v_dot2c_f32_bf16 v15, v221, v23
  v_dot2c_f32_bf16 v16, v222, v22
  v_dot2c_f32_bf16 v17, v222, v23
  v_dot2c_f32_bf16 v18, v223, v22
  v_dot2c_f32_bf16 v19, v223, v23
  v_mov_b32_dpp v20, v110 row_newbcast:0 row_mask:0xf bank_mask:0xf
  v_mov_b32_dpp v21, v102 row_newbcast:0 row_mask:0xf bank_mask:0xf
  s_waitcnt vmcnt(7)
  v_dot2c_f32_bf16 v12, v224, v20
  v_dot2c_f32_bf16 v13, v224, v21
  v_dot2c_f32_bf16 v14, v225, v20
  v_dot2c_f32_bf16 v15, v225, v21
  v_dot2c_f32_bf16 v16, v226, v20
  v_dot2c_f32_bf16 v17, v226, v21
  v_dot2c_f32_bf16 v18, v227, v20
  v_dot2c_f32_bf16 v19, v227, v21
  v_mov_b32_dpp v22, v110 row_newbcast:8 row_mask:0xf bank_mask:0xf
  v_mov_b32_dpp v23, v102 row_newbcast:8 row_mask:0xf bank_mask:0xf
  s_waitcnt vmcnt(6)
  v_dot2c_f32_bf16 v12, v228, v22
  v_dot2c_f32_bf16 v13, v228, v23
  v_dot2c_f32_bf16 v14, v229, v22
  v_dot2c_f32_bf16 v15, v229, v23
  v_dot2c_f32_bf16 v16, v230, v22
  v_dot2c_f32_bf16 v17, v230, v23
  v_dot2c_f32_bf16 v18, v231, v22
  v_dot2c_f32_bf16 v19, v231, v23
  v_mov_b32_dpp v20, v110 row_newbcast:4 row_mask:0xf bank_mask:0xf
  v_mov_b32_dpp v21, v102 row_newbcast:4 row_mask:0xf bank_mask:0xf
  s_waitcnt vmcnt(5)
  v_dot2c_f32_bf16 v12, v232, v20
  v_dot2c_f32_bf16 v13, v232, v21
  v_dot2c_f32_bf16 v14, v233, v20
  v_dot2c_f32_bf16 v15, v233, v21
  v_dot2c_f32_bf16 v16, v234, v20
  v_dot2c_f32_bf16 v17, v234, v21
  v_dot2c_f32_bf16 v18, v235, v20
  v_dot2c_f32_bf16 v19, v235, v21
  v_mov_b32_dpp v22, v110 row_newbcast:12 row_mask:0xf bank_mask:0xf
  v_mov_b32_dpp v23, v102 row_newbcast:12 row_mask:0xf bank_mask:0xf
  s_waitcnt vmcnt(4)
  v_dot2c_f32_bf16 v12, v236, v22
  v_dot2c_f32_bf16 v13, v236, v23
  v_dot2c_f32_bf16 v14, v237, v22
  v_dot2c_f32_bf16 v15, v237, v23
  v_dot2c_f32_bf16 v16, v238, v22
  v_dot2c_f32_bf16 v17, v238, v23
  v_dot2c_f32_bf16 v18, v239, v22
  v_dot2c_f32_bf16 v19, v239, v23
  v_mov_b32_dpp v20, v111 row_newbcast:0 row_mask:0xf bank_mask:0xf
  v_mov_b32_dpp v21, v103 row_newbcast:0 row_mask:0xf bank_mask:0xf
  s_waitcnt vmcnt(3)
  v_dot2c_f32_bf16 v12, v240, v20
  v_dot2c_f32_bf16 v13, v240, v21
  v_dot2c_f32_bf16 v14, v241, v20
  v_dot2c_f32_bf16 v15, v241, v21
  v_dot2c_f32_bf16 v16, v242, v20
  v_dot2c_f32_bf16 v17, v242, v21
  v_dot2c_f32_bf16 v18, v243, v20
  v_dot2c_f32_bf16 v19, v243, v21
  v_mov_b32_dpp v22, v111 row_newbcast:8 row_mask:0xf bank_mask:0xf
  v_mov_b32_dpp v23, v103 row_newbcast:8 row_mask:0xf bank_mask:0xf
  s_waitcnt vmcnt(2)
  v_dot2c_f32_bf16 v12, v244, v22
  v_dot2c_f32_bf16 v13, v244, v23
  v_dot2c_f32_bf16 v14, v245, v22
  v_dot2c_f32_bf16 v15, v245, v23
  v_dot2c_f32_bf16 v16, v246, v22
  v_dot2c_f32_bf16 v17, v246, v23
  v_dot2c_f32_bf16 v18, v247, v22
  v_dot2c_f32_bf16 v19, v247, v23
  v_mov_b32_dpp v20, v111 row_newbcast:4 row_mask:0xf bank_mask:0xf
  v_mov_b32_dpp v21, v103 row_newbcast:4 row_mask:0xf bank_mask:0xf
  s_waitcnt vmcnt(1)
  v_dot2c_f32_bf16 v12, v248, v20
  v_dot2c_f32_bf16 v13, v248, v21
  v_dot2c_f32_bf16 v14, v249, v20
  v_dot2c_f32_bf16 v15, v249, v21
  v_dot2c_f32_bf16 v16, v250, v20
  v_dot2c_f32_bf16 v17, v250, v21
  v_dot2c_f32_bf16 v18, v251, v20
  v_dot2c_f32_bf16 v19, v251, v21
  v_mov_b32_dpp v22, v111 row_newbcast:12 row_mask:0xf bank_mask:0xf
  v_mov_b32_dpp v23, v103 row_newbcast:12 row_mask:0xf bank_mask:0xf
  s_waitcnt vmcnt(0)
  v_dot2c_f32_bf16 v12, v252, v22
  v_dot2c_f32_bf16 v13, v252, v23
  v_dot2c_f32_bf16 v14, v253, v22
  v_dot2c_f32_bf16 v15, v253, v23
  v_dot2c_f32_bf16 v16, v254, v22
  v_dot2c_f32_bf16 v17, v254, v23
  v_dot2c_f32_bf16 v18, v255, v22
  v_dot2c_f32_bf16 v19, v255, v23
  s_branch L_tail
L_pv15:
  v_mov_b32 v8, 114752
  ds_read_b64 v[46:47], v8
  s_waitcnt lgkmcnt(0)
  v_sub_f32 v96, v96, v46
  v_mul_f32 v96, 0x3fb8aa3b, v96
  v_exp_f32 v96, v96
  v_sub_f32 v97, v97, v46
  v_mul_f32 v97, 0x3fb8aa3b, v97
  v_exp_f32 v97, v97
  v_sub_f32 v98, v98, v46
  v_mul_f32 v98, 0x3fb8aa3b, v98
  v_exp_f32 v98, v98
  v_sub_f32 v99, v99, v46
  v_mul_f32 v99, 0x3fb8aa3b, v99
  v_exp_f32 v99, v99
  v_sub_f32 v100, v100, v46
  v_mul_f32 v100, 0x3fb8aa3b, v100
  v_exp_f32 v100, v100
  v_sub_f32 v101, v101, v46
  v_mul_f32 v101, 0x3fb8aa3b, v101
  v_exp_f32 v101, v101
  v_sub_f32 v102, v102, v46
  v_mul_f32 v102, 0x3fb8aa3b, v102
  v_exp_f32 v102, v102
  v_sub_f32 v103, v103, v46
  v_mul_f32 v103, 0x3fb8aa3b, v103
  v_exp_f32 v103, v103
  s_nop 0
  v_mul_f32 v96, v96, v47
  v_mul_f32 v97, v97, v47
  v_cvt_pk_bf16_f32 v45, v96, v97
  v_lshlrev_b32 v96, 16, v45
  v_and_b32 v97, 0xffff0000, v45
  v_mul_f32 v98, v98, v47
  v_mul_f32 v99, v99, v47
  v_cvt_pk_bf16_f32 v45, v98, v99
  v_lshlrev_b32 v98, 16, v45
  v_and_b32 v99, 0xffff0000, v45
  v_mul_f32 v100, v100, v47
  v_mul_f32 v101, v101, v47
  v_cvt_pk_bf16_f32 v45, v100, v101
  v_lshlrev_b32 v100, 16, v45
  v_and_b32 v101, 0xffff0000, v45
  v_mul_f32 v102, v102, v47
  v_mul_f32 v103, v103, v47
  v_cvt_pk_bf16_f32 v45, v102, v103
  v_lshlrev_b32 v102, 16, v45
  v_and_b32 v103, 0xffff0000, v45
  v_lshrrev_b32 v104, 16, v96
  v_lshrrev_b32 v105, 16, v97
  v_lshrrev_b32 v106, 16, v98
  v_lshrrev_b32 v107, 16, v99
  v_lshrrev_b32 v108, 16, v100
  v_lshrrev_b32 v109, 16, v101
  v_lshrrev_b32 v110, 16, v102
  v_lshrrev_b32 v111, 16, v103
  v_mov_b32 v12, 0
  v_mov_b32 v13, 0
  v_mov_b32 v14, 0
  v_mov_b32 v15, 0
  v_mov_b32 v16, 0
  v_mov_b32 v17, 0
  v_mov_b32 v18, 0
  v_mov_b32 v19, 0
  v_add_u32 v7, s101, v6
  ds_read_b128 v[128:131], v7 offset:0
  v_mov_b32_dpp v20, v104 row_newbcast:0 row_mask:0xf bank_mask:0xf
  v_mov_b32_dpp v21, v96 row_newbcast:0 row_mask:0xf bank_mask:0xf
  s_waitcnt lgkmcnt(0)
  v_dot2c_f32_bf16 v12, v128, v20
  v_dot2c_f32_bf16 v13, v128, v21
  v_dot2c_f32_bf16 v14, v129, v20
  v_dot2c_f32_bf16 v15, v129, v21
  v_dot2c_f32_bf16 v16, v130, v20
  v_dot2c_f32_bf16 v17, v130, v21
  v_dot2c_f32_bf16 v18, v131, v20
  v_dot2c_f32_bf16 v19, v131, v21
  v_mov_b32_dpp v22, v104 row_newbcast:8 row_mask:0xf bank_mask:0xf
  v_mov_b32_dpp v23, v96 row_newbcast:8 row_mask:0xf bank_mask:0xf
  v_dot2c_f32_bf16 v12, v132, v22
  v_dot2c_f32_bf16 v13, v132, v23
  v_dot2c_f32_bf16 v14, v133, v22
  v_dot2c_f32_bf16 v15, v133, v23
  v_dot2c_f32_bf16 v16, v134, v22
  v_dot2c_f32_bf16 v17, v134, v23
  v_dot2c_f32_bf16 v18, v135, v22
  v_dot2c_f32_bf16 v19, v135, v23
  v_mov_b32_dpp v20, v104 row_newbcast:4 row_mask:0xf bank_mask:0xf
  v_mov_b32_dpp v21, v96 row_newbcast:4 row_mask:0xf bank_mask:0xf
  v_dot2c_f32_bf16 v12, v136, v20
  v_dot2c_f32_bf16 v13, v136, v21
  v_dot2c_f32_bf16 v14, v137, v20
  v_dot2c_f32_bf16 v15, v137, v21
  v_dot2c_f32_bf16 v16, v138, v20
  v_dot2c_f32_bf16 v17, v138, v21
  v_dot2c_f32_bf16 v18, v139, v20
  v_dot2c_f32_bf16 v19, v139, v21
  v_mov_b32_dpp v22, v104 row_newbcast:12 row_mask:0xf bank_mask:0xf
  v_mov_b32_dpp v23, v96 row_newbcast:12 row_mask:0xf bank_mask:0xf
  v_dot2c_f32_bf16 v12, v140, v22
  v_dot2c_f32_bf16 v13, v140, v23
  v_dot2c_f32_bf16 v14, v141, v22
  v_dot2c_f32_bf16 v15, v141, v23
  v_dot2c_f32_bf16 v16, v142, v22
  v_dot2c_f32_bf16 v17, v142, v23
  v_dot2c_f32_bf16 v18, v143, v22
  v_dot2c_f32_bf16 v19, v143, v23
  v_mov_b32_dpp v20, v105 row_newbcast:0 row_mask:0xf bank_mask:0xf
  v_mov_b32_dpp v21, v97 row_newbcast:0 row_mask:0xf bank_mask:0xf
  v_dot2c_f32_bf16 v12, v144, v20
  v_dot2c_f32_bf16 v13, v144, v21
  v_dot2c_f32_bf16 v14, v145, v20
  v_dot2c_f32_bf16 v15, v145, v21
  v_dot2c_f32_bf16 v16, v146, v20
  v_dot2c_f32_bf16 v17, v146, v21
  v_dot2c_f32_bf16 v18, v147, v20
  v_dot2c_f32_bf16 v19, v147, v21
  v_mov_b32_dpp v22, v105 row_newbcast:8 row_mask:0xf bank_mask:0xf
  v_mov_b32_dpp v23, v97 row_newbcast:8 row_mask:0xf bank_mask:0xf
  v_dot2c_f32_bf16 v12, v148, v22
  v_dot2c_f32_bf16 v13, v148, v23
  v_dot2c_f32_bf16 v14, v149, v22
  v_dot2c_f32_bf16 v15, v149, v23
  v_dot2c_f32_bf16 v16, v150, v22
  v_dot2c_f32_bf16 v17, v150, v23
  v_dot2c_f32_bf16 v18, v151, v22
  v_dot2c_f32_bf16 v19, v151, v23
  v_mov_b32_dpp v20, v105 row_newbcast:4 row_mask:0xf bank_mask:0xf
  v_mov_b32_dpp v21, v97 row_newbcast:4 row_mask:0xf bank_mask:0xf
  v_dot2c_f32_bf16 v12, v152, v20
  v_dot2c_f32_bf16 v13, v152, v21
  v_dot2c_f32_bf16 v14, v153, v20
  v_dot2c_f32_bf16 v15, v153, v21
  v_dot2c_f32_bf16 v16, v154, v20
  v_dot2c_f32_bf16 v17, v154, v21
  v_dot2c_f32_bf16 v18, v155, v20
  v_dot2c_f32_bf16 v19, v155, v21
  v_mov_b32_dpp v22, v105 row_newbcast:12 row_mask:0xf bank_mask:0xf
  v_mov_b32_dpp v23, v97 row_newbcast:12 row_mask:0xf bank_mask:0xf
  v_dot2c_f32_bf16 v12, v156, v22
  v_dot2c_f32_bf16 v13, v156, v23
  v_dot2c_f32_bf16 v14, v157, v22
  v_dot2c_f32_bf16 v15, v157, v23
  v_dot2c_f32_bf16 v16, v158, v22
  v_dot2c_f32_bf16 v17, v158, v23
  v_dot2c_f32_bf16 v18, v159, v22
  v_dot2c_f32_bf16 v19, v159, v23
  v_mov_b32_dpp v20, v106 row_newbcast:0 row_mask:0xf bank_mask:0xf
  v_mov_b32_dpp v21, v98 row_newbcast:0 row_mask:0xf bank_mask:0xf
  v_dot2c_f32_bf16 v12, v160, v20
  v_dot2c_f32_bf16 v13, v160, v21
  v_dot2c_f32_bf16 v14, v161, v20
  v_dot2c_f32_bf16 v15, v161, v21
  v_dot2c_f32_bf16 v16, v162, v20
  v_dot2c_f32_bf16 v17, v162, v21
  v_dot2c_f32_bf16 v18, v163, v20
  v_dot2c_f32_bf16 v19, v163, v21
  v_mov_b32_dpp v22, v106 row_newbcast:8 row_mask:0xf bank_mask:0xf
  v_mov_b32_dpp v23, v98 row_newbcast:8 row_mask:0xf bank_mask:0xf
  v_dot2c_f32_bf16 v12, v164, v22
  v_dot2c_f32_bf16 v13, v164, v23
  v_dot2c_f32_bf16 v14, v165, v22
  v_dot2c_f32_bf16 v15, v165, v23
  v_dot2c_f32_bf16 v16, v166, v22
  v_dot2c_f32_bf16 v17, v166, v23
  v_dot2c_f32_bf16 v18, v167, v22
  v_dot2c_f32_bf16 v19, v167, v23
  v_mov_b32_dpp v20, v106 row_newbcast:4 row_mask:0xf bank_mask:0xf
  v_mov_b32_dpp v21, v98 row_newbcast:4 row_mask:0xf bank_mask:0xf
  v_dot2c_f32_bf16 v12, v168, v20
  v_dot2c_f32_bf16 v13, v168, v21
  v_dot2c_f32_bf16 v14, v169, v20
  v_dot2c_f32_bf16 v15, v169, v21
  v_dot2c_f32_bf16 v16, v170, v20
  v_dot2c_f32_bf16 v17, v170, v21
  v_dot2c_f32_bf16 v18, v171, v20
  v_dot2c_f32_bf16 v19, v171, v21
  v_mov_b32_dpp v22, v106 row_newbcast:12 row_mask:0xf bank_mask:0xf
  v_mov_b32_dpp v23, v98 row_newbcast:12 row_mask:0xf bank_mask:0xf
  v_dot2c_f32_bf16 v12, v172, v22
  v_dot2c_f32_bf16 v13, v172, v23
  v_dot2c_f32_bf16 v14, v173, v22
  v_dot2c_f32_bf16 v15, v173, v23
  v_dot2c_f32_bf16 v16, v174, v22
  v_dot2c_f32_bf16 v17, v174, v23
  v_dot2c_f32_bf16 v18, v175, v22
  v_dot2c_f32_bf16 v19, v175, v23
  v_mov_b32_dpp v20, v107 row_newbcast:0 row_mask:0xf bank_mask:0xf
  v_mov_b32_dpp v21, v99 row_newbcast:0 row_mask:0xf bank_mask:0xf
  v_dot2c_f32_bf16 v12, v176, v20
  v_dot2c_f32_bf16 v13, v176, v21
  v_dot2c_f32_bf16 v14, v177, v20
  v_dot2c_f32_bf16 v15, v177, v21
  v_dot2c_f32_bf16 v16, v178, v20
  v_dot2c_f32_bf16 v17, v178, v21
  v_dot2c_f32_bf16 v18, v179, v20
  v_dot2c_f32_bf16 v19, v179, v21
  v_mov_b32_dpp v22, v107 row_newbcast:8 row_mask:0xf bank_mask:0xf
  v_mov_b32_dpp v23, v99 row_newbcast:8 row_mask:0xf bank_mask:0xf
  v_dot2c_f32_bf16 v12, v180, v22
  v_dot2c_f32_bf16 v13, v180, v23
  v_dot2c_f32_bf16 v14, v181, v22
  v_dot2c_f32_bf16 v15, v181, v23
  v_dot2c_f32_bf16 v16, v182, v22
  v_dot2c_f32_bf16 v17, v182, v23
  v_dot2c_f32_bf16 v18, v183, v22
  v_dot2c_f32_bf16 v19, v183, v23
  v_mov_b32_dpp v20, v107 row_newbcast:4 row_mask:0xf bank_mask:0xf
  v_mov_b32_dpp v21, v99 row_newbcast:4 row_mask:0xf bank_mask:0xf
  v_dot2c_f32_bf16 v12, v184, v20
  v_dot2c_f32_bf16 v13, v184, v21
  v_dot2c_f32_bf16 v14, v185, v20
  v_dot2c_f32_bf16 v15, v185, v21
  v_dot2c_f32_bf16 v16, v186, v20
  v_dot2c_f32_bf16 v17, v186, v21
  v_dot2c_f32_bf16 v18, v187, v20
  v_dot2c_f32_bf16 v19, v187, v21
  buffer_load_dwordx4 v[232:235], v4, s[44:47], s90 offen offset:2048 nt
  v_mov_b32_dpp v22, v107 row_newbcast:12 row_mask:0xf bank_mask:0xf
  v_mov_b32_dpp v23, v99 row_newbcast:12 row_mask:0xf bank_mask:0xf
  v_dot2c_f32_bf16 v12, v188, v22
  v_dot2c_f32_bf16 v13, v188, v23
  v_dot2c_f32_bf16 v14, v189, v22
  v_dot2c_f32_bf16 v15, v189, v23
  v_dot2c_f32_bf16 v16, v190, v22
  v_dot2c_f32_bf16 v17, v190, v23
  v_dot2c_f32_bf16 v18, v191, v22
  v_dot2c_f32_bf16 v19, v191, v23
  buffer_load_dwordx4 v[236:239], v4, s[44:47], s90 offen offset:3072 nt
  v_mov_b32_dpp v20, v108 row_newbcast:0 row_mask:0xf bank_mask:0xf
  v_mov_b32_dpp v21, v100 row_newbcast:0 row_mask:0xf bank_mask:0xf
  s_waitcnt vmcnt(11)
  v_dot2c_f32_bf16 v12, v192, v20
  v_dot2c_f32_bf16 v13, v192, v21
  v_dot2c_f32_bf16 v14, v193, v20
  v_dot2c_f32_bf16 v15, v193, v21
  v_dot2c_f32_bf16 v16, v194, v20
  v_dot2c_f32_bf16 v17, v194, v21
  v_dot2c_f32_bf16 v18, v195, v20
  v_dot2c_f32_bf16 v19, v195, v21
  buffer_load_dwordx4 v[240:243], v4, s[44:47], s91 offen offset:0 nt
  v_mov_b32_dpp v22, v108 row_newbcast:8 row_mask:0xf bank_mask:0xf
  v_mov_b32_dpp v23, v100 row_newbcast:8 row_mask:0xf bank_mask:0xf
  s_waitcnt vmcnt(11)
  v_dot2c_f32_bf16 v12, v196, v22
  v_dot2c_f32_bf16 v13, v196, v23
  v_dot2c_f32_bf16 v14, v197, v22
  v_dot2c_f32_bf16 v15, v197, v23
  v_dot2c_f32_bf16 v16, v198, v22
  v_dot2c_f32_bf16 v17, v198, v23
  v_dot2c_f32_bf16 v18, v199, v22
  v_dot2c_f32_bf16 v19, v199, v23
  buffer_load_dwordx4 v[244:247], v4, s[44:47], s91 offen offset:1024 nt
  v_mov_b32_dpp v20, v108 row_newbcast:4 row_mask:0xf bank_mask:0xf
  v_mov_b32_dpp v21, v100 row_newbcast:4 row_mask:0xf bank_mask:0xf
  s_waitcnt vmcnt(11)
  v_dot2c_f32_bf16 v12, v200, v20
  v_dot2c_f32_bf16 v13, v200, v21
  v_dot2c_f32_bf16 v14, v201, v20
  v_dot2c_f32_bf16 v15, v201, v21
  v_dot2c_f32_bf16 v16, v202, v20
  v_dot2c_f32_bf16 v17, v202, v21
  v_dot2c_f32_bf16 v18, v203, v20
  v_dot2c_f32_bf16 v19, v203, v21
  buffer_load_dwordx4 v[248:251], v4, s[44:47], s91 offen offset:2048 nt
  v_mov_b32_dpp v22, v108 row_newbcast:12 row_mask:0xf bank_mask:0xf
  v_mov_b32_dpp v23, v100 row_newbcast:12 row_mask:0xf bank_mask:0xf
  s_waitcnt vmcnt(11)
  v_dot2c_f32_bf16 v12, v204, v22
  v_dot2c_f32_bf16 v13, v204, v23
  v_dot2c_f32_bf16 v14, v205, v22
  v_dot2c_f32_bf16 v15, v205, v23
  v_dot2c_f32_bf16 v16, v206, v22
  v_dot2c_f32_bf16 v17, v206, v23
  v_dot2c_f32_bf16 v18, v207, v22
  v_dot2c_f32_bf16 v19, v207, v23
  buffer_load_dwordx4 v[252:255], v4, s[44:47], s91 offen offset:3072 nt
  v_mov_b32_dpp v20, v109 row_newbcast:0 row_mask:0xf bank_mask:0xf
  v_mov_b32_dpp v21, v101 row_newbcast:0 row_mask:0xf bank_mask:0xf
  s_waitcnt vmcnt(11)
  v_dot2c_f32_bf16 v12, v208, v20
  v_dot2c_f32_bf16 v13, v208, v21
  v_dot2c_f32_bf16 v14, v209, v20
  v_dot2c_f32_bf16 v15, v209, v21
  v_dot2c_f32_bf16 v16, v210, v20
  v_dot2c_f32_bf16 v17, v210, v21
  v_dot2c_f32_bf16 v18, v211, v20
  v_dot2c_f32_bf16 v19, v211, v21
  v_mov_b32_dpp v22, v109 row_newbcast:8 row_mask:0xf bank_mask:0xf
  v_mov_b32_dpp v23, v101 row_newbcast:8 row_mask:0xf bank_mask:0xf
  s_waitcnt vmcnt(10)
  v_dot2c_f32_bf16 v12, v212, v22
  v_dot2c_f32_bf16 v13, v212, v23
  v_dot2c_f32_bf16 v14, v213, v22
  v_dot2c_f32_bf16 v15, v213, v23
  v_dot2c_f32_bf16 v16, v214, v22
  v_dot2c_f32_bf16 v17, v214, v23
  v_dot2c_f32_bf16 v18, v215, v22
  v_dot2c_f32_bf16 v19, v215, v23
  v_mov_b32_dpp v20, v109 row_newbcast:4 row_mask:0xf bank_mask:0xf
  v_mov_b32_dpp v21, v101 row_newbcast:4 row_mask:0xf bank_mask:0xf
  s_waitcnt vmcnt(9)
  v_dot2c_f32_bf16 v12, v216, v20
  v_dot2c_f32_bf16 v13, v216, v21
  v_dot2c_f32_bf16 v14, v217, v20
  v_dot2c_f32_bf16 v15, v217, v21
  v_dot2c_f32_bf16 v16, v218, v20
  v_dot2c_f32_bf16 v17, v218, v21
  v_dot2c_f32_bf16 v18, v219, v20
  v_dot2c_f32_bf16 v19, v219, v21
  v_mov_b32_dpp v22, v109 row_newbcast:12 row_mask:0xf bank_mask:0xf
  v_mov_b32_dpp v23, v101 row_newbcast:12 row_mask:0xf bank_mask:0xf
  s_waitcnt vmcnt(8)
  v_dot2c_f32_bf16 v12, v220, v22
  v_dot2c_f32_bf16 v13, v220, v23
  v_dot2c_f32_bf16 v14, v221, v22
  v_dot2c_f32_bf16 v15, v221, v23
  v_dot2c_f32_bf16 v16, v222, v22
  v_dot2c_f32_bf16 v17, v222, v23
  v_dot2c_f32_bf16 v18, v223, v22
  v_dot2c_f32_bf16 v19, v223, v23
  v_mov_b32_dpp v20, v110 row_newbcast:0 row_mask:0xf bank_mask:0xf
  v_mov_b32_dpp v21, v102 row_newbcast:0 row_mask:0xf bank_mask:0xf
  s_waitcnt vmcnt(7)
  v_dot2c_f32_bf16 v12, v224, v20
  v_dot2c_f32_bf16 v13, v224, v21
  v_dot2c_f32_bf16 v14, v225, v20
  v_dot2c_f32_bf16 v15, v225, v21
  v_dot2c_f32_bf16 v16, v226, v20
  v_dot2c_f32_bf16 v17, v226, v21
  v_dot2c_f32_bf16 v18, v227, v20
  v_dot2c_f32_bf16 v19, v227, v21
  v_mov_b32_dpp v22, v110 row_newbcast:8 row_mask:0xf bank_mask:0xf
  v_mov_b32_dpp v23, v102 row_newbcast:8 row_mask:0xf bank_mask:0xf
  s_waitcnt vmcnt(6)
  v_dot2c_f32_bf16 v12, v228, v22
  v_dot2c_f32_bf16 v13, v228, v23
  v_dot2c_f32_bf16 v14, v229, v22
  v_dot2c_f32_bf16 v15, v229, v23
  v_dot2c_f32_bf16 v16, v230, v22
  v_dot2c_f32_bf16 v17, v230, v23
  v_dot2c_f32_bf16 v18, v231, v22
  v_dot2c_f32_bf16 v19, v231, v23
  v_mov_b32_dpp v20, v110 row_newbcast:4 row_mask:0xf bank_mask:0xf
  v_mov_b32_dpp v21, v102 row_newbcast:4 row_mask:0xf bank_mask:0xf
  s_waitcnt vmcnt(5)
  v_dot2c_f32_bf16 v12, v232, v20
  v_dot2c_f32_bf16 v13, v232, v21
  v_dot2c_f32_bf16 v14, v233, v20
  v_dot2c_f32_bf16 v15, v233, v21
  v_dot2c_f32_bf16 v16, v234, v20
  v_dot2c_f32_bf16 v17, v234, v21
  v_dot2c_f32_bf16 v18, v235, v20
  v_dot2c_f32_bf16 v19, v235, v21
  v_mov_b32_dpp v22, v110 row_newbcast:12 row_mask:0xf bank_mask:0xf
  v_mov_b32_dpp v23, v102 row_newbcast:12 row_mask:0xf bank_mask:0xf
  s_waitcnt vmcnt(4)
  v_dot2c_f32_bf16 v12, v236, v22
  v_dot2c_f32_bf16 v13, v236, v23
  v_dot2c_f32_bf16 v14, v237, v22
  v_dot2c_f32_bf16 v15, v237, v23
  v_dot2c_f32_bf16 v16, v238, v22
  v_dot2c_f32_bf16 v17, v238, v23
  v_dot2c_f32_bf16 v18, v239, v22
  v_dot2c_f32_bf16 v19, v239, v23
  v_mov_b32_dpp v20, v111 row_newbcast:0 row_mask:0xf bank_mask:0xf
  v_mov_b32_dpp v21, v103 row_newbcast:0 row_mask:0xf bank_mask:0xf
  s_waitcnt vmcnt(3)
  v_dot2c_f32_bf16 v12, v240, v20
  v_dot2c_f32_bf16 v13, v240, v21
  v_dot2c_f32_bf16 v14, v241, v20
  v_dot2c_f32_bf16 v15, v241, v21
  v_dot2c_f32_bf16 v16, v242, v20
  v_dot2c_f32_bf16 v17, v242, v21
  v_dot2c_f32_bf16 v18, v243, v20
  v_dot2c_f32_bf16 v19, v243, v21
  v_mov_b32_dpp v22, v111 row_newbcast:8 row_mask:0xf bank_mask:0xf
  v_mov_b32_dpp v23, v103 row_newbcast:8 row_mask:0xf bank_mask:0xf
  s_waitcnt vmcnt(2)
  v_dot2c_f32_bf16 v12, v244, v22
  v_dot2c_f32_bf16 v13, v244, v23
  v_dot2c_f32_bf16 v14, v245, v22
  v_dot2c_f32_bf16 v15, v245, v23
  v_dot2c_f32_bf16 v16, v246, v22
  v_dot2c_f32_bf16 v17, v246, v23
  v_dot2c_f32_bf16 v18, v247, v22
  v_dot2c_f32_bf16 v19, v247, v23
  v_mov_b32_dpp v20, v111 row_newbcast:4 row_mask:0xf bank_mask:0xf
  v_mov_b32_dpp v21, v103 row_newbcast:4 row_mask:0xf bank_mask:0xf
  s_waitcnt vmcnt(1)
  v_dot2c_f32_bf16 v12, v248, v20
  v_dot2c_f32_bf16 v13, v248, v21
  v_dot2c_f32_bf16 v14, v249, v20
  v_dot2c_f32_bf16 v15, v249, v21
  v_dot2c_f32_bf16 v16, v250, v20
  v_dot2c_f32_bf16 v17, v250, v21
  v_dot2c_f32_bf16 v18, v251, v20
  v_dot2c_f32_bf16 v19, v251, v21
  v_mov_b32_dpp v22, v111 row_newbcast:12 row_mask:0xf bank_mask:0xf
  v_mov_b32_dpp v23, v103 row_newbcast:12 row_mask:0xf bank_mask:0xf
  s_waitcnt vmcnt(0)
  v_dot2c_f32_bf16 v12, v252, v22
  v_dot2c_f32_bf16 v13, v252, v23
  v_dot2c_f32_bf16 v14, v253, v22
  v_dot2c_f32_bf16 v15, v253, v23
  v_dot2c_f32_bf16 v16, v254, v22
  v_dot2c_f32_bf16 v17, v254, v23
  v_dot2c_f32_bf16 v18, v255, v22
  v_dot2c_f32_bf16 v19, v255, v23
  s_branch L_tail
L_pv18:
  v_mov_b32 v8, 114752
  ds_read_b64 v[46:47], v8
  s_waitcnt lgkmcnt(0)
  v_sub_f32 v96, v96, v46
  v_mul_f32 v96, 0x3fb8aa3b, v96
  v_exp_f32 v96, v96
  v_sub_f32 v97, v97, v46
  v_mul_f32 v97, 0x3fb8aa3b, v97
  v_exp_f32 v97, v97
  v_sub_f32 v98, v98, v46
  v_mul_f32 v98, 0x3fb8aa3b, v98
  v_exp_f32 v98, v98
  v_sub_f32 v99, v99, v46
  v_mul_f32 v99, 0x3fb8aa3b, v99
  v_exp_f32 v99, v99
  v_sub_f32 v100, v100, v46
  v_mul_f32 v100, 0x3fb8aa3b, v100
  v_exp_f32 v100, v100
  v_sub_f32 v101, v101, v46
  v_mul_f32 v101, 0x3fb8aa3b, v101
  v_exp_f32 v101, v101
  v_sub_f32 v102, v102, v46
  v_mul_f32 v102, 0x3fb8aa3b, v102
  v_exp_f32 v102, v102
  v_sub_f32 v103, v103, v46
  v_mul_f32 v103, 0x3fb8aa3b, v103
  v_exp_f32 v103, v103
  s_nop 0
  v_mul_f32 v96, v96, v47
  v_mul_f32 v97, v97, v47
  v_cvt_pk_bf16_f32 v45, v96, v97
  v_lshlrev_b32 v96, 16, v45
  v_and_b32 v97, 0xffff0000, v45
  v_mul_f32 v98, v98, v47
  v_mul_f32 v99, v99, v47
  v_cvt_pk_bf16_f32 v45, v98, v99
  v_lshlrev_b32 v98, 16, v45
  v_and_b32 v99, 0xffff0000, v45
  v_mul_f32 v100, v100, v47
  v_mul_f32 v101, v101, v47
  v_cvt_pk_bf16_f32 v45, v100, v101
  v_lshlrev_b32 v100, 16, v45
  v_and_b32 v101, 0xffff0000, v45
  v_mul_f32 v102, v102, v47
  v_mul_f32 v103, v103, v47
  v_cvt_pk_bf16_f32 v45, v102, v103
  v_lshlrev_b32 v102, 16, v45
  v_and_b32 v103, 0xffff0000, v45
  v_lshrrev_b32 v104, 16, v96
  v_lshrrev_b32 v105, 16, v97
  v_lshrrev_b32 v106, 16, v98
  v_lshrrev_b32 v107, 16, v99
  v_lshrrev_b32 v108, 16, v100
  v_lshrrev_b32 v109, 16, v101
  v_lshrrev_b32 v110, 16, v102
  v_lshrrev_b32 v111, 16, v103
  v_mov_b32 v12, 0
  v_mov_b32 v13, 0
  v_mov_b32 v14, 0
  v_mov_b32 v15, 0
  v_mov_b32 v16, 0
  v_mov_b32 v17, 0
  v_mov_b32 v18, 0
  v_mov_b32 v19, 0
  v_add_u32 v7, s101, v6
  ds_read_b128 v[128:131], v7 offset:0
  v_mov_b32_dpp v20, v104 row_newbcast:0 row_mask:0xf bank_mask:0xf
  v_mov_b32_dpp v21, v96 row_newbcast:0 row_mask:0xf bank_mask:0xf
  s_waitcnt lgkmcnt(0)
  v_dot2c_f32_bf16 v12, v128, v20
  v_dot2c_f32_bf16 v13, v128, v21
  v_dot2c_f32_bf16 v14, v129, v20
  v_dot2c_f32_bf16 v15, v129, v21
  v_dot2c_f32_bf16 v16, v130, v20
  v_dot2c_f32_bf16 v17, v130, v21
  v_dot2c_f32_bf16 v18, v131, v20
  v_dot2c_f32_bf16 v19, v131, v21
  v_mov_b32_dpp v22, v104 row_newbcast:8 row_mask:0xf bank_mask:0xf
  v_mov_b32_dpp v23, v96 row_newbcast:8 row_mask:0xf bank_mask:0xf
  v_dot2c_f32_bf16 v12, v132, v22
  v_dot2c_f32_bf16 v13, v132, v23
  v_dot2c_f32_bf16 v14, v133, v22
  v_dot2c_f32_bf16 v15, v133, v23
  v_dot2c_f32_bf16 v16, v134, v22
  v_dot2c_f32_bf16 v17, v134, v23
  v_dot2c_f32_bf16 v18, v135, v22
  v_dot2c_f32_bf16 v19, v135, v23
  v_mov_b32_dpp v20, v104 row_newbcast:4 row_mask:0xf bank_mask:0xf
  v_mov_b32_dpp v21, v96 row_newbcast:4 row_mask:0xf bank_mask:0xf
  v_dot2c_f32_bf16 v12, v136, v20
  v_dot2c_f32_bf16 v13, v136, v21
  v_dot2c_f32_bf16 v14, v137, v20
  v_dot2c_f32_bf16 v15, v137, v21
  v_dot2c_f32_bf16 v16, v138, v20
  v_dot2c_f32_bf16 v17, v138, v21
  v_dot2c_f32_bf16 v18, v139, v20
  v_dot2c_f32_bf16 v19, v139, v21
  v_mov_b32_dpp v22, v104 row_newbcast:12 row_mask:0xf bank_mask:0xf
  v_mov_b32_dpp v23, v96 row_newbcast:12 row_mask:0xf bank_mask:0xf
  v_dot2c_f32_bf16 v12, v140, v22
  v_dot2c_f32_bf16 v13, v140, v23
  v_dot2c_f32_bf16 v14, v141, v22
  v_dot2c_f32_bf16 v15, v141, v23
  v_dot2c_f32_bf16 v16, v142, v22
  v_dot2c_f32_bf16 v17, v142, v23
  v_dot2c_f32_bf16 v18, v143, v22
  v_dot2c_f32_bf16 v19, v143, v23
  v_mov_b32_dpp v20, v105 row_newbcast:0 row_mask:0xf bank_mask:0xf
  v_mov_b32_dpp v21, v97 row_newbcast:0 row_mask:0xf bank_mask:0xf
  v_dot2c_f32_bf16 v12, v144, v20
  v_dot2c_f32_bf16 v13, v144, v21
  v_dot2c_f32_bf16 v14, v145, v20
  v_dot2c_f32_bf16 v15, v145, v21
  v_dot2c_f32_bf16 v16, v146, v20
  v_dot2c_f32_bf16 v17, v146, v21
  v_dot2c_f32_bf16 v18, v147, v20
  v_dot2c_f32_bf16 v19, v147, v21
  v_mov_b32_dpp v22, v105 row_newbcast:8 row_mask:0xf bank_mask:0xf
  v_mov_b32_dpp v23, v97 row_newbcast:8 row_mask:0xf bank_mask:0xf
  v_dot2c_f32_bf16 v12, v148, v22
  v_dot2c_f32_bf16 v13, v148, v23
  v_dot2c_f32_bf16 v14, v149, v22
  v_dot2c_f32_bf16 v15, v149, v23
  v_dot2c_f32_bf16 v16, v150, v22
  v_dot2c_f32_bf16 v17, v150, v23
  v_dot2c_f32_bf16 v18, v151, v22
  v_dot2c_f32_bf16 v19, v151, v23
  v_mov_b32_dpp v20, v105 row_newbcast:4 row_mask:0xf bank_mask:0xf
  v_mov_b32_dpp v21, v97 row_newbcast:4 row_mask:0xf bank_mask:0xf
  v_dot2c_f32_bf16 v12, v152, v20
  v_dot2c_f32_bf16 v13, v152, v21
  v_dot2c_f32_bf16 v14, v153, v20
  v_dot2c_f32_bf16 v15, v153, v21
  v_dot2c_f32_bf16 v16, v154, v20
  v_dot2c_f32_bf16 v17, v154, v21
  v_dot2c_f32_bf16 v18, v155, v20
  v_dot2c_f32_bf16 v19, v155, v21
  v_mov_b32_dpp v22, v105 row_newbcast:12 row_mask:0xf bank_mask:0xf
  v_mov_b32_dpp v23, v97 row_newbcast:12 row_mask:0xf bank_mask:0xf
  v_dot2c_f32_bf16 v12, v156, v22
  v_dot2c_f32_bf16 v13, v156, v23
  v_dot2c_f32_bf16 v14, v157, v22
  v_dot2c_f32_bf16 v15, v157, v23
  v_dot2c_f32_bf16 v16, v158, v22
  v_dot2c_f32_bf16 v17, v158, v23
  v_dot2c_f32_bf16 v18, v159, v22
  v_dot2c_f32_bf16 v19, v159, v23
  v_mov_b32_dpp v20, v106 row_newbcast:0 row_mask:0xf bank_mask:0xf
  v_mov_b32_dpp v21, v98 row_newbcast:0 row_mask:0xf bank_mask:0xf
  v_dot2c_f32_bf16 v12, v160, v20
  v_dot2c_f32_bf16 v13, v160, v21
  v_dot2c_f32_bf16 v14, v161, v20
  v_dot2c_f32_bf16 v15, v161, v21
  v_dot2c_f32_bf16 v16, v162, v20
  v_dot2c_f32_bf16 v17, v162, v21
  v_dot2c_f32_bf16 v18, v163, v20
  v_dot2c_f32_bf16 v19, v163, v21
  v_mov_b32_dpp v22, v106 row_newbcast:8 row_mask:0xf bank_mask:0xf
  v_mov_b32_dpp v23, v98 row_newbcast:8 row_mask:0xf bank_mask:0xf
  v_dot2c_f32_bf16 v12, v164, v22
  v_dot2c_f32_bf16 v13, v164, v23
  v_dot2c_f32_bf16 v14, v165, v22
  v_dot2c_f32_bf16 v15, v165, v23
  v_dot2c_f32_bf16 v16, v166, v22
  v_dot2c_f32_bf16 v17, v166, v23
  v_dot2c_f32_bf16 v18, v167, v22
  v_dot2c_f32_bf16 v19, v167, v23
  v_mov_b32_dpp v20, v106 row_newbcast:4 row_mask:0xf bank_mask:0xf
  v_mov_b32_dpp v21, v98 row_newbcast:4 row_mask:0xf bank_mask:0xf
  v_dot2c_f32_bf16 v12, v168, v20
  v_dot2c_f32_bf16 v13, v168, v21
  v_dot2c_f32_bf16 v14, v169, v20
  v_dot2c_f32_bf16 v15, v169, v21
  v_dot2c_f32_bf16 v16, v170, v20
  v_dot2c_f32_bf16 v17, v170, v21
  v_dot2c_f32_bf16 v18, v171, v20
  v_dot2c_f32_bf16 v19, v171, v21
  v_mov_b32_dpp v22, v106 row_newbcast:12 row_mask:0xf bank_mask:0xf
  v_mov_b32_dpp v23, v98 row_newbcast:12 row_mask:0xf bank_mask:0xf
  v_dot2c_f32_bf16 v12, v172, v22
  v_dot2c_f32_bf16 v13, v172, v23
  v_dot2c_f32_bf16 v14, v173, v22
  v_dot2c_f32_bf16 v15, v173, v23
  v_dot2c_f32_bf16 v16, v174, v22
  v_dot2c_f32_bf16 v17, v174, v23
  v_dot2c_f32_bf16 v18, v175, v22
  v_dot2c_f32_bf16 v19, v175, v23
  v_mov_b32_dpp v20, v107 row_newbcast:0 row_mask:0xf bank_mask:0xf
  v_mov_b32_dpp v21, v99 row_newbcast:0 row_mask:0xf bank_mask:0xf
  v_dot2c_f32_bf16 v12, v176, v20
  v_dot2c_f32_bf16 v13, v176, v21
  v_dot2c_f32_bf16 v14, v177, v20
  v_dot2c_f32_bf16 v15, v177, v21
  v_dot2c_f32_bf16 v16, v178, v20
  v_dot2c_f32_bf16 v17, v178, v21
  v_dot2c_f32_bf16 v18, v179, v20
  v_dot2c_f32_bf16 v19, v179, v21
  v_mov_b32_dpp v22, v107 row_newbcast:8 row_mask:0xf bank_mask:0xf
  v_mov_b32_dpp v23, v99 row_newbcast:8 row_mask:0xf bank_mask:0xf
  v_dot2c_f32_bf16 v12, v180, v22
  v_dot2c_f32_bf16 v13, v180, v23
  v_dot2c_f32_bf16 v14, v181, v22
  v_dot2c_f32_bf16 v15, v181, v23
  v_dot2c_f32_bf16 v16, v182, v22
  v_dot2c_f32_bf16 v17, v182, v23
  v_dot2c_f32_bf16 v18, v183, v22
  v_dot2c_f32_bf16 v19, v183, v23
  v_mov_b32_dpp v20, v107 row_newbcast:4 row_mask:0xf bank_mask:0xf
  v_mov_b32_dpp v21, v99 row_newbcast:4 row_mask:0xf bank_mask:0xf
  v_dot2c_f32_bf16 v12, v184, v20
  v_dot2c_f32_bf16 v13, v184, v21
  v_dot2c_f32_bf16 v14, v185, v20
  v_dot2c_f32_bf16 v15, v185, v21
  v_dot2c_f32_bf16 v16, v186, v20
  v_dot2c_f32_bf16 v17, v186, v21
  v_dot2c_f32_bf16 v18, v187, v20
  v_dot2c_f32_bf16 v19, v187, v21
  v_mov_b32_dpp v22, v107 row_newbcast:12 row_mask:0xf bank_mask:0xf
  v_mov_b32_dpp v23, v99 row_newbcast:12 row_mask:0xf bank_mask:0xf
  v_dot2c_f32_bf16 v12, v188, v22
  v_dot2c_f32_bf16 v13, v188, v23
  v_dot2c_f32_bf16 v14, v189, v22
  v_dot2c_f32_bf16 v15, v189, v23
  v_dot2c_f32_bf16 v16, v190, v22
  v_dot2c_f32_bf16 v17, v190, v23
  v_dot2c_f32_bf16 v18, v191, v22
  v_dot2c_f32_bf16 v19, v191, v23
  v_mov_b32_dpp v20, v108 row_newbcast:0 row_mask:0xf bank_mask:0xf
  v_mov_b32_dpp v21, v100 row_newbcast:0 row_mask:0xf bank_mask:0xf
  v_dot2c_f32_bf16 v12, v192, v20
  v_dot2c_f32_bf16 v13, v192, v21
  v_dot2c_f32_bf16 v14, v193, v20
  v_dot2c_f32_bf16 v15, v193, v21
  v_dot2c_f32_bf16 v16, v194, v20
  v_dot2c_f32_bf16 v17, v194, v21
  v_dot2c_f32_bf16 v18, v195, v20
  v_dot2c_f32_bf16 v19, v195, v21
  v_mov_b32_dpp v22, v108 row_newbcast:8 row_mask:0xf bank_mask:0xf
  v_mov_b32_dpp v23, v100 row_newbcast:8 row_mask:0xf bank_mask:0xf
  v_dot2c_f32_bf16 v12, v196, v22
  v_dot2c_f32_bf16 v13, v196, v23
  v_dot2c_f32_bf16 v14, v197, v22
  v_dot2c_f32_bf16 v15, v197, v23
  v_dot2c_f32_bf16 v16, v198, v22
  v_dot2c_f32_bf16 v17, v198, v23
  v_dot2c_f32_bf16 v18, v199, v22
  v_dot2c_f32_bf16 v19, v199, v23
  buffer_load_dwordx4 v[244:247], v4, s[44:47], s91 offen offset:1024 nt
  v_mov_b32_dpp v20, v108 row_newbcast:4 row_mask:0xf bank_mask:0xf
  v_mov_b32_dpp v21, v100 row_newbcast:4 row_mask:0xf bank_mask:0xf
  v_dot2c_f32_bf16 v12, v200, v20
  v_dot2c_f32_bf16 v13, v200, v21
  v_dot2c_f32_bf16 v14, v201, v20
  v_dot2c_f32_bf16 v15, v201, v21
  v_dot2c_f32_bf16 v16, v202, v20
  v_dot2c_f32_bf16 v17, v202, v21
  v_dot2c_f32_bf16 v18, v203, v20
  v_dot2c_f32_bf16 v19, v203, v21
  buffer_load_dwordx4 v[248:251], v4, s[44:47], s91 offen offset:2048 nt
  v_mov_b32_dpp v22, v108 row_newbcast:12 row_mask:0xf bank_mask:0xf
  v_mov_b32_dpp v23, v100 row_newbcast:12 row_mask:0xf bank_mask:0xf
  s_waitcnt vmcnt(11)
  v_dot2c_f32_bf16 v12, v204, v22
  v_dot2c_f32_bf16 v13, v204, v23
  v_dot2c_f32_bf16 v14, v205, v22
  v_dot2c_f32_bf16 v15, v205, v23
  v_dot2c_f32_bf16 v16, v206, v22
  v_dot2c_f32_bf16 v17, v206, v23
  v_dot2c_f32_bf16 v18, v207, v22
  v_dot2c_f32_bf16 v19, v207, v23
  buffer_load_dwordx4 v[252:255], v4, s[44:47], s91 offen offset:3072 nt
  v_mov_b32_dpp v20, v109 row_newbcast:0 row_mask:0xf bank_mask:0xf
  v_mov_b32_dpp v21, v101 row_newbcast:0 row_mask:0xf bank_mask:0xf
  s_waitcnt vmcnt(11)
  v_dot2c_f32_bf16 v12, v208, v20
  v_dot2c_f32_bf16 v13, v208, v21
  v_dot2c_f32_bf16 v14, v209, v20
  v_dot2c_f32_bf16 v15, v209, v21
  v_dot2c_f32_bf16 v16, v210, v20
  v_dot2c_f32_bf16 v17, v210, v21
  v_dot2c_f32_bf16 v18, v211, v20
  v_dot2c_f32_bf16 v19, v211, v21
  v_mov_b32_dpp v22, v109 row_newbcast:8 row_mask:0xf bank_mask:0xf
  v_mov_b32_dpp v23, v101 row_newbcast:8 row_mask:0xf bank_mask:0xf
  s_waitcnt vmcnt(10)
  v_dot2c_f32_bf16 v12, v212, v22
  v_dot2c_f32_bf16 v13, v212, v23
  v_dot2c_f32_bf16 v14, v213, v22
  v_dot2c_f32_bf16 v15, v213, v23
  v_dot2c_f32_bf16 v16, v214, v22
  v_dot2c_f32_bf16 v17, v214, v23
  v_dot2c_f32_bf16 v18, v215, v22
  v_dot2c_f32_bf16 v19, v215, v23
  v_mov_b32_dpp v20, v109 row_newbcast:4 row_mask:0xf bank_mask:0xf
  v_mov_b32_dpp v21, v101 row_newbcast:4 row_mask:0xf bank_mask:0xf
  s_waitcnt vmcnt(9)
  v_dot2c_f32_bf16 v12, v216, v20
  v_dot2c_f32_bf16 v13, v216, v21
  v_dot2c_f32_bf16 v14, v217, v20
  v_dot2c_f32_bf16 v15, v217, v21
  v_dot2c_f32_bf16 v16, v218, v20
  v_dot2c_f32_bf16 v17, v218, v21
  v_dot2c_f32_bf16 v18, v219, v20
  v_dot2c_f32_bf16 v19, v219, v21
  v_mov_b32_dpp v22, v109 row_newbcast:12 row_mask:0xf bank_mask:0xf
  v_mov_b32_dpp v23, v101 row_newbcast:12 row_mask:0xf bank_mask:0xf
  s_waitcnt vmcnt(8)
  v_dot2c_f32_bf16 v12, v220, v22
  v_dot2c_f32_bf16 v13, v220, v23
  v_dot2c_f32_bf16 v14, v221, v22
  v_dot2c_f32_bf16 v15, v221, v23
  v_dot2c_f32_bf16 v16, v222, v22
  v_dot2c_f32_bf16 v17, v222, v23
  v_dot2c_f32_bf16 v18, v223, v22
  v_dot2c_f32_bf16 v19, v223, v23
  v_mov_b32_dpp v20, v110 row_newbcast:0 row_mask:0xf bank_mask:0xf
  v_mov_b32_dpp v21, v102 row_newbcast:0 row_mask:0xf bank_mask:0xf
  s_waitcnt vmcnt(7)
  v_dot2c_f32_bf16 v12, v224, v20
  v_dot2c_f32_bf16 v13, v224, v21
  v_dot2c_f32_bf16 v14, v225, v20
  v_dot2c_f32_bf16 v15, v225, v21
  v_dot2c_f32_bf16 v16, v226, v20
  v_dot2c_f32_bf16 v17, v226, v21
  v_dot2c_f32_bf16 v18, v227, v20
  v_dot2c_f32_bf16 v19, v227, v21
  v_mov_b32_dpp v22, v110 row_newbcast:8 row_mask:0xf bank_mask:0xf
  v_mov_b32_dpp v23, v102 row_newbcast:8 row_mask:0xf bank_mask:0xf
  s_waitcnt vmcnt(6)
  v_dot2c_f32_bf16 v12, v228, v22
  v_dot2c_f32_bf16 v13, v228, v23
  v_dot2c_f32_bf16 v14, v229, v22
  v_dot2c_f32_bf16 v15, v229, v23
  v_dot2c_f32_bf16 v16, v230, v22
  v_dot2c_f32_bf16 v17, v230, v23
  v_dot2c_f32_bf16 v18, v231, v22
  v_dot2c_f32_bf16 v19, v231, v23
  v_mov_b32_dpp v20, v110 row_newbcast:4 row_mask:0xf bank_mask:0xf
  v_mov_b32_dpp v21, v102 row_newbcast:4 row_mask:0xf bank_mask:0xf
  s_waitcnt vmcnt(5)
  v_dot2c_f32_bf16 v12, v232, v20
  v_dot2c_f32_bf16 v13, v232, v21
  v_dot2c_f32_bf16 v14, v233, v20
  v_dot2c_f32_bf16 v15, v233, v21
  v_dot2c_f32_bf16 v16, v234, v20
  v_dot2c_f32_bf16 v17, v234, v21
  v_dot2c_f32_bf16 v18, v235, v20
  v_dot2c_f32_bf16 v19, v235, v21
  v_mov_b32_dpp v22, v110 row_newbcast:12 row_mask:0xf bank_mask:0xf
  v_mov_b32_dpp v23, v102 row_newbcast:12 row_mask:0xf bank_mask:0xf
  s_waitcnt vmcnt(4)
  v_dot2c_f32_bf16 v12, v236, v22
  v_dot2c_f32_bf16 v13, v236, v23
  v_dot2c_f32_bf16 v14, v237, v22
  v_dot2c_f32_bf16 v15, v237, v23
  v_dot2c_f32_bf16 v16, v238, v22
  v_dot2c_f32_bf16 v17, v238, v23
  v_dot2c_f32_bf16 v18, v239, v22
  v_dot2c_f32_bf16 v19, v239, v23
  v_mov_b32_dpp v20, v111 row_newbcast:0 row_mask:0xf bank_mask:0xf
  v_mov_b32_dpp v21, v103 row_newbcast:0 row_mask:0xf bank_mask:0xf
  s_waitcnt vmcnt(3)
  v_dot2c_f32_bf16 v12, v240, v20
  v_dot2c_f32_bf16 v13, v240, v21
  v_dot2c_f32_bf16 v14, v241, v20
  v_dot2c_f32_bf16 v15, v241, v21
  v_dot2c_f32_bf16 v16, v242, v20
  v_dot2c_f32_bf16 v17, v242, v21
  v_dot2c_f32_bf16 v18, v243, v20
  v_dot2c_f32_bf16 v19, v243, v21
  v_mov_b32_dpp v22, v111 row_newbcast:8 row_mask:0xf bank_mask:0xf
  v_mov_b32_dpp v23, v103 row_newbcast:8 row_mask:0xf bank_mask:0xf
  s_waitcnt vmcnt(2)
  v_dot2c_f32_bf16 v12, v244, v22
  v_dot2c_f32_bf16 v13, v244, v23
  v_dot2c_f32_bf16 v14, v245, v22
  v_dot2c_f32_bf16 v15, v245, v23
  v_dot2c_f32_bf16 v16, v246, v22
  v_dot2c_f32_bf16 v17, v246, v23
  v_dot2c_f32_bf16 v18, v247, v22
  v_dot2c_f32_bf16 v19, v247, v23
  v_mov_b32_dpp v20, v111 row_newbcast:4 row_mask:0xf bank_mask:0xf
  v_mov_b32_dpp v21, v103 row_newbcast:4 row_mask:0xf bank_mask:0xf
  s_waitcnt vmcnt(1)
  v_dot2c_f32_bf16 v12, v248, v20
  v_dot2c_f32_bf16 v13, v248, v21
  v_dot2c_f32_bf16 v14, v249, v20
  v_dot2c_f32_bf16 v15, v249, v21
  v_dot2c_f32_bf16 v16, v250, v20
  v_dot2c_f32_bf16 v17, v250, v21
  v_dot2c_f32_bf16 v18, v251, v20
  v_dot2c_f32_bf16 v19, v251, v21
  v_mov_b32_dpp v22, v111 row_newbcast:12 row_mask:0xf bank_mask:0xf
  v_mov_b32_dpp v23, v103 row_newbcast:12 row_mask:0xf bank_mask:0xf
  s_waitcnt vmcnt(0)
  v_dot2c_f32_bf16 v12, v252, v22
  v_dot2c_f32_bf16 v13, v252, v23
  v_dot2c_f32_bf16 v14, v253, v22
  v_dot2c_f32_bf16 v15, v253, v23
  v_dot2c_f32_bf16 v16, v254, v22
  v_dot2c_f32_bf16 v17, v254, v23
  v_dot2c_f32_bf16 v18, v255, v22
  v_dot2c_f32_bf16 v19, v255, v23
  s_branch L_tail
L_pv21:
  v_mov_b32 v8, 114752
  ds_read_b64 v[46:47], v8
  s_waitcnt lgkmcnt(0)
  v_sub_f32 v96, v96, v46
  v_mul_f32 v96, 0x3fb8aa3b, v96
  v_exp_f32 v96, v96
  v_sub_f32 v97, v97, v46
  v_mul_f32 v97, 0x3fb8aa3b, v97
  v_exp_f32 v97, v97
  v_sub_f32 v98, v98, v46
  v_mul_f32 v98, 0x3fb8aa3b, v98
  v_exp_f32 v98, v98
  v_sub_f32 v99, v99, v46
  v_mul_f32 v99, 0x3fb8aa3b, v99
  v_exp_f32 v99, v99
  v_sub_f32 v100, v100, v46
  v_mul_f32 v100, 0x3fb8aa3b, v100
  v_exp_f32 v100, v100
  v_sub_f32 v101, v101, v46
  v_mul_f32 v101, 0x3fb8aa3b, v101
  v_exp_f32 v101, v101
  v_sub_f32 v102, v102, v46
  v_mul_f32 v102, 0x3fb8aa3b, v102
  v_exp_f32 v102, v102
  v_sub_f32 v103, v103, v46
  v_mul_f32 v103, 0x3fb8aa3b, v103
  v_exp_f32 v103, v103
  s_nop 0
  v_mul_f32 v96, v96, v47
  v_mul_f32 v97, v97, v47
  v_cvt_pk_bf16_f32 v45, v96, v97
  v_lshlrev_b32 v96, 16, v45
  v_and_b32 v97, 0xffff0000, v45
  v_mul_f32 v98, v98, v47
  v_mul_f32 v99, v99, v47
  v_cvt_pk_bf16_f32 v45, v98, v99
  v_lshlrev_b32 v98, 16, v45
  v_and_b32 v99, 0xffff0000, v45
  v_mul_f32 v100, v100, v47
  v_mul_f32 v101, v101, v47
  v_cvt_pk_bf16_f32 v45, v100, v101
  v_lshlrev_b32 v100, 16, v45
  v_and_b32 v101, 0xffff0000, v45
  v_mul_f32 v102, v102, v47
  v_mul_f32 v103, v103, v47
  v_cvt_pk_bf16_f32 v45, v102, v103
  v_lshlrev_b32 v102, 16, v45
  v_and_b32 v103, 0xffff0000, v45
  v_lshrrev_b32 v104, 16, v96
  v_lshrrev_b32 v105, 16, v97
  v_lshrrev_b32 v106, 16, v98
  v_lshrrev_b32 v107, 16, v99
  v_lshrrev_b32 v108, 16, v100
  v_lshrrev_b32 v109, 16, v101
  v_lshrrev_b32 v110, 16, v102
  v_lshrrev_b32 v111, 16, v103
  v_mov_b32 v12, 0
  v_mov_b32 v13, 0
  v_mov_b32 v14, 0
  v_mov_b32 v15, 0
  v_mov_b32 v16, 0
  v_mov_b32 v17, 0
  v_mov_b32 v18, 0
  v_mov_b32 v19, 0
  v_add_u32 v7, s101, v6
  ds_read_b128 v[128:131], v7 offset:0
  v_mov_b32_dpp v20, v104 row_newbcast:0 row_mask:0xf bank_mask:0xf
  v_mov_b32_dpp v21, v96 row_newbcast:0 row_mask:0xf bank_mask:0xf
  s_waitcnt lgkmcnt(0)
  v_dot2c_f32_bf16 v12, v128, v20
  v_dot2c_f32_bf16 v13, v128, v21
  v_dot2c_f32_bf16 v14, v129, v20
  v_dot2c_f32_bf16 v15, v129, v21
  v_dot2c_f32_bf16 v16, v130, v20
  v_dot2c_f32_bf16 v17, v130, v21
  v_dot2c_f32_bf16 v18, v131, v20
  v_dot2c_f32_bf16 v19, v131, v21
  v_mov_b32_dpp v22, v104 row_newbcast:8 row_mask:0xf bank_mask:0xf
  v_mov_b32_dpp v23, v96 row_newbcast:8 row_mask:0xf bank_mask:0xf
  v_dot2c_f32_bf16 v12, v132, v22
  v_dot2c_f32_bf16 v13, v132, v23
  v_dot2c_f32_bf16 v14, v133, v22
  v_dot2c_f32_bf16 v15, v133, v23
  v_dot2c_f32_bf16 v16, v134, v22
  v_dot2c_f32_bf16 v17, v134, v23
  v_dot2c_f32_bf16 v18, v135, v22
  v_dot2c_f32_bf16 v19, v135, v23
  v_mov_b32_dpp v20, v104 row_newbcast:4 row_mask:0xf bank_mask:0xf
  v_mov_b32_dpp v21, v96 row_newbcast:4 row_mask:0xf bank_mask:0xf
  v_dot2c_f32_bf16 v12, v136, v20
  v_dot2c_f32_bf16 v13, v136, v21
  v_dot2c_f32_bf16 v14, v137, v20
  v_dot2c_f32_bf16 v15, v137, v21
  v_dot2c_f32_bf16 v16, v138, v20
  v_dot2c_f32_bf16 v17, v138, v21
  v_dot2c_f32_bf16 v18, v139, v20
  v_dot2c_f32_bf16 v19, v139, v21
  v_mov_b32_dpp v22, v104 row_newbcast:12 row_mask:0xf bank_mask:0xf
  v_mov_b32_dpp v23, v96 row_newbcast:12 row_mask:0xf bank_mask:0xf
  v_dot2c_f32_bf16 v12, v140, v22
  v_dot2c_f32_bf16 v13, v140, v23
  v_dot2c_f32_bf16 v14, v141, v22
  v_dot2c_f32_bf16 v15, v141, v23
  v_dot2c_f32_bf16 v16, v142, v22
  v_dot2c_f32_bf16 v17, v142, v23
  v_dot2c_f32_bf16 v18, v143, v22
  v_dot2c_f32_bf16 v19, v143, v23
  v_mov_b32_dpp v20, v105 row_newbcast:0 row_mask:0xf bank_mask:0xf
  v_mov_b32_dpp v21, v97 row_newbcast:0 row_mask:0xf bank_mask:0xf
  v_dot2c_f32_bf16 v12, v144, v20
  v_dot2c_f32_bf16 v13, v144, v21
  v_dot2c_f32_bf16 v14, v145, v20
  v_dot2c_f32_bf16 v15, v145, v21
  v_dot2c_f32_bf16 v16, v146, v20
  v_dot2c_f32_bf16 v17, v146, v21
  v_dot2c_f32_bf16 v18, v147, v20
  v_dot2c_f32_bf16 v19, v147, v21
  v_mov_b32_dpp v22, v105 row_newbcast:8 row_mask:0xf bank_mask:0xf
  v_mov_b32_dpp v23, v97 row_newbcast:8 row_mask:0xf bank_mask:0xf
  v_dot2c_f32_bf16 v12, v148, v22
  v_dot2c_f32_bf16 v13, v148, v23
  v_dot2c_f32_bf16 v14, v149, v22
  v_dot2c_f32_bf16 v15, v149, v23
  v_dot2c_f32_bf16 v16, v150, v22
  v_dot2c_f32_bf16 v17, v150, v23
  v_dot2c_f32_bf16 v18, v151, v22
  v_dot2c_f32_bf16 v19, v151, v23
  v_mov_b32_dpp v20, v105 row_newbcast:4 row_mask:0xf bank_mask:0xf
  v_mov_b32_dpp v21, v97 row_newbcast:4 row_mask:0xf bank_mask:0xf
  v_dot2c_f32_bf16 v12, v152, v20
  v_dot2c_f32_bf16 v13, v152, v21
  v_dot2c_f32_bf16 v14, v153, v20
  v_dot2c_f32_bf16 v15, v153, v21
  v_dot2c_f32_bf16 v16, v154, v20
  v_dot2c_f32_bf16 v17, v154, v21
  v_dot2c_f32_bf16 v18, v155, v20
  v_dot2c_f32_bf16 v19, v155, v21
  v_mov_b32_dpp v22, v105 row_newbcast:12 row_mask:0xf bank_mask:0xf
  v_mov_b32_dpp v23, v97 row_newbcast:12 row_mask:0xf bank_mask:0xf
  v_dot2c_f32_bf16 v12, v156, v22
  v_dot2c_f32_bf16 v13, v156, v23
  v_dot2c_f32_bf16 v14, v157, v22
  v_dot2c_f32_bf16 v15, v157, v23
  v_dot2c_f32_bf16 v16, v158, v22
  v_dot2c_f32_bf16 v17, v158, v23
  v_dot2c_f32_bf16 v18, v159, v22
  v_dot2c_f32_bf16 v19, v159, v23
  v_mov_b32_dpp v20, v106 row_newbcast:0 row_mask:0xf bank_mask:0xf
  v_mov_b32_dpp v21, v98 row_newbcast:0 row_mask:0xf bank_mask:0xf
  v_dot2c_f32_bf16 v12, v160, v20
  v_dot2c_f32_bf16 v13, v160, v21
  v_dot2c_f32_bf16 v14, v161, v20
  v_dot2c_f32_bf16 v15, v161, v21
  v_dot2c_f32_bf16 v16, v162, v20
  v_dot2c_f32_bf16 v17, v162, v21
  v_dot2c_f32_bf16 v18, v163, v20
  v_dot2c_f32_bf16 v19, v163, v21
  v_mov_b32_dpp v22, v106 row_newbcast:8 row_mask:0xf bank_mask:0xf
  v_mov_b32_dpp v23, v98 row_newbcast:8 row_mask:0xf bank_mask:0xf
  v_dot2c_f32_bf16 v12, v164, v22
  v_dot2c_f32_bf16 v13, v164, v23
  v_dot2c_f32_bf16 v14, v165, v22
  v_dot2c_f32_bf16 v15, v165, v23
  v_dot2c_f32_bf16 v16, v166, v22
  v_dot2c_f32_bf16 v17, v166, v23
  v_dot2c_f32_bf16 v18, v167, v22
  v_dot2c_f32_bf16 v19, v167, v23
  v_mov_b32_dpp v20, v106 row_newbcast:4 row_mask:0xf bank_mask:0xf
  v_mov_b32_dpp v21, v98 row_newbcast:4 row_mask:0xf bank_mask:0xf
  v_dot2c_f32_bf16 v12, v168, v20
  v_dot2c_f32_bf16 v13, v168, v21
  v_dot2c_f32_bf16 v14, v169, v20
  v_dot2c_f32_bf16 v15, v169, v21
  v_dot2c_f32_bf16 v16, v170, v20
  v_dot2c_f32_bf16 v17, v170, v21
  v_dot2c_f32_bf16 v18, v171, v20
  v_dot2c_f32_bf16 v19, v171, v21
  v_mov_b32_dpp v22, v106 row_newbcast:12 row_mask:0xf bank_mask:0xf
  v_mov_b32_dpp v23, v98 row_newbcast:12 row_mask:0xf bank_mask:0xf
  v_dot2c_f32_bf16 v12, v172, v22
  v_dot2c_f32_bf16 v13, v172, v23
  v_dot2c_f32_bf16 v14, v173, v22
  v_dot2c_f32_bf16 v15, v173, v23
  v_dot2c_f32_bf16 v16, v174, v22
  v_dot2c_f32_bf16 v17, v174, v23
  v_dot2c_f32_bf16 v18, v175, v22
  v_dot2c_f32_bf16 v19, v175, v23
  v_mov_b32_dpp v20, v107 row_newbcast:0 row_mask:0xf bank_mask:0xf
  v_mov_b32_dpp v21, v99 row_newbcast:0 row_mask:0xf bank_mask:0xf
  v_dot2c_f32_bf16 v12, v176, v20
  v_dot2c_f32_bf16 v13, v176, v21
  v_dot2c_f32_bf16 v14, v177, v20
  v_dot2c_f32_bf16 v15, v177, v21
  v_dot2c_f32_bf16 v16, v178, v20
  v_dot2c_f32_bf16 v17, v178, v21
  v_dot2c_f32_bf16 v18, v179, v20
  v_dot2c_f32_bf16 v19, v179, v21
  v_mov_b32_dpp v22, v107 row_newbcast:8 row_mask:0xf bank_mask:0xf
  v_mov_b32_dpp v23, v99 row_newbcast:8 row_mask:0xf bank_mask:0xf
  v_dot2c_f32_bf16 v12, v180, v22
  v_dot2c_f32_bf16 v13, v180, v23
  v_dot2c_f32_bf16 v14, v181, v22
  v_dot2c_f32_bf16 v15, v181, v23
  v_dot2c_f32_bf16 v16, v182, v22
  v_dot2c_f32_bf16 v17, v182, v23
  v_dot2c_f32_bf16 v18, v183, v22
  v_dot2c_f32_bf16 v19, v183, v23
  v_mov_b32_dpp v20, v107 row_newbcast:4 row_mask:0xf bank_mask:0xf
  v_mov_b32_dpp v21, v99 row_newbcast:4 row_mask:0xf bank_mask:0xf
  v_dot2c_f32_bf16 v12, v184, v20
  v_dot2c_f32_bf16 v13, v184, v21
  v_dot2c_f32_bf16 v14, v185, v20
  v_dot2c_f32_bf16 v15, v185, v21
  v_dot2c_f32_bf16 v16, v186, v20
  v_dot2c_f32_bf16 v17, v186, v21
  v_dot2c_f32_bf16 v18, v187, v20
  v_dot2c_f32_bf16 v19, v187, v21
  v_mov_b32_dpp v22, v107 row_newbcast:12 row_mask:0xf bank_mask:0xf
  v_mov_b32_dpp v23, v99 row_newbcast:12 row_mask:0xf bank_mask:0xf
  v_dot2c_f32_bf16 v12, v188, v22
  v_dot2c_f32_bf16 v13, v188, v23
  v_dot2c_f32_bf16 v14, v189, v22
  v_dot2c_f32_bf16 v15, v189, v23
  v_dot2c_f32_bf16 v16, v190, v22
  v_dot2c_f32_bf16 v17, v190, v23
  v_dot2c_f32_bf16 v18, v191, v22
  v_dot2c_f32_bf16 v19, v191, v23
  v_mov_b32_dpp v20, v108 row_newbcast:0 row_mask:0xf bank_mask:0xf
  v_mov_b32_dpp v21, v100 row_newbcast:0 row_mask:0xf bank_mask:0xf
  v_dot2c_f32_bf16 v12, v192, v20
  v_dot2c_f32_bf16 v13, v192, v21
  v_dot2c_f32_bf16 v14, v193, v20
  v_dot2c_f32_bf16 v15, v193, v21
  v_dot2c_f32_bf16 v16, v194, v20
  v_dot2c_f32_bf16 v17, v194, v21
  v_dot2c_f32_bf16 v18, v195, v20
  v_dot2c_f32_bf16 v19, v195, v21
  v_mov_b32_dpp v22, v108 row_newbcast:8 row_mask:0xf bank_mask:0xf
  v_mov_b32_dpp v23, v100 row_newbcast:8 row_mask:0xf bank_mask:0xf
  v_dot2c_f32_bf16 v12, v196, v22
  v_dot2c_f32_bf16 v13, v196, v23
  v_dot2c_f32_bf16 v14, v197, v22
  v_dot2c_f32_bf16 v15, v197, v23
  v_dot2c_f32_bf16 v16, v198, v22
  v_dot2c_f32_bf16 v17, v198, v23
  v_dot2c_f32_bf16 v18, v199, v22
  v_dot2c_f32_bf16 v19, v199, v23
  v_mov_b32_dpp v20, v108 row_newbcast:4 row_mask:0xf bank_mask:0xf
  v_mov_b32_dpp v21, v100 row_newbcast:4 row_mask:0xf bank_mask:0xf
  v_dot2c_f32_bf16 v12, v200, v20
  v_dot2c_f32_bf16 v13, v200, v21
  v_dot2c_f32_bf16 v14, v201, v20
  v_dot2c_f32_bf16 v15, v201, v21
  v_dot2c_f32_bf16 v16, v202, v20
  v_dot2c_f32_bf16 v17, v202, v21
  v_dot2c_f32_bf16 v18, v203, v20
  v_dot2c_f32_bf16 v19, v203, v21
  v_mov_b32_dpp v22, v108 row_newbcast:12 row_mask:0xf bank_mask:0xf
  v_mov_b32_dpp v23, v100 row_newbcast:12 row_mask:0xf bank_mask:0xf
  v_dot2c_f32_bf16 v12, v204, v22
  v_dot2c_f32_bf16 v13, v204, v23
  v_dot2c_f32_bf16 v14, v205, v22
  v_dot2c_f32_bf16 v15, v205, v23
  v_dot2c_f32_bf16 v16, v206, v22
  v_dot2c_f32_bf16 v17, v206, v23
  v_dot2c_f32_bf16 v18, v207, v22
  v_dot2c_f32_bf16 v19, v207, v23
  v_mov_b32_dpp v20, v109 row_newbcast:0 row_mask:0xf bank_mask:0xf
  v_mov_b32_dpp v21, v101 row_newbcast:0 row_mask:0xf bank_mask:0xf
  v_dot2c_f32_bf16 v12, v208, v20
  v_dot2c_f32_bf16 v13, v208, v21
  v_dot2c_f32_bf16 v14, v209, v20
  v_dot2c_f32_bf16 v15, v209, v21
  v_dot2c_f32_bf16 v16, v210, v20
  v_dot2c_f32_bf16 v17, v210, v21
  v_dot2c_f32_bf16 v18, v211, v20
  v_dot2c_f32_bf16 v19, v211, v21
  v_mov_b32_dpp v22, v109 row_newbcast:8 row_mask:0xf bank_mask:0xf
  v_mov_b32_dpp v23, v101 row_newbcast:8 row_mask:0xf bank_mask:0xf
  v_dot2c_f32_bf16 v12, v212, v22
  v_dot2c_f32_bf16 v13, v212, v23
  v_dot2c_f32_bf16 v14, v213, v22
  v_dot2c_f32_bf16 v15, v213, v23
  v_dot2c_f32_bf16 v16, v214, v22
  v_dot2c_f32_bf16 v17, v214, v23
  v_dot2c_f32_bf16 v18, v215, v22
  v_dot2c_f32_bf16 v19, v215, v23
  v_mov_b32_dpp v20, v109 row_newbcast:4 row_mask:0xf bank_mask:0xf
  v_mov_b32_dpp v21, v101 row_newbcast:4 row_mask:0xf bank_mask:0xf
  s_waitcnt vmcnt(9)
  v_dot2c_f32_bf16 v12, v216, v20
  v_dot2c_f32_bf16 v13, v216, v21
  v_dot2c_f32_bf16 v14, v217, v20
  v_dot2c_f32_bf16 v15, v217, v21
  v_dot2c_f32_bf16 v16, v218, v20
  v_dot2c_f32_bf16 v17, v218, v21
  v_dot2c_f32_bf16 v18, v219, v20
  v_dot2c_f32_bf16 v19, v219, v21
  v_mov_b32_dpp v22, v109 row_newbcast:12 row_mask:0xf bank_mask:0xf
  v_mov_b32_dpp v23, v101 row_newbcast:12 row_mask:0xf bank_mask:0xf
  s_waitcnt vmcnt(8)
  v_dot2c_f32_bf16 v12, v220, v22
  v_dot2c_f32_bf16 v13, v220, v23
  v_dot2c_f32_bf16 v14, v221, v22
  v_dot2c_f32_bf16 v15, v221, v23
  v_dot2c_f32_bf16 v16, v222, v22
  v_dot2c_f32_bf16 v17, v222, v23
  v_dot2c_f32_bf16 v18, v223, v22
  v_dot2c_f32_bf16 v19, v223, v23
  v_mov_b32_dpp v20, v110 row_newbcast:0 row_mask:0xf bank_mask:0xf
  v_mov_b32_dpp v21, v102 row_newbcast:0 row_mask:0xf bank_mask:0xf
  s_waitcnt vmcnt(7)
  v_dot2c_f32_bf16 v12, v224, v20
  v_dot2c_f32_bf16 v13, v224, v21
  v_dot2c_f32_bf16 v14, v225, v20
  v_dot2c_f32_bf16 v15, v225, v21
  v_dot2c_f32_bf16 v16, v226, v20
  v_dot2c_f32_bf16 v17, v226, v21
  v_dot2c_f32_bf16 v18, v227, v20
  v_dot2c_f32_bf16 v19, v227, v21
  v_mov_b32_dpp v22, v110 row_newbcast:8 row_mask:0xf bank_mask:0xf
  v_mov_b32_dpp v23, v102 row_newbcast:8 row_mask:0xf bank_mask:0xf
  s_waitcnt vmcnt(6)
  v_dot2c_f32_bf16 v12, v228, v22
  v_dot2c_f32_bf16 v13, v228, v23
  v_dot2c_f32_bf16 v14, v229, v22
  v_dot2c_f32_bf16 v15, v229, v23
  v_dot2c_f32_bf16 v16, v230, v22
  v_dot2c_f32_bf16 v17, v230, v23
  v_dot2c_f32_bf16 v18, v231, v22
  v_dot2c_f32_bf16 v19, v231, v23
  v_mov_b32_dpp v20, v110 row_newbcast:4 row_mask:0xf bank_mask:0xf
  v_mov_b32_dpp v21, v102 row_newbcast:4 row_mask:0xf bank_mask:0xf
  s_waitcnt vmcnt(5)
  v_dot2c_f32_bf16 v12, v232, v20
  v_dot2c_f32_bf16 v13, v232, v21
  v_dot2c_f32_bf16 v14, v233, v20
  v_dot2c_f32_bf16 v15, v233, v21
  v_dot2c_f32_bf16 v16, v234, v20
  v_dot2c_f32_bf16 v17, v234, v21
  v_dot2c_f32_bf16 v18, v235, v20
  v_dot2c_f32_bf16 v19, v235, v21
  v_mov_b32_dpp v22, v110 row_newbcast:12 row_mask:0xf bank_mask:0xf
  v_mov_b32_dpp v23, v102 row_newbcast:12 row_mask:0xf bank_mask:0xf
  s_waitcnt vmcnt(4)
  v_dot2c_f32_bf16 v12, v236, v22
  v_dot2c_f32_bf16 v13, v236, v23
  v_dot2c_f32_bf16 v14, v237, v22
  v_dot2c_f32_bf16 v15, v237, v23
  v_dot2c_f32_bf16 v16, v238, v22
  v_dot2c_f32_bf16 v17, v238, v23
  v_dot2c_f32_bf16 v18, v239, v22
  v_dot2c_f32_bf16 v19, v239, v23
  v_mov_b32_dpp v20, v111 row_newbcast:0 row_mask:0xf bank_mask:0xf
  v_mov_b32_dpp v21, v103 row_newbcast:0 row_mask:0xf bank_mask:0xf
  s_waitcnt vmcnt(3)
  v_dot2c_f32_bf16 v12, v240, v20
  v_dot2c_f32_bf16 v13, v240, v21
  v_dot2c_f32_bf16 v14, v241, v20
  v_dot2c_f32_bf16 v15, v241, v21
  v_dot2c_f32_bf16 v16, v242, v20
  v_dot2c_f32_bf16 v17, v242, v21
  v_dot2c_f32_bf16 v18, v243, v20
  v_dot2c_f32_bf16 v19, v243, v21
  v_mov_b32_dpp v22, v111 row_newbcast:8 row_mask:0xf bank_mask:0xf
  v_mov_b32_dpp v23, v103 row_newbcast:8 row_mask:0xf bank_mask:0xf
  s_waitcnt vmcnt(2)
  v_dot2c_f32_bf16 v12, v244, v22
  v_dot2c_f32_bf16 v13, v244, v23
  v_dot2c_f32_bf16 v14, v245, v22
  v_dot2c_f32_bf16 v15, v245, v23
  v_dot2c_f32_bf16 v16, v246, v22
  v_dot2c_f32_bf16 v17, v246, v23
  v_dot2c_f32_bf16 v18, v247, v22
  v_dot2c_f32_bf16 v19, v247, v23
  v_mov_b32_dpp v20, v111 row_newbcast:4 row_mask:0xf bank_mask:0xf
  v_mov_b32_dpp v21, v103 row_newbcast:4 row_mask:0xf bank_mask:0xf
  s_waitcnt vmcnt(1)
  v_dot2c_f32_bf16 v12, v248, v20
  v_dot2c_f32_bf16 v13, v248, v21
  v_dot2c_f32_bf16 v14, v249, v20
  v_dot2c_f32_bf16 v15, v249, v21
  v_dot2c_f32_bf16 v16, v250, v20
  v_dot2c_f32_bf16 v17, v250, v21
  v_dot2c_f32_bf16 v18, v251, v20
  v_dot2c_f32_bf16 v19, v251, v21
  v_mov_b32_dpp v22, v111 row_newbcast:12 row_mask:0xf bank_mask:0xf
  v_mov_b32_dpp v23, v103 row_newbcast:12 row_mask:0xf bank_mask:0xf
  s_waitcnt vmcnt(0)
  v_dot2c_f32_bf16 v12, v252, v22
  v_dot2c_f32_bf16 v13, v252, v23
  v_dot2c_f32_bf16 v14, v253, v22
  v_dot2c_f32_bf16 v15, v253, v23
  v_dot2c_f32_bf16 v16, v254, v22
  v_dot2c_f32_bf16 v17, v254, v23
  v_dot2c_f32_bf16 v18, v255, v22
  v_dot2c_f32_bf16 v19, v255, v23
  s_branch L_tail
L_tail:
  v_lshlrev_b32 v7, 5, v0
  v_add_u32 v7, 98304, v7
  ds_write_b128 v7, v[12:15]
  ds_write_b128 v7, v[16:19] offset:16
  s_cmp_ge_u32 s3, 4
  s_cbranch_scc1 L_tail_hi
  s_cmp_lg_u32 s3, 0
  s_cbranch_scc1 L_tail_mid
  s_mov_b32 s14, 0
  v_lshlrev_b32 v51, 5, v1
  v_add_u32 v51, 0x154000, v51
L_chk_9:
  v_cmp_eq_u32 vcc, s98, v88
  v_cmp_eq_u32 s[10:11], s99, v89
  s_and_b64 vcc, vcc, s[10:11]
  v_cmp_eq_u32 s[10:11], s98, v90
  s_and_b64 vcc, vcc, s[10:11]
  v_cmp_eq_u32 s[10:11], s99, v91
  s_and_b64 vcc, vcc, s[10:11]
  v_cmp_eq_u32 s[10:11], s98, v92
  s_and_b64 vcc, vcc, s[10:11]
  v_cmp_eq_u32 s[10:11], s99, v93
  s_and_b64 vcc, vcc, s[10:11]
  v_cmp_eq_u32 s[10:11], s98, v94
  s_and_b64 vcc, vcc, s[10:11]
  v_cmp_eq_u32 s[10:11], s99, v95
  s_and_b64 vcc, vcc, s[10:11]
  s_cmp_eq_u64 vcc, exec
  s_cbranch_scc1 L_chkd_10
  s_sleep 2
  buffer_load_dwordx4 v[88:91], v51, s[80:83], 0 offen sc1
  buffer_load_dwordx4 v[92:95], v51, s[80:83], 0 offen offset:16 sc1
  s_waitcnt vmcnt(0)
  s_add_u32 s14, s14, 1
  s_cmp_lt_u32 s14, 400000
  s_cbranch_scc1 L_chk_9
L_chkd_10:
  v_mov_b32 v7, 0x152400
  v_mov_b32 v48, 1
  s_mov_b64 s[10:11], exec
  s_mov_b64 exec, 1
  buffer_atomic_add v48, v7, s[80:83], 0 offen sc0 sc1
  s_mov_b64 exec, s[10:11]
  v_lshlrev_b32 v7, 3, v2
  v_lshrrev_b32 v8, 2, v3
  v_add_u32 v7, v7, v8
  v_lshlrev_b32 v9, 7, v7
  v_and_b32 v8, 3, v1
  v_lshlrev_b32 v8, 3, v8
  v_add_u32 v9, v9, v8
  v_add_u32 v9, 132736, v9
  ds_read_b64_tr_b16 v[128:129], v9 offset:0
  ds_read_b64_tr_b16 v[130:131], v9 offset:512
  ds_read_b64_tr_b16 v[132:133], v9 offset:4096
  ds_read_b64_tr_b16 v[134:135], v9 offset:4608
  ds_read_b64_tr_b16 v[136:137], v9 offset:8192
  ds_read_b64_tr_b16 v[138:139], v9 offset:8704
  ds_read_b64_tr_b16 v[140:141], v9 offset:12288
  ds_read_b64_tr_b16 v[142:143], v9 offset:12800
  ds_read_b64_tr_b16 v[144:145], v9 offset:32
  ds_read_b64_tr_b16 v[146:147], v9 offset:544
  ds_read_b64_tr_b16 v[148:149], v9 offset:4128
  ds_read_b64_tr_b16 v[150:151], v9 offset:4640
  ds_read_b64_tr_b16 v[152:153], v9 offset:8224
  ds_read_b64_tr_b16 v[154:155], v9 offset:8736
  ds_read_b64_tr_b16 v[156:157], v9 offset:12320
  ds_read_b64_tr_b16 v[158:159], v9 offset:12832
  ds_read_b64_tr_b16 v[160:161], v9 offset:64
  ds_read_b64_tr_b16 v[162:163], v9 offset:576
  ds_read_b64_tr_b16 v[164:165], v9 offset:4160
  ds_read_b64_tr_b16 v[166:167], v9 offset:4672
  ds_read_b64_tr_b16 v[168:169], v9 offset:8256
  ds_read_b64_tr_b16 v[170:171], v9 offset:8768
  ds_read_b64_tr_b16 v[172:173], v9 offset:12352
  ds_read_b64_tr_b16 v[174:175], v9 offset:12864
  ds_read_b64_tr_b16 v[176:177], v9 offset:96
  ds_read_b64_tr_b16 v[178:179], v9 offset:608
  ds_read_b64_tr_b16 v[180:181], v9 offset:4192
  ds_read_b64_tr_b16 v[182:183], v9 offset:4704
  ds_read_b64_tr_b16 v[184:185], v9 offset:8288
  ds_read_b64_tr_b16 v[186:187], v9 offset:8800
  ds_read_b64_tr_b16 v[188:189], v9 offset:12384
  ds_read_b64_tr_b16 v[190:191], v9 offset:12896
  v_lshlrev_b32 v7, 3, v1
  v_add_u32 v8, 98304, v7
  s_lshl_b32 s9, s2, 10
  v_add_u32 v5, s9, v7
  s_and_b32 s9, s2, 31
  s_lshl_b32 s9, s9, 10
  v_add_u32 v7, s9, v7
  s_mov_b32 s16, 0
  s_mov_b32 s17, 32768
  s_mov_b32 s18, 65536
  s_mov_b32 s19, 98304
  s_mov_b32 s20, 131072
  s_mov_b32 s21, 163840
  s_mov_b32 s22, 196608
  s_mov_b32 s23, 229376
  v_and_b32 v9, 3, v1
  v_lshlrev_b32 v9, 8, v9
  v_lshlrev_b32 v10, 4, v2
  v_add_u32 v9, v9, v10
  v_add_u32 v9, 114816, v9
  v_lshlrev_b32 v32, 8, v3
  v_add_u32 v32, v32, v10
  v_add_u32 v32, 130688, v32
  v_lshlrev_b32 v33, 2, v1
  s_lshl_b32 s9, s8, 8
  s_add_u32 s9, s9, 0x150000
  v_add_u32 v11, s9, v33
  v_add_u32 v33, 130688, v33
  s_mov_b32 s24, 0
  s_mov_b32 s25, 2048
  s_mov_b32 s26, 4096
  s_mov_b32 s27, 6144
  v_lshlrev_b32 v10, 2, v1
  v_add_u32 v10, 114816, v10
  s_waitcnt lgkmcnt(0)
  s_barrier
  ds_read_b64 v[64:65], v8 offset:0
  ds_read_b64 v[66:67], v8 offset:512
  ds_read_b64 v[68:69], v8 offset:1024
  ds_read_b64 v[70:71], v8 offset:1536
  ds_read_b64 v[72:73], v8 offset:2048
  ds_read_b64 v[74:75], v8 offset:2560
  ds_read_b64 v[76:77], v8 offset:3072
  ds_read_b64 v[78:79], v8 offset:3584
  ds_read_b64 v[80:81], v8 offset:4096
  ds_read_b64 v[82:83], v8 offset:4608
  ds_read_b64 v[84:85], v8 offset:5120
  ds_read_b64 v[86:87], v8 offset:5632
  ds_read_b64 v[88:89], v8 offset:6144
  ds_read_b64 v[90:91], v8 offset:6656
  ds_read_b64 v[92:93], v8 offset:7168
  ds_read_b64 v[94:95], v8 offset:7680
  ds_read_b64 v[96:97], v8 offset:8192
  ds_read_b64 v[98:99], v8 offset:8704
  ds_read_b64 v[100:101], v8 offset:9216
  ds_read_b64 v[102:103], v8 offset:9728
  ds_read_b64 v[104:105], v8 offset:10240
  ds_read_b64 v[106:107], v8 offset:10752
  ds_read_b64 v[108:109], v8 offset:11264
  ds_read_b64 v[110:111], v8 offset:11776
  ds_read_b64 v[112:113], v8 offset:12288
  ds_read_b64 v[114:115], v8 offset:12800
  ds_read_b64 v[116:117], v8 offset:13312
  ds_read_b64 v[118:119], v8 offset:13824
  ds_read_b64 v[120:121], v8 offset:14336
  ds_read_b64 v[122:123], v8 offset:14848
  ds_read_b64 v[124:125], v8 offset:15360
  ds_read_b64 v[126:127], v8 offset:15872
  s_waitcnt lgkmcnt(0)
  v_add_f32 v64, v64, v96
  v_add_f32 v65, v65, v97
  v_add_f32 v66, v66, v98
  v_add_f32 v67, v67, v99
  v_add_f32 v68, v68, v100
  v_add_f32 v69, v69, v101
  v_add_f32 v70, v70, v102
  v_add_f32 v71, v71, v103
  v_add_f32 v72, v72, v104
  v_add_f32 v73, v73, v105
  v_add_f32 v74, v74, v106
  v_add_f32 v75, v75, v107
  v_add_f32 v76, v76, v108
  v_add_f32 v77, v77, v109
  v_add_f32 v78, v78, v110
  v_add_f32 v79, v79, v111
  v_add_f32 v80, v80, v112
  v_add_f32 v81, v81, v113
  v_add_f32 v82, v82, v114
  v_add_f32 v83, v83, v115
  v_add_f32 v84, v84, v116
  v_add_f32 v85, v85, v117
  v_add_f32 v86, v86, v118
  v_add_f32 v87, v87, v119
  v_add_f32 v88, v88, v120
  v_add_f32 v89, v89, v121
  v_add_f32 v90, v90, v122
  v_add_f32 v91, v91, v123
  v_add_f32 v92, v92, v124
  v_add_f32 v93, v93, v125
  v_add_f32 v94, v94, v126
  v_add_f32 v95, v95, v127
  v_add_f32 v64, v64, v80
  v_add_f32 v65, v65, v81
  v_add_f32 v66, v66, v82
  v_add_f32 v67, v67, v83
  v_add_f32 v68, v68, v84
  v_add_f32 v69, v69, v85
  v_add_f32 v70, v70, v86
  v_add_f32 v71, v71, v87
  v_add_f32 v72, v72, v88
  v_add_f32 v73, v73, v89
  v_add_f32 v74, v74, v90
  v_add_f32 v75, v75, v91
  v_add_f32 v76, v76, v92
  v_add_f32 v77, v77, v93
  v_add_f32 v78, v78, v94
  v_add_f32 v79, v79, v95
  v_add_f32 v64, v64, v72
  v_add_f32 v65, v65, v73
  v_add_f32 v66, v66, v74
  v_add_f32 v67, v67, v75
  v_add_f32 v68, v68, v76
  v_add_f32 v69, v69, v77
  v_add_f32 v70, v70, v78
  v_add_f32 v71, v71, v79
  v_add_f32 v64, v64, v68
  v_add_f32 v65, v65, v69
  v_add_f32 v66, v66, v70
  v_add_f32 v67, v67, v71
  v_add_f32 v64, v64, v66
  v_add_f32 v65, v65, v67
  buffer_store_dwordx2 v[64:65], v5, s[80:83], 0 offen sc1
  s_waitcnt vmcnt(1)
  v_mov_b32 v34, 149124
  v_add_u32 v35, 1, v48
  s_mov_b64 s[10:11], exec
  s_mov_b64 exec, 1
  ds_write_b32 v34, v35
  s_mov_b64 exec, s[10:11]
  s_mov_b32 s14, 0
L_pollg:
  buffer_load_dwordx2 v[12:13], v7, s[80:83], s16 offen sc1
  buffer_load_dwordx2 v[14:15], v7, s[80:83], s17 offen sc1
  buffer_load_dwordx2 v[16:17], v7, s[80:83], s18 offen sc1
  buffer_load_dwordx2 v[18:19], v7, s[80:83], s19 offen sc1
  buffer_load_dwordx2 v[20:21], v7, s[80:83], s20 offen sc1
  buffer_load_dwordx2 v[22:23], v7, s[80:83], s21 offen sc1
  buffer_load_dwordx2 v[24:25], v7, s[80:83], s22 offen sc1
  buffer_load_dwordx2 v[26:27], v7, s[80:83], s23 offen sc1
  s_waitcnt vmcnt(0)
  v_cmp_eq_u32 vcc, -1, v12
  v_cmp_eq_u32 s[10:11], -1, v13
  s_or_b64 vcc, vcc, s[10:11]
  v_cmp_eq_u32 s[10:11], -1, v14
  s_or_b64 vcc, vcc, s[10:11]
  v_cmp_eq_u32 s[10:11], -1, v15
  s_or_b64 vcc, vcc, s[10:11]
  v_cmp_eq_u32 s[10:11], -1, v16
  s_or_b64 vcc, vcc, s[10:11]
  v_cmp_eq_u32 s[10:11], -1, v17
  s_or_b64 vcc, vcc, s[10:11]
  v_cmp_eq_u32 s[10:11], -1, v18
  s_or_b64 vcc, vcc, s[10:11]
  v_cmp_eq_u32 s[10:11], -1, v19
  s_or_b64 vcc, vcc, s[10:11]
  v_cmp_eq_u32 s[10:11], -1, v20
  s_or_b64 vcc, vcc, s[10:11]
  v_cmp_eq_u32 s[10:11], -1, v21
  s_or_b64 vcc, vcc, s[10:11]
  v_cmp_eq_u32 s[10:11], -1, v22
  s_or_b64 vcc, vcc, s[10:11]
  v_cmp_eq_u32 s[10:11], -1, v23
  s_or_b64 vcc, vcc, s[10:11]
  v_cmp_eq_u32 s[10:11], -1, v24
  s_or_b64 vcc, vcc, s[10:11]
  v_cmp_eq_u32 s[10:11], -1, v25
  s_or_b64 vcc, vcc, s[10:11]
  v_cmp_eq_u32 s[10:11], -1, v26
  s_or_b64 vcc, vcc, s[10:11]
  v_cmp_eq_u32 s[10:11], -1, v27
  s_or_b64 vcc, vcc, s[10:11]
  s_cmp_eq_u64 vcc, 0
  s_cbranch_scc1 L_pollg_done
  s_add_u32 s14, s14, 1
  s_cmp_lt_u32 s14, 400000
  s_cbranch_scc1 L_pollg
L_pollg_done:
  v_add_f32 v12, v12, v14
  v_add_f32 v13, v13, v15
  v_cvt_pk_bf16_f32 v12, v12, v13
  ds_write_b32 v10, v12 offset:0
  v_add_f32 v16, v16, v18
  v_add_f32 v17, v17, v19
  v_cvt_pk_bf16_f32 v16, v16, v17
  ds_write_b32 v10, v16 offset:256
  v_add_f32 v20, v20, v22
  v_add_f32 v21, v21, v23
  v_cvt_pk_bf16_f32 v20, v20, v21
  ds_write_b32 v10, v20 offset:512
  v_add_f32 v24, v24, v26
  v_add_f32 v25, v25, v27
  v_cvt_pk_bf16_f32 v24, v24, v25
  ds_write_b32 v10, v24 offset:768
  v_cmp_gt_u32 vcc, 4, v3
  s_waitcnt lgkmcnt(0)
  ds_read_b128 v[80:83], v9 offset:0
  ds_read_b128 v[84:87], v9 offset:64
  ds_read_b128 v[88:91], v9 offset:128
  ds_read_b128 v[92:95], v9 offset:192
  s_waitcnt lgkmcnt(3)
  v_mfma_f32_16x16x32_bf16 v[12:15], v[128:131], v[80:83], 0
  v_mfma_f32_16x16x32_bf16 v[16:19], v[144:147], v[80:83], 0
  v_mfma_f32_16x16x32_bf16 v[20:23], v[160:163], v[80:83], 0
  v_mfma_f32_16x16x32_bf16 v[24:27], v[176:179], v[80:83], 0
  s_waitcnt lgkmcnt(2)
  v_mfma_f32_16x16x32_bf16 v[12:15], v[132:135], v[84:87], v[12:15]
  v_mfma_f32_16x16x32_bf16 v[16:19], v[148:151], v[84:87], v[16:19]
  v_mfma_f32_16x16x32_bf16 v[20:23], v[164:167], v[84:87], v[20:23]
  v_mfma_f32_16x16x32_bf16 v[24:27], v[180:183], v[84:87], v[24:27]
  s_waitcnt lgkmcnt(1)
  v_mfma_f32_16x16x32_bf16 v[12:15], v[136:139], v[88:91], v[12:15]
  v_mfma_f32_16x16x32_bf16 v[16:19], v[152:155], v[88:91], v[16:19]
  v_mfma_f32_16x16x32_bf16 v[20:23], v[168:171], v[88:91], v[20:23]
  v_mfma_f32_16x16x32_bf16 v[24:27], v[184:187], v[88:91], v[24:27]
  s_waitcnt lgkmcnt(0)
  v_mfma_f32_16x16x32_bf16 v[12:15], v[140:143], v[92:95], v[12:15]
  v_mfma_f32_16x16x32_bf16 v[16:19], v[156:159], v[92:95], v[16:19]
  v_mfma_f32_16x16x32_bf16 v[20:23], v[172:175], v[92:95], v[20:23]
  v_mfma_f32_16x16x32_bf16 v[24:27], v[188:191], v[92:95], v[24:27]
  s_and_saveexec_b64 s[10:11], vcc
  s_nop 3
  ds_write_b128 v32, v[12:15] offset:0
  ds_write_b128 v32, v[16:19] offset:64
  ds_write_b128 v32, v[20:23] offset:128
  ds_write_b128 v32, v[24:27] offset:192
  s_mov_b64 exec, s[10:11]
  s_waitcnt lgkmcnt(0)
  ds_read_b32 v12, v33 offset:0
  ds_read_b32 v13, v33 offset:256
  ds_read_b32 v14, v33 offset:512
  ds_read_b32 v15, v33 offset:768
  s_waitcnt lgkmcnt(3)
  buffer_atomic_add_f32 v12, v11, s[80:83], s24 offen
  s_waitcnt lgkmcnt(2)
  buffer_atomic_add_f32 v13, v11, s[80:83], s25 offen
  s_waitcnt lgkmcnt(1)
  buffer_atomic_add_f32 v14, v11, s[80:83], s26 offen
  s_waitcnt lgkmcnt(0)
  buffer_atomic_add_f32 v15, v11, s[80:83], s27 offen
  s_mov_b64 s[10:11], exec
  s_mov_b64 exec, 1
  s_lshl_b32 s9, s2, 2
  s_add_u32 s9, s9, 0x152000
  v_mov_b32 v7, s9
  v_mov_b32 v8, 1
  s_waitcnt vmcnt(0)
  buffer_store_dword v8, v7, s[80:83], 0 offen sc1
  v_readfirstlane_b32 s100, v48
  s_mov_b64 exec, s[10:11]
  s_branch L_tail_ffn
L_tail_mid:
  s_waitcnt lgkmcnt(0)
  s_barrier
  v_mov_b32 v50, 149124
  s_mov_b32 s14, 0
L_gom_11:
  ds_read_b32 v49, v50
  s_waitcnt lgkmcnt(0)
  v_readfirstlane_b32 s9, v49
  s_cmp_ge_u32 s9, 1
  s_cbranch_scc1 L_gomd_12
  s_sleep 1
  s_add_u32 s14, s14, 1
  s_cmp_lt_u32 s14, 1600000
  s_cbranch_scc1 L_gom_11
L_gomd_12:
  s_sub_u32 s100, s9, 1
L_tail_ffn:
  s_cmp_ge_u32 s100, 43
  s_cbranch_scc1 L_end
  s_cmp_lg_u32 s3, 0
  s_cbranch_scc1 L_poll2_other
  v_add_u32 v9, 0x152000, v6
  s_mov_b32 s14, 0
L_poll2:
  buffer_load_dwordx4 v[12:15], v9, s[80:83], 0 offen sc1
  s_waitcnt vmcnt(0)
  v_and_b32 v12, v12, v13
  v_and_b32 v14, v14, v15
  v_and_b32 v12, v12, v14
  v_cmp_eq_u32 vcc, 1, v12
  s_cmp_eq_u64 vcc, exec
  s_cbranch_scc1 L_poll2_done
  s_sleep 1
  s_add_u32 s14, s14, 1
  s_cmp_lt_u32 s14, 400000
  s_cbranch_scc1 L_poll2
L_poll2_done:
  v_mov_b32 v7, 149128
  v_mov_b32 v8, 1
  ds_write_b32 v7, v8
  s_branch L_poll2_all
L_poll2_other:
  v_mov_b32 v50, 149128
  s_mov_b32 s14, 0
L_p2_13:
  ds_read_b32 v49, v50
  s_waitcnt lgkmcnt(0)
  v_readfirstlane_b32 s9, v49
  s_cmp_ge_u32 s9, 1
  s_cbranch_scc1 L_p2d_14
  s_sleep 1
  s_add_u32 s14, s14, 1
  s_cmp_lt_u32 s14, 1600000
  s_cbranch_scc1 L_p2_13
L_p2d_14:
L_poll2_all:
  s_lshl_b32 s9, s3, 11
  s_add_u32 s9, s9, 0x150000
  v_lshlrev_b32 v9, 5, v1
  v_add_u32 v10, s9, v9
  buffer_load_dwordx4 v[12:15], v10, s[80:83], 0 offen sc1
  buffer_load_dwordx4 v[16:19], v10, s[80:83], 0 offen offset:16 sc1
  v_lshlrev_b32 v128, 16, v60
  v_and_b32 v129, 0xffff0000, v60
  v_lshlrev_b32 v130, 16, v61
  v_and_b32 v131, 0xffff0000, v61
  v_lshlrev_b32 v132, 16, v62
  v_and_b32 v133, 0xffff0000, v62
  v_lshlrev_b32 v134, 16, v63
  v_and_b32 v135, 0xffff0000, v63
  s_waitcnt vmcnt(0)
  v_cvt_pk_bf16_f32 v20, v12, v13
  v_lshlrev_b32 v12, 16, v20
  v_and_b32 v13, 0xffff0000, v20
  v_cvt_pk_bf16_f32 v20, v14, v15
  v_lshlrev_b32 v14, 16, v20
  v_and_b32 v15, 0xffff0000, v20
  v_cvt_pk_bf16_f32 v20, v16, v17
  v_lshlrev_b32 v16, 16, v20
  v_and_b32 v17, 0xffff0000, v20
  v_cvt_pk_bf16_f32 v20, v18, v19
  v_lshlrev_b32 v18, 16, v20
  v_and_b32 v19, 0xffff0000, v20
  v_add_f32 v12, v12, v128
  v_add_f32 v13, v13, v129
  v_add_f32 v14, v14, v130
  v_add_f32 v15, v15, v131
  v_add_f32 v16, v16, v132
  v_add_f32 v17, v17, v133
  v_add_f32 v18, v18, v134
  v_add_f32 v19, v19, v135
  v_cvt_pk_bf16_f32 v20, v12, v13
  v_lshlrev_b32 v12, 16, v20
  v_and_b32 v13, 0xffff0000, v20
  v_cvt_pk_bf16_f32 v20, v14, v15
  v_lshlrev_b32 v14, 16, v20
  v_and_b32 v15, 0xffff0000, v20
  v_cvt_pk_bf16_f32 v20, v16, v17
  v_lshlrev_b32 v16, 16, v20
  v_and_b32 v17, 0xffff0000, v20
  v_cvt_pk_bf16_f32 v20, v18, v19
  v_lshlrev_b32 v18, 16, v20
  v_and_b32 v19, 0xffff0000, v20
  s_lshl_b32 s9, s3, 11
  s_add_u32 s9, s9, 122240
  v_add_u32 v10, s9, v9
  ds_write_b128 v10, v[12:15]
  ds_write_b128 v10, v[16:19] offset:16
  v_add_f32 v144, v12, v13
  v_add_f32 v144, v144, v14
  v_add_f32 v144, v144, v15
  v_add_f32 v144, v144, v16
  v_add_f32 v144, v144, v17
  v_add_f32 v144, v144, v18
  v_add_f32 v144, v144, v19
  s_nop 1
  v_add_f32_dpp v144, v144, v144 row_ror:8 row_mask:0xf bank_mask:0xf
  s_nop 1
  v_add_f32_dpp v144, v144, v144 row_ror:4 row_mask:0xf bank_mask:0xf
  s_nop 1
  v_add_f32_dpp v144, v144, v144 row_ror:2 row_mask:0xf bank_mask:0xf
  s_nop 1
  v_add_f32_dpp v144, v144, v144 row_ror:1 row_mask:0xf bank_mask:0xf
  s_nop 0
  v_readlane_b32 s12, v144, 0
  v_readlane_b32 s13, v144, 16
  v_readlane_b32 s14, v144, 32
  v_readlane_b32 s15, v144, 48
  v_mov_b32 v146, s12
  v_add_f32 v146, s13, v146
  v_add_f32 v146, s14, v146
  v_add_f32 v146, s15, v146
  v_mul_f32 v146, 0x3b000000, v146
  v_sub_f32 v136, v12, v146
  v_sub_f32 v137, v13, v146
  v_sub_f32 v138, v14, v146
  v_sub_f32 v139, v15, v146
  v_sub_f32 v140, v16, v146
  v_sub_f32 v141, v17, v146
  v_sub_f32 v142, v18, v146
  v_sub_f32 v143, v19, v146
  v_mul_f32 v144, v136, v136
  v_fmac_f32 v144, v137, v137
  v_fmac_f32 v144, v138, v138
  v_fmac_f32 v144, v139, v139
  v_fmac_f32 v144, v140, v140
  v_fmac_f32 v144, v141, v141
  v_fmac_f32 v144, v142, v142
  v_fmac_f32 v144, v143, v143
  s_nop 1
  v_add_f32_dpp v144, v144, v144 row_ror:8 row_mask:0xf bank_mask:0xf
  s_nop 1
  v_add_f32_dpp v144, v144, v144 row_ror:4 row_mask:0xf bank_mask:0xf
  s_nop 1
  v_add_f32_dpp v144, v144, v144 row_ror:2 row_mask:0xf bank_mask:0xf
  s_nop 1
  v_add_f32_dpp v144, v144, v144 row_ror:1 row_mask:0xf bank_mask:0xf
  s_nop 0
  v_readlane_b32 s12, v144, 0
  v_readlane_b32 s13, v144, 16
  v_readlane_b32 s14, v144, 32
  v_readlane_b32 s15, v144, 48
  v_mov_b32 v145, s12
  v_add_f32 v145, s13, v145
  v_add_f32 v145, s14, v145
  v_add_f32 v145, s15, v145
  v_mul_f32 v145, 0x3b000000, v145
  v_cvt_pk_bf16_f32 v149, v145, v145
  v_lshlrev_b32 v145, 16, v149
  v_add_f32 v145, 0x3727c5ac, v145
  v_cvt_pk_bf16_f32 v149, v145, v145
  v_lshlrev_b32 v145, 16, v149
  v_sqrt_f32 v148, v145
  s_nop 0
  v_cvt_pk_bf16_f32 v149, v148, v148
  v_lshlrev_b32 v148, 16, v149
  v_rcp_f32 v147, v148
  v_cvt_pk_bf16_f32 v149, v146, v146
  v_lshlrev_b32 v146, 16, v149
  v_sub_f32 v136, v12, v146
  v_sub_f32 v137, v13, v146
  v_sub_f32 v138, v14, v146
  v_sub_f32 v139, v15, v146
  v_sub_f32 v140, v16, v146
  v_sub_f32 v141, v17, v146
  v_sub_f32 v142, v18, v146
  v_sub_f32 v143, v19, v146
  v_cvt_pk_bf16_f32 v149, v136, v137
  v_lshlrev_b32 v136, 16, v149
  v_and_b32 v137, 0xffff0000, v149
  v_cvt_pk_bf16_f32 v149, v138, v139
  v_lshlrev_b32 v138, 16, v149
  v_and_b32 v139, 0xffff0000, v149
  v_cvt_pk_bf16_f32 v149, v140, v141
  v_lshlrev_b32 v140, 16, v149
  v_and_b32 v141, 0xffff0000, v149
  v_cvt_pk_bf16_f32 v149, v142, v143
  v_lshlrev_b32 v142, 16, v149
  v_and_b32 v143, 0xffff0000, v149
  v_mul_f32 v144, v136, v147
  v_fma_f32 v145, -v144, v148, v136
  v_fma_f32 v136, v145, v147, v144
  v_mul_f32 v144, v137, v147
  v_fma_f32 v145, -v144, v148, v137
  v_fma_f32 v137, v145, v147, v144
  v_mul_f32 v144, v138, v147
  v_fma_f32 v145, -v144, v148, v138
  v_fma_f32 v138, v145, v147, v144
  v_mul_f32 v144, v139, v147
  v_fma_f32 v145, -v144, v148, v139
  v_fma_f32 v139, v145, v147, v144
  v_mul_f32 v144, v140, v147
  v_fma_f32 v145, -v144, v148, v140
  v_fma_f32 v140, v145, v147, v144
  v_mul_f32 v144, v141, v147
  v_fma_f32 v145, -v144, v148, v141
  v_fma_f32 v141, v145, v147, v144
  v_mul_f32 v144, v142, v147
  v_fma_f32 v145, -v144, v148, v142
  v_fma_f32 v142, v145, v147, v144
  v_mul_f32 v144, v143, v147
  v_fma_f32 v145, -v144, v148, v143
  v_fma_f32 v143, v145, v147, v144
  v_cvt_pk_bf16_f32 v152, v136, v137
  v_lshlrev_b32 v136, 16, v152
  v_and_b32 v137, 0xffff0000, v152
  v_cvt_pk_bf16_f32 v153, v138, v139
  v_lshlrev_b32 v138, 16, v153
  v_and_b32 v139, 0xffff0000, v153
  v_cvt_pk_bf16_f32 v154, v140, v141
  v_lshlrev_b32 v140, 16, v154
  v_and_b32 v141, 0xffff0000, v154
  v_cvt_pk_bf16_f32 v155, v142, v143
  v_lshlrev_b32 v142, 16, v155
  v_and_b32 v143, 0xffff0000, v155
  s_lshl_b32 s9, s3, 10
  s_add_u32 s9, s9, 118144
  v_add_u32 v10, s9, v6
  ds_write_b128 v10, v[152:155]
  s_waitcnt lgkmcnt(0)
  s_barrier
  v_lshlrev_b32 v7, 3, v2
  v_lshrrev_b32 v8, 2, v3
  v_add_u32 v7, v7, v8
  v_and_b32 v8, 3, v1
  v_lshlrev_b32 v8, 3, v8
  v_lshlrev_b32 v9, 10, v7
  v_add_u32 v9, v9, v8
  s_lshl_b32 s9, s3, 7
  s_add_u32 s9, s9, 65536
  v_add_u32 v9, s9, v9
  ds_read_b64_tr_b16 v[32:33], v9 offset:0
  ds_read_b64_tr_b16 v[34:35], v9 offset:4096
  ds_read_b64_tr_b16 v[36:37], v9 offset:32
  ds_read_b64_tr_b16 v[38:39], v9 offset:4128
  ds_read_b64_tr_b16 v[40:41], v9 offset:64
  ds_read_b64_tr_b16 v[42:43], v9 offset:4160
  ds_read_b64_tr_b16 v[44:45], v9 offset:96
  ds_read_b64_tr_b16 v[46:47], v9 offset:4192
  s_barrier
  s_branch L_ffn_down
L_tail_hi:
  s_waitcnt lgkmcnt(0)
  s_barrier
  v_mov_b32 v50, 149124
  s_mov_b32 s14, 0
L_go_15:
  ds_read_b32 v49, v50
  s_waitcnt lgkmcnt(0)
  v_readfirstlane_b32 s9, v49
  s_cmp_ge_u32 s9, 1
  s_cbranch_scc1 L_god_16
  s_sleep 1
  s_add_u32 s14, s14, 1
  s_cmp_lt_u32 s14, 1600000
  s_cbranch_scc1 L_go_15
L_god_16:
  s_sub_u32 s100, s9, 1
  s_cmp_ge_u32 s100, 43
  s_cbranch_scc1 L_end
  s_sub_u32 s12, s3, 4
  v_lshrrev_b32 v7, 2, v1
  s_lshl_b32 s10, s12, 7
  v_add_u32 v7, s10, v7
  s_movk_i32 s10, 2752
  v_mul_lo_u32 v7, v7, s10
  v_and_b32 v8, 3, v1
  v_lshlrev_b32 v8, 4, v8
  v_add_u32 v7, v7, v8
  s_lshl_b32 s10, s100, 6
  v_add_u32 v7, s10, v7
  s_lshl_b32 s11, s12, 13
  s_add_u32 m0, s11, 0
  s_nop 0
  buffer_load_dwordx4 v7, s[60:63], 0 offen nt lds
  s_add_u32 m0, s11, 32768
  s_nop 0
  buffer_load_dwordx4 v7, s[64:67], 0 offen nt lds
  v_add_u32 v7, 44032, v7
  s_add_u32 m0, s11, 1024
  s_nop 0
  buffer_load_dwordx4 v7, s[60:63], 0 offen nt lds
  s_add_u32 m0, s11, 33792
  s_nop 0
  buffer_load_dwordx4 v7, s[64:67], 0 offen nt lds
  v_add_u32 v7, 44032, v7
  s_add_u32 m0, s11, 2048
  s_nop 0
  buffer_load_dwordx4 v7, s[60:63], 0 offen nt lds
  s_add_u32 m0, s11, 34816
  s_nop 0
  buffer_load_dwordx4 v7, s[64:67], 0 offen nt lds
  v_add_u32 v7, 44032, v7
  s_add_u32 m0, s11, 3072
  s_nop 0
  buffer_load_dwordx4 v7, s[60:63], 0 offen nt lds
  s_add_u32 m0, s11, 35840
  s_nop 0
  buffer_load_dwordx4 v7, s[64:67], 0 offen nt lds
  v_add_u32 v7, 44032, v7
  s_add_u32 m0, s11, 4096
  s_nop 0
  buffer_load_dwordx4 v7, s[60:63], 0 offen nt lds
  s_add_u32 m0, s11, 36864
  s_nop 0
  buffer_load_dwordx4 v7, s[64:67], 0 offen nt lds
  v_add_u32 v7, 44032, v7
  s_add_u32 m0, s11, 5120
  s_nop 0
  buffer_load_dwordx4 v7, s[60:63], 0 offen nt lds
  s_add_u32 m0, s11, 37888
  s_nop 0
  buffer_load_dwordx4 v7, s[64:67], 0 offen nt lds
  v_add_u32 v7, 44032, v7
  s_add_u32 m0, s11, 6144
  s_nop 0
  buffer_load_dwordx4 v7, s[60:63], 0 offen nt lds
  s_add_u32 m0, s11, 38912
  s_nop 0
  buffer_load_dwordx4 v7, s[64:67], 0 offen nt lds
  v_add_u32 v7, 44032, v7
  s_add_u32 m0, s11, 7168
  s_nop 0
  buffer_load_dwordx4 v7, s[60:63], 0 offen nt lds
  s_add_u32 m0, s11, 39936
  s_nop 0
  buffer_load_dwordx4 v7, s[64:67], 0 offen nt lds
  s_lshl_b32 s10, s100, 15
  s_add_u32 s10, s10, s11
  v_add_u32 v7, s10, v6
  s_add_u32 m0, s11, 65536
  s_nop 0
  buffer_load_dwordx4 v7, s[68:71], 0 offen nt lds
  v_add_u32 v7, 1024, v7
  s_add_u32 m0, s11, 66560
  s_nop 0
  buffer_load_dwordx4 v7, s[68:71], 0 offen nt lds
  v_add_u32 v7, 1024, v7
  s_add_u32 m0, s11, 67584
  s_nop 0
  buffer_load_dwordx4 v7, s[68:71], 0 offen nt lds
  v_add_u32 v7, 1024, v7
  s_add_u32 m0, s11, 68608
  s_nop 0
  buffer_load_dwordx4 v7, s[68:71], 0 offen nt lds
  v_add_u32 v7, 1024, v7
  s_add_u32 m0, s11, 69632
  s_nop 0
  buffer_load_dwordx4 v7, s[68:71], 0 offen nt lds
  v_add_u32 v7, 1024, v7
  s_add_u32 m0, s11, 70656
  s_nop 0
  buffer_load_dwordx4 v7, s[68:71], 0 offen nt lds
  v_add_u32 v7, 1024, v7
  s_add_u32 m0, s11, 71680
  s_nop 0
  buffer_load_dwordx4 v7, s[68:71], 0 offen nt lds
  v_add_u32 v7, 1024, v7
  s_add_u32 m0, s11, 72704
  s_nop 0
  buffer_load_dwordx4 v7, s[68:71], 0 offen nt lds
  v_mov_b32 v7, 149136
  v_mov_b32 v8, 1
  s_waitcnt vmcnt(0)
  s_mov_b64 s[10:11], exec
  s_mov_b64 exec, 1
  ds_add_u32 v7, v8
  s_mov_b64 exec, s[10:11]
  s_mov_b32 s14, 0
L_cnt:
  ds_read_b32 v8, v7
  s_waitcnt lgkmcnt(0)
  v_readfirstlane_b32 s9, v8
  s_cmp_ge_u32 s9, 4
  s_cbranch_scc1 L_cnt_done
  s_sleep 1
  s_add_u32 s14, s14, 1
  s_cmp_lt_u32 s14, 400000
  s_cbranch_scc1 L_cnt
L_cnt_done:
  v_lshlrev_b32 v7, 3, v2
  v_lshrrev_b32 v8, 2, v3
  v_add_u32 v7, v7, v8
  v_and_b32 v8, 3, v1
  v_lshlrev_b32 v8, 3, v8
  v_lshlrev_b32 v9, 10, v7
  v_add_u32 v9, v9, v8
  s_lshl_b32 s9, s3, 7
  s_add_u32 s9, s9, 65536
  v_add_u32 v9, s9, v9
  ds_read_b64_tr_b16 v[32:33], v9 offset:0
  ds_read_b64_tr_b16 v[34:35], v9 offset:4096
  ds_read_b64_tr_b16 v[36:37], v9 offset:32
  ds_read_b64_tr_b16 v[38:39], v9 offset:4128
  ds_read_b64_tr_b16 v[40:41], v9 offset:64
  ds_read_b64_tr_b16 v[42:43], v9 offset:4160
  ds_read_b64_tr_b16 v[44:45], v9 offset:96
  ds_read_b64_tr_b16 v[46:47], v9 offset:4192
  s_cmp_ge_u32 s3, 6
  s_cbranch_scc1 L_ffn_idle0
  v_lshlrev_b32 v9, 6, v7
  v_add_u32 v9, v9, v8
  s_sub_u32 s9, s3, 4
  s_lshl_b32 s9, s9, 5
  v_add_u32 v9, s9, v9
  v_add_u32 v10, 32768, v9
  v_and_b32 v11, 3, v1
  v_lshlrev_b32 v11, 10, v11
  v_lshlrev_b32 v20, 4, v2
  v_add_u32 v11, v11, v20
  v_add_u32 v11, 118144, v11
  ds_read_b64_tr_b16 v[128:129], v9 offset:0
  ds_read_b64_tr_b16 v[130:131], v9 offset:256
  ds_read_b64_tr_b16 v[192:193], v10 offset:0
  ds_read_b64_tr_b16 v[194:195], v10 offset:256
  ds_read_b64_tr_b16 v[132:133], v9 offset:2048
  ds_read_b64_tr_b16 v[134:135], v9 offset:2304
  ds_read_b64_tr_b16 v[196:197], v10 offset:2048
  ds_read_b64_tr_b16 v[198:199], v10 offset:2304
  ds_read_b64_tr_b16 v[136:137], v9 offset:4096
  ds_read_b64_tr_b16 v[138:139], v9 offset:4352
  ds_read_b64_tr_b16 v[200:201], v10 offset:4096
  ds_read_b64_tr_b16 v[202:203], v10 offset:4352
  ds_read_b64_tr_b16 v[140:141], v9 offset:6144
  ds_read_b64_tr_b16 v[142:143], v9 offset:6400
  ds_read_b64_tr_b16 v[204:205], v10 offset:6144
  ds_read_b64_tr_b16 v[206:207], v10 offset:6400
  ds_read_b64_tr_b16 v[144:145], v9 offset:8192
  ds_read_b64_tr_b16 v[146:147], v9 offset:8448
  ds_read_b64_tr_b16 v[208:209], v10 offset:8192
  ds_read_b64_tr_b16 v[210:211], v10 offset:8448
  ds_read_b64_tr_b16 v[148:149], v9 offset:10240
  ds_read_b64_tr_b16 v[150:151], v9 offset:10496
  ds_read_b64_tr_b16 v[212:213], v10 offset:10240
  ds_read_b64_tr_b16 v[214:215], v10 offset:10496
  ds_read_b64_tr_b16 v[152:153], v9 offset:12288
  ds_read_b64_tr_b16 v[154:155], v9 offset:12544
  ds_read_b64_tr_b16 v[216:217], v10 offset:12288
  ds_read_b64_tr_b16 v[218:219], v10 offset:12544
  ds_read_b64_tr_b16 v[156:157], v9 offset:14336
  ds_read_b64_tr_b16 v[158:159], v9 offset:14592
  ds_read_b64_tr_b16 v[220:221], v10 offset:14336
  ds_read_b64_tr_b16 v[222:223], v10 offset:14592
  ds_read_b64_tr_b16 v[160:161], v9 offset:16384
  ds_read_b64_tr_b16 v[162:163], v9 offset:16640
  ds_read_b64_tr_b16 v[224:225], v10 offset:16384
  ds_read_b64_tr_b16 v[226:227], v10 offset:16640
  ds_read_b64_tr_b16 v[164:165], v9 offset:18432
  ds_read_b64_tr_b16 v[166:167], v9 offset:18688
  ds_read_b64_tr_b16 v[228:229], v10 offset:18432
  ds_read_b64_tr_b16 v[230:231], v10 offset:18688
  ds_read_b64_tr_b16 v[168:169], v9 offset:20480
  ds_read_b64_tr_b16 v[170:171], v9 offset:20736
  ds_read_b64_tr_b16 v[232:233], v10 offset:20480
  ds_read_b64_tr_b16 v[234:235], v10 offset:20736
  ds_read_b64_tr_b16 v[172:173], v9 offset:22528
  ds_read_b64_tr_b16 v[174:175], v9 offset:22784
  ds_read_b64_tr_b16 v[236:237], v10 offset:22528
  ds_read_b64_tr_b16 v[238:239], v10 offset:22784
  ds_read_b64_tr_b16 v[176:177], v9 offset:24576
  ds_read_b64_tr_b16 v[178:179], v9 offset:24832
  ds_read_b64_tr_b16 v[240:241], v10 offset:24576
  ds_read_b64_tr_b16 v[242:243], v10 offset:24832
  ds_read_b64_tr_b16 v[180:181], v9 offset:26624
  ds_read_b64_tr_b16 v[182:183], v9 offset:26880
  ds_read_b64_tr_b16 v[244:245], v10 offset:26624
  ds_read_b64_tr_b16 v[246:247], v10 offset:26880
  ds_read_b64_tr_b16 v[184:185], v9 offset:28672
  ds_read_b64_tr_b16 v[186:187], v9 offset:28928
  ds_read_b64_tr_b16 v[248:249], v10 offset:28672
  ds_read_b64_tr_b16 v[250:251], v10 offset:28928
  ds_read_b64_tr_b16 v[188:189], v9 offset:30720
  ds_read_b64_tr_b16 v[190:191], v9 offset:30976
  ds_read_b64_tr_b16 v[252:253], v10 offset:30720
  ds_read_b64_tr_b16 v[254:255], v10 offset:30976
  s_waitcnt lgkmcnt(0)
  s_barrier
  ds_read_b128 v[64:67], v11 offset:0
  ds_read_b128 v[68:71], v11 offset:64
  ds_read_b128 v[72:75], v11 offset:128
  ds_read_b128 v[76:79], v11 offset:192
  ds_read_b128 v[80:83], v11 offset:256
  ds_read_b128 v[84:87], v11 offset:320
  ds_read_b128 v[88:91], v11 offset:384
  ds_read_b128 v[92:95], v11 offset:448
  ds_read_b128 v[96:99], v11 offset:512
  ds_read_b128 v[100:103], v11 offset:576
  ds_read_b128 v[104:107], v11 offset:640
  ds_read_b128 v[108:111], v11 offset:704
  ds_read_b128 v[112:115], v11 offset:768
  ds_read_b128 v[116:119], v11 offset:832
  ds_read_b128 v[120:123], v11 offset:896
  ds_read_b128 v[124:127], v11 offset:960
  s_waitcnt lgkmcnt(15)
  v_mfma_f32_16x16x32_bf16 v[12:15], v[128:131], v[64:67], 0
  v_mfma_f32_16x16x32_bf16 v[16:19], v[192:195], v[64:67], 0
  s_waitcnt lgkmcnt(14)
  v_mfma_f32_16x16x32_bf16 v[12:15], v[132:135], v[68:71], v[12:15]
  v_mfma_f32_16x16x32_bf16 v[16:19], v[196:199], v[68:71], v[16:19]
  s_waitcnt lgkmcnt(13)
  v_mfma_f32_16x16x32_bf16 v[12:15], v[136:139], v[72:75], v[12:15]
  v_mfma_f32_16x16x32_bf16 v[16:19], v[200:203], v[72:75], v[16:19]
  s_waitcnt lgkmcnt(12)
  v_mfma_f32_16x16x32_bf16 v[12:15], v[140:143], v[76:79], v[12:15]
  v_mfma_f32_16x16x32_bf16 v[16:19], v[204:207], v[76:79], v[16:19]
  s_waitcnt lgkmcnt(11)
  v_mfma_f32_16x16x32_bf16 v[12:15], v[144:147], v[80:83], v[12:15]
  v_mfma_f32_16x16x32_bf16 v[16:19], v[208:211], v[80:83], v[16:19]
  s_waitcnt lgkmcnt(10)
  v_mfma_f32_16x16x32_bf16 v[12:15], v[148:151], v[84:87], v[12:15]
  v_mfma_f32_16x16x32_bf16 v[16:19], v[212:215], v[84:87], v[16:19]
  s_waitcnt lgkmcnt(9)
  v_mfma_f32_16x16x32_bf16 v[12:15], v[152:155], v[88:91], v[12:15]
  v_mfma_f32_16x16x32_bf16 v[16:19], v[216:219], v[88:91], v[16:19]
  s_waitcnt lgkmcnt(8)
  v_mfma_f32_16x16x32_bf16 v[12:15], v[156:159], v[92:95], v[12:15]
  v_mfma_f32_16x16x32_bf16 v[16:19], v[220:223], v[92:95], v[16:19]
  s_waitcnt lgkmcnt(7)
  v_mfma_f32_16x16x32_bf16 v[12:15], v[160:163], v[96:99], v[12:15]
  v_mfma_f32_16x16x32_bf16 v[16:19], v[224:227], v[96:99], v[16:19]
  s_waitcnt lgkmcnt(6)
  v_mfma_f32_16x16x32_bf16 v[12:15], v[164:167], v[100:103], v[12:15]
  v_mfma_f32_16x16x32_bf16 v[16:19], v[228:231], v[100:103], v[16:19]
  s_waitcnt lgkmcnt(5)
  v_mfma_f32_16x16x32_bf16 v[12:15], v[168:171], v[104:107], v[12:15]
  v_mfma_f32_16x16x32_bf16 v[16:19], v[232:235], v[104:107], v[16:19]
  s_waitcnt lgkmcnt(4)
  v_mfma_f32_16x16x32_bf16 v[12:15], v[172:175], v[108:111], v[12:15]
  v_mfma_f32_16x16x32_bf16 v[16:19], v[236:239], v[108:111], v[16:19]
  s_waitcnt lgkmcnt(3)
  v_mfma_f32_16x16x32_bf16 v[12:15], v[176:179], v[112:115], v[12:15]
  v_mfma_f32_16x16x32_bf16 v[16:19], v[240:243], v[112:115], v[16:19]
  s_waitcnt lgkmcnt(2)
  v_mfma_f32_16x16x32_bf16 v[12:15], v[180:183], v[116:119], v[12:15]
  v_mfma_f32_16x16x32_bf16 v[16:19], v[244:247], v[116:119], v[16:19]
  s_waitcnt lgkmcnt(1)
  v_mfma_f32_16x16x32_bf16 v[12:15], v[184:187], v[120:123], v[12:15]
  v_mfma_f32_16x16x32_bf16 v[16:19], v[248:251], v[120:123], v[16:19]
  s_waitcnt lgkmcnt(0)
  v_mfma_f32_16x16x32_bf16 v[12:15], v[188:191], v[124:127], v[12:15]
  v_mfma_f32_16x16x32_bf16 v[16:19], v[252:255], v[124:127], v[16:19]
  s_nop 6
  v_cvt_pk_bf16_f32 v20, v12, v13
  v_lshlrev_b32 v12, 16, v20
  v_and_b32 v13, 0xffff0000, v20
  v_cvt_pk_bf16_f32 v20, v14, v15
  v_lshlrev_b32 v14, 16, v20
  v_and_b32 v15, 0xffff0000, v20
  v_cvt_pk_bf16_f32 v20, v16, v17
  v_lshlrev_b32 v16, 16, v20
  v_and_b32 v17, 0xffff0000, v20
  v_cvt_pk_bf16_f32 v20, v18, v19
  v_lshlrev_b32 v18, 16, v20
  v_and_b32 v19, 0xffff0000, v20
  v_mul_f32 v20, 0xbfb8aa3b, v12
  v_exp_f32 v20, v20
  v_mul_f32 v21, 0xbfb8aa3b, v13
  v_exp_f32 v21, v21
  v_mul_f32 v22, 0xbfb8aa3b, v14
  v_exp_f32 v22, v22
  v_mul_f32 v23, 0xbfb8aa3b, v15
  v_exp_f32 v23, v23
  s_nop 0
  v_add_f32 v20, 1.0, v20
  v_rcp_f32 v24, v20
  v_add_f32 v21, 1.0, v21
  v_rcp_f32 v25, v21
  v_add_f32 v22, 1.0, v22
  v_rcp_f32 v26, v22
  v_add_f32 v23, 1.0, v23
  v_rcp_f32 v27, v23
  s_nop 0
  v_mul_f32 v28, v12, v24
  v_fma_f32 v48, -v28, v20, v12
  v_fma_f32 v12, v48, v24, v28
  v_mul_f32 v29, v13, v25
  v_fma_f32 v49, -v29, v21, v13
  v_fma_f32 v13, v49, v25, v29
  v_mul_f32 v30, v14, v26
  v_fma_f32 v50, -v30, v22, v14
  v_fma_f32 v14, v50, v26, v30
  v_mul_f32 v31, v15, v27
  v_fma_f32 v51, -v31, v23, v15
  v_fma_f32 v15, v51, v27, v31
  v_cvt_pk_bf16_f32 v20, v12, v13
  v_lshlrev_b32 v12, 16, v20
  v_and_b32 v13, 0xffff0000, v20
  v_cvt_pk_bf16_f32 v20, v14, v15
  v_lshlrev_b32 v14, 16, v20
  v_and_b32 v15, 0xffff0000, v20
  v_mul_f32 v12, v12, v16
  v_mul_f32 v13, v13, v17
  v_mul_f32 v14, v14, v18
  v_mul_f32 v15, v15, v19
  v_cvt_pk_bf16_f32 v20, v12, v13
  v_cvt_pk_bf16_f32 v21, v14, v15
  v_lshlrev_b32 v9, 6, v3
  v_lshlrev_b32 v10, 3, v2
  v_add_u32 v9, v9, v10
  s_add_u32 s9, s9, 130432
  v_add_u32 v9, s9, v9
  v_cmp_gt_u32 vcc, 4, v3
  s_and_saveexec_b64 s[10:11], vcc
  ds_write_b64 v9, v[20:21]
  s_mov_b64 exec, s[10:11]
  s_waitcnt lgkmcnt(0)
  s_branch L_ffn_idle
L_ffn_idle0:
  s_barrier
L_ffn_idle:
  s_barrier
L_ffn_down:
  v_and_b32 v9, 3, v1
  v_lshlrev_b32 v9, 6, v9
  v_lshlrev_b32 v10, 4, v2
  v_add_u32 v9, v9, v10
  v_add_u32 v9, 130432, v9
  ds_read_b128 v[28:31], v9
  v_lshlrev_b32 v9, 11, v3
  v_add_u32 v9, v9, v10
  s_lshl_b32 s9, s100, 13
  s_lshl_b32 s10, s3, 8
  s_add_u32 s9, s9, s10
  s_add_u32 s9, s9, 0x160000
  v_add_u32 v9, s9, v9
  v_cmp_gt_u32 vcc, 4, v3
  s_waitcnt lgkmcnt(0)
  v_mfma_f32_16x16x32_bf16 v[12:15], v[32:35], v[28:31], 0
  v_mfma_f32_16x16x32_bf16 v[16:19], v[36:39], v[28:31], 0
  v_mfma_f32_16x16x32_bf16 v[20:23], v[40:43], v[28:31], 0
  v_mfma_f32_16x16x32_bf16 v[24:27], v[44:47], v[28:31], 0
  s_and_saveexec_b64 s[10:11], vcc
  s_nop 3
  buffer_store_dwordx4 v[12:15], v9, s[80:83], 0 offen offset:0 sc1
  buffer_store_dwordx4 v[16:19], v9, s[80:83], 0 offen offset:64 sc1
  buffer_store_dwordx4 v[20:23], v9, s[80:83], 0 offen offset:128 sc1
  buffer_store_dwordx4 v[24:27], v9, s[80:83], 0 offen offset:192 sc1
  s_mov_b64 exec, s[10:11]
  s_cmp_ge_u32 s100, 32
  s_cbranch_scc1 L_end
  s_lshl_b32 s9, s100, 8
  s_lshl_b32 s10, s3, 13
  s_add_u32 s9, s9, s10
  s_add_u32 s9, s9, 0x160000
  v_lshlrev_b32 v10, 2, v1
  v_add_u32 v9, s9, v10
  s_mov_b32 s16, 0
  s_mov_b32 s17, 65536
  s_mov_b32 s18, 131072
  s_mov_b32 s19, 196608
  s_mov_b32 s20, 262144
  s_mov_b32 s21, 327680
  s_mov_b32 s14, 0
L_poll3:
  buffer_load_dword v12, v9, s[80:83], s16 offen sc1
  buffer_load_dword v13, v9, s[80:83], s17 offen sc1
  buffer_load_dword v14, v9, s[80:83], s18 offen sc1
  buffer_load_dword v15, v9, s[80:83], s19 offen sc1
  buffer_load_dword v16, v9, s[80:83], s20 offen sc1
  buffer_load_dword v17, v9, s[80:83], s21 offen sc1
  s_waitcnt vmcnt(0)
  v_cmp_eq_u32 vcc, -1, v12
  v_cmp_eq_u32 s[10:11], -1, v13
  s_or_b64 vcc, vcc, s[10:11]
  v_cmp_eq_u32 s[10:11], -1, v14
  s_or_b64 vcc, vcc, s[10:11]
  v_cmp_eq_u32 s[10:11], -1, v15
  s_or_b64 vcc, vcc, s[10:11]
  v_cmp_eq_u32 s[10:11], -1, v16
  s_or_b64 vcc, vcc, s[10:11]
  v_cmp_eq_u32 s[10:11], -1, v17
  s_or_b64 vcc, vcc, s[10:11]
  s_cmp_eq_u64 vcc, 0
  s_cbranch_scc1 L_poll3_done
  s_add_u32 s14, s14, 1
  s_cmp_lt_u32 s14, 400000
  s_cbranch_scc1 L_poll3
L_poll3_done:
  v_add_f32 v12, v12, v13
  v_add_f32 v14, v14, v15
  v_add_f32 v16, v16, v17
  v_add_f32 v12, v12, v14
  v_add_f32 v12, v12, v16
  v_lshlrev_b32 v9, 2, v0
  v_add_u32 v9, 130688, v9
  ds_write_b32 v9, v12
  s_waitcnt lgkmcnt(0)
  s_barrier
  s_cmp_lg_u32 s3, 0
  s_cbranch_scc1 L_end
  ds_read_b32 v12, v9 offset:0
  ds_read_b32 v13, v9 offset:256
  ds_read_b32 v14, v9 offset:512
  ds_read_b32 v15, v9 offset:768
  ds_read_b32 v16, v9 offset:1024
  ds_read_b32 v17, v9 offset:1280
  ds_read_b32 v18, v9 offset:1536
  ds_read_b32 v19, v9 offset:1792
  s_lshl_b32 s9, s100, 8
  s_add_u32 s9, s9, 122240
  v_add_u32 v10, s9, v10
  ds_read_b32 v20, v10
  s_waitcnt lgkmcnt(0)
  v_add_f32 v12, v12, v16
  v_add_f32 v13, v13, v17
  v_add_f32 v14, v14, v18
  v_add_f32 v15, v15, v19
  v_add_f32 v12, v12, v14
  v_add_f32 v13, v13, v15
  v_add_f32 v12, v12, v13
  v_cvt_pk_bf16_f32 v21, v12, v12
  v_lshlrev_b32 v12, 16, v21
  v_add_f32 v12, v12, v20
  v_cvt_pk_bf16_f32 v12, v12, v12
  s_lshl_b32 s9, s100, 7
  v_lshlrev_b32 v10, 1, v1
  v_add_u32 v10, s9, v10
  buffer_store_short v12, v10, s[72:75], 0 offen
L_end:
  s_endpgm
.section .rodata,"a"
.p2align 6
.amdhsa_kernel sequential_preLN__sliding_block_cached__swiglu_ffn__decode_kernel
  .amdhsa_next_free_vgpr 256
  .amdhsa_next_free_sgpr 102
  .amdhsa_accum_offset 256
  .amdhsa_group_segment_fixed_size 0
  .amdhsa_kernarg_size 96
  .amdhsa_user_sgpr_count 2
  .amdhsa_user_sgpr_kernarg_segment_ptr 1
  .amdhsa_system_sgpr_workgroup_id_x 1
.end_amdhsa_kernel
```
